```python
import torch

def _softmax(x, axis=-1):
    return torch.softmax(x, dim=axis)
def _gelu(x):
    return torch.nn.functional.gelu(x, approximate="tanh")
def _silu(x):
    return torch.nn.functional.silu(x)
def _sigmoid(x):
    return torch.sigmoid(x)
def _layernorm(x, axis=-1, eps=1e-5):
    m = x.mean(dim=axis, keepdim=True)
    v = x.var(dim=axis, keepdim=True, unbiased=False)
    return (x - m) / torch.sqrt(v + eps)
def _scatter_add(tgt, idx, src, axis=0):
    return tgt.clone().index_add_(axis, idx, src)
def _segment_sum(src, seg, n):
    out = torch.zeros((n,) + src.shape[1:], dtype=src.dtype)
    return out.index_add_(0, seg, src)
def _pad(x, pw):
    flat = tuple(v for pair in reversed(pw) for v in pair)
    return torch.nn.functional.pad(x, flat)

kernel_name = 'concat_heads__mha_block_cached__mha_block_cached__near_ridge'

def setup_inputs():

    _w = (lambda a: (lambda t: t.to(torch.bfloat16) if t.is_floating_point() else t)(torch.as_tensor(a)))
    def _A_setup():
        B, Sq, D = 16, 80, 640
        H, Sk, Dh = 32, 512, 192
        return {
            "x": _w((lambda *s: torch.randn(*s, dtype=torch.bfloat16) * 0.8)(B, Sq, D)),
            "k_cache": _w((lambda *s: torch.randn(*s, dtype=torch.bfloat16) * 0.8)(B, H, Sk, Dh)),
            "v_cache": _w((lambda *s: torch.randn(*s, dtype=torch.bfloat16) * 0.05)(B, H, Sk, Dh)),
            "wq": _w((lambda *s: torch.randn(*s, dtype=torch.bfloat16) * 0.8)(D, H * Dh) * (D ** -0.5)),
            "wo": _w((lambda *s: torch.randn(*s, dtype=torch.bfloat16) * 0.05)(H * Dh, D) * ((H * Dh) ** -0.5)),
        }
    _A_in = _A_setup()

    def _B_setup():
        B, Sq, D = 16, 80, 640
        H, Sk, Dh = 32, 512, 192
        return {
            "x": _w((lambda *s: torch.randn(*s, dtype=torch.bfloat16) * 0.8)(B, Sq, D)),
            "k_cache": _w((lambda *s: torch.randn(*s, dtype=torch.bfloat16) * 0.8)(B, H, Sk, Dh)),
            "v_cache": _w((lambda *s: torch.randn(*s, dtype=torch.bfloat16) * 0.05)(B, H, Sk, Dh)),
            "wq": _w((lambda *s: torch.randn(*s, dtype=torch.bfloat16) * 0.8)(D, H * Dh) * (D ** -0.5)),
            "wo": _w((lambda *s: torch.randn(*s, dtype=torch.bfloat16) * 0.05)(H * Dh, D) * ((H * Dh) ** -0.5)),
        }
    _B_in = _B_setup()

    return {
        "A_x": _A_in["x"],
        "A_k_cache": _A_in["k_cache"],
        "A_v_cache": _A_in["v_cache"],
        "A_wq": _A_in["wq"],
        "A_wo": _A_in["wo"],
        "B_x": _B_in["x"],
        "B_k_cache": _B_in["k_cache"],
        "B_v_cache": _B_in["v_cache"],
        "B_wq": _B_in["wq"],
        "B_wo": _B_in["wo"],
    }

def reference(A_x, A_k_cache, A_v_cache, A_wq, A_wo, B_x, B_k_cache, B_v_cache, B_wq, B_wo):
    def _A_ref(x, k_cache, v_cache, wq, wo):
        B, Sq, D = x.shape
        H, Dh = 32, 192
        q = (lambda x, *d: x.permute(*d))((x @ wq).reshape(B, Sq, H, Dh), 0, 2, 1, 3)
        scores = torch.einsum("bhqd,bhkd->bhqk", q, k_cache) * (Dh ** -0.5)
        p = _softmax(scores, axis=-1)
        o = torch.einsum("bhqk,bhkd->bhqd", p, v_cache)
        return (lambda x, *d: x.permute(*d))(o, 0, 2, 1, 3).reshape(B, Sq, H * Dh) @ wo

    def _B_ref(x, k_cache, v_cache, wq, wo):
        B, Sq, D = x.shape
        H, Dh = 32, 192
        q = (lambda x, *d: x.permute(*d))((x @ wq).reshape(B, Sq, H, Dh), 0, 2, 1, 3)
        scores = torch.einsum("bhqd,bhkd->bhqk", q, k_cache) * (Dh ** -0.5)
        p = _softmax(scores, axis=-1)
        o = torch.einsum("bhqk,bhkd->bhqd", p, v_cache)
        return (lambda x, *d: x.permute(*d))(o, 0, 2, 1, 3).reshape(B, Sq, H * Dh) @ wo

    a = _A_ref(A_x, A_k_cache, A_v_cache, A_wq, A_wo)
    b = _B_ref(B_x, B_k_cache, B_v_cache, B_wq, B_wo)
    return torch.concatenate([a, b], axis=-1)
```

```asm
; @launch grid=(256,1,1) block=(512,1,1) lds=163840
.amdgcn_target "amdgcn-amd-amdhsa--gfx950"
.text
.globl concat_heads__mha_block_cached__mha_block_cached__near_ridge_kernel
.p2align 8
.type concat_heads__mha_block_cached__mha_block_cached__near_ridge_kernel,@function
concat_heads__mha_block_cached__mha_block_cached__near_ridge_kernel:
s_cmp_ge_u32 s2, 256
s_cbranch_scc1 .Lf_end
s_and_b32 s3, s2, 7
s_lshr_b32 s4, s2, 3
s_lshr_b32 s5, s3, 2
s_mul_i32 s6, s5, 40
s_add_u32 s6, s0, s6
s_addc_u32 s7, s1, 0
s_load_dwordx4 s[40:43], s[6:7], 0
s_load_dwordx4 s[44:47], s[6:7], 16
s_load_dwordx2 s[48:49], s[6:7], 32
s_load_dwordx2 s[64:65], s[0:1], 96
v_lshrrev_b32 v1, 6, v0
v_and_b32 v0, 63, v0
s_and_b32 s3, s3, 3
v_readfirstlane_b32 s50, v1
s_lshl_b32 s3, s3, 1
s_lshr_b32 s6, s4, 4
s_add_u32 s52, s3, s6
s_and_b32 s4, s4, 15
s_and_b32 s51, s50, 3
s_lshl_b32 s3, s4, 3
s_add_u32 s3, s3, s52
s_mul_i32 s53, s3, 786432
s_lshl_b32 s6, s5, 7
s_add_u32 s3, s3, s6
s_lshl_b32 s69, s3, 7
s_add_u32 s69, s69, 26214400
s_lshl_b32 s3, s3, 2
s_add_u32 s3, s3, s51
s_mul_i32 s54, s3, 25600
s_mul_i32 s55, s52, 1536
s_mul_i32 s56, s4, 102400
s_lshr_b32 s66, s4, 0
s_lshl_b32 s66, s66, 2
s_add_u32 s66, s66, s51
s_mul_i32 s66, s66, 30
s_and_b32 s67, s4, 0
s_lshl_b32 s67, s67, 0
s_sub_u32 s57, 7864320, s55
s_mul_i32 s58, s52, 983040
s_waitcnt lgkmcnt(0)
s_add_u32 s20, s40, s56
s_addc_u32 s21, s41, 0
s_mov_b32 s22, 102400
s_mov_b32 s23, 0x00020000
s_add_u32 s8, s42, s53
s_addc_u32 s9, s43, 0
s_mov_b32 s10, 786432
s_mov_b32 s11, 0x00020000
s_add_u32 s12, s44, s53
s_addc_u32 s13, s45, 0
s_mov_b32 s14, 786432
s_mov_b32 s15, 0x00020000
s_add_u32 s16, s46, s55
s_addc_u32 s17, s47, 0
s_mov_b32 s18, s57
s_mov_b32 s19, 0x00020000
s_add_u32 s24, s48, s58
s_addc_u32 s25, s49, 0
s_mov_b32 s26, 983040
s_mov_b32 s27, 0x00020000
s_add_u32 s28, s64, s54
s_addc_u32 s29, s65, 0
s_mov_b32 s30, 25600
s_mov_b32 s31, 0x00020000
s_lshl_b32 s3, s51, 3
s_and_b32 s4, s51, 1
s_lshl_b32 s5, s4, 1
v_add_u32 v10, 0, v0
v_mul_u32_u24 v11, 2731, v10
v_lshrrev_b32 v11, 16, v11
v_mul_u32_u24 v12, 24, v11
v_sub_u32 v12, v10, v12
v_lshrrev_b32 v13, 1, v11
v_and_b32 v14, 3, v13
v_lshlrev_b32 v14, 1, v14
v_xor_b32 v14, v14, v12
v_mul_u32_u24 v15, 384, v11
v_lshl_add_u32 v14, v14, 4, v15
v_subrev_u32 v1, 0, v14
v_and_b32 v13, 1, v13
v_or_b32 v13, s5, v13
v_lshlrev_b32 v13, 1, v13
v_xor_b32 v13, v13, v12
v_add_u32 v11, s3, v11
v_mul_u32_u24 v11, 12288, v11
v_lshl_add_u32 v13, v13, 4, v11
v_subrev_u32 v5, 0, v13
v_add_u32 v10, 64, v0
v_mul_u32_u24 v11, 2731, v10
v_lshrrev_b32 v11, 16, v11
v_mul_u32_u24 v12, 24, v11
v_sub_u32 v12, v10, v12
v_lshrrev_b32 v13, 1, v11
v_and_b32 v14, 3, v13
v_lshlrev_b32 v14, 1, v14
v_xor_b32 v14, v14, v12
v_mul_u32_u24 v15, 384, v11
v_lshl_add_u32 v14, v14, 4, v15
v_subrev_u32 v2, 1024, v14
v_and_b32 v13, 1, v13
v_or_b32 v13, s5, v13
v_lshlrev_b32 v13, 1, v13
v_xor_b32 v13, v13, v12
v_add_u32 v11, s3, v11
v_mul_u32_u24 v11, 12288, v11
v_lshl_add_u32 v13, v13, 4, v11
v_subrev_u32 v6, 1024, v13
v_add_u32 v10, 128, v0
v_mul_u32_u24 v11, 2731, v10
v_lshrrev_b32 v11, 16, v11
v_mul_u32_u24 v12, 24, v11
v_sub_u32 v12, v10, v12
v_lshrrev_b32 v13, 1, v11
v_and_b32 v14, 3, v13
v_lshlrev_b32 v14, 1, v14
v_xor_b32 v14, v14, v12
v_mul_u32_u24 v15, 384, v11
v_lshl_add_u32 v14, v14, 4, v15
v_subrev_u32 v3, 2048, v14
v_and_b32 v13, 1, v13
v_or_b32 v13, s5, v13
v_lshlrev_b32 v13, 1, v13
v_xor_b32 v13, v13, v12
v_add_u32 v11, s3, v11
v_mul_u32_u24 v11, 12288, v11
v_lshl_add_u32 v13, v13, 4, v11
v_subrev_u32 v7, 2048, v13
v_lshrrev_b32 v16, 4, v0
v_and_b32 v17, 15, v0
v_bfe_u32 v18, v0, 2, 2
v_and_b32 v19, 3, v0
v_lshrrev_b32 v20, 1, v18
v_and_b32 v21, 1, v16
v_lshl_or_b32 v20, v21, 1, v20
v_lshl_add_u32 v22, v16, 3, v18
s_mov_b32 s38, 0
s_cmp_ge_u32 s50, 4
s_cbranch_scc1 .LP_start
s_mul_i32 s33, s51, 12288
s_mov_b32 s34, s33
s_mov_b32 s63, 0x3dd53b95
v_lshlrev_b32 v4, 4, v0
v_add_u32 v4, 49152, v4
v_bfe_u32 v24, v17, 1, 2
v_lshlrev_b32 v24, 1, v24
v_xor_b32 v24, v24, v16
v_lshlrev_b32 v25, 4, v24
v_lshl_add_u32 v5, v17, 7, v25
v_add_u32 v5, 139264, v5
v_mul_u32_u24 v25, 384, v17
v_add_u32 v25, s33, v25
v_lshl_add_u32 v6, v24, 4, v25
v_xor_b32 v24, 4, v24
v_lshl_add_u32 v7, v24, 4, v25
v_lshrrev_b32 v24, 2, v0
v_mul_u32_u24 v25, 384, v24
v_lshl_add_u32 v25, v19, 3, v25
v_bfe_u32 v24, v24, 1, 2
v_mul_u32_u24 v26, 384, v22
v_lshl_add_u32 v26, v19, 3, v26
v_add_u32 v26, 90112, v26
v_lshrrev_b32 v27, 1, v16
v_lshl_add_u32 v27, v27, 4, v17
v_lshlrev_b32 v27, 4, v27
v_lshl_add_u32 v27, v21, 3, v27
v_lshlrev_b32 v18, 4, v17
s_mul_i32 s3, s51, 3
s_add_u32 s4, s3, 0
v_xor_b32 v28, s4, v24
v_lshl_add_u32 v8, v28, 5, v25
v_xor_b32 v28, s4, v20
v_lshl_add_u32 v11, v28, 5, v26
s_lshr_b32 s5, s4, 1
s_mul_i32 s5, s5, 5120
s_and_b32 s4, s4, 1
s_lshl_b32 s4, s4, 9
s_add_u32 s4, s4, s5
s_add_u32 s4, s4, 49152
v_add_u32 v14, s4, v27
s_add_u32 s4, s3, 1
v_xor_b32 v28, s4, v24
v_lshl_add_u32 v9, v28, 5, v25
v_xor_b32 v28, s4, v20
v_lshl_add_u32 v12, v28, 5, v26
s_lshr_b32 s5, s4, 1
s_mul_i32 s5, s5, 5120
s_and_b32 s4, s4, 1
s_lshl_b32 s4, s4, 9
s_add_u32 s4, s4, s5
s_add_u32 s4, s4, 49152
v_add_u32 v15, s4, v27
s_add_u32 s4, s3, 2
v_xor_b32 v28, s4, v24
v_lshl_add_u32 v10, v28, 5, v25
v_xor_b32 v28, s4, v20
v_lshl_add_u32 v13, v28, 5, v26
s_lshr_b32 s5, s4, 1
s_mul_i32 s5, s5, 5120
s_and_b32 s4, s4, 1
s_lshl_b32 s4, s4, 9
s_add_u32 s4, s4, s5
s_add_u32 s4, s4, 49152
v_add_u32 v16, s4, v27
v_add_u32 v18, 159744, v18
s_lshl_b32 s4, s51, 2
v_add_u32 v17, s4, v18
s_mul_i32 s4, s51, 5120
v_add_u32 v0, s4, v4
s_load_dwordx2 s[42:43], s[0:1], 88
s_cmp_lg_u32 s50, 0
s_cbranch_scc1 .Lnoflag
v_mbcnt_lo_u32_b32 v249, -1, 0
v_lshlrev_b32 v249, 2, v249
v_add_u32 v249, s69, v249
v_mov_b32 v250, 0
s_mov_b64 exec, 0xff
global_store_dword v249, v250, s[64:65] sc1
s_mov_b64 exec, -1
.Lnoflag:
s_add_u32 s60, s38, 0
s_and_b32 s60, s60, 3
s_xor_b32 s60, s60, s67
s_add_u32 s62, s38, 0
s_and_b32 s62, s62, 3
s_xor_b32 s62, s62, s67
s_mul_i32 s60, s60, 384
s_mul_i32 s62, s62, 245760
v_mbcnt_lo_u32_b32 v251, -1, 0
v_mbcnt_hi_u32_b32 v251, -1, v251
v_min_u32 v252, 29, v251
v_add_u32 v252, s66, v252
v_add_u32 v252, 0, v252
v_mul_u32_u24 v253, 21846, v252
v_lshrrev_b32 v253, 16, v253
v_lshlrev_b32 v252, 7, v252
v_mul_u32_u24 v253, 11904, v253
v_add_u32 v253, v253, v252
buffer_load_dword v254, v253, s[16:19], s60 offen
v_lshlrev_b32 v251, 7, v251
s_mul_i32 s60, s51, 25600
s_lshr_b32 s62, s2, 7
s_mul_i32 s62, s62, 12800
s_add_u32 s60, s60, s62
v_min_u32 v251, 6272, v251
buffer_load_dword v255, v251, s[20:23], s60 offen
s_add_u32 s60, s60, 6400
buffer_load_dword v255, v251, s[20:23], s60 offen
s_add_u32 s60, s60, 6400
s_setprio 1
v_xor_b32 v248, 64, v5
s_waitcnt lgkmcnt(0)
s_barrier
ds_read_b64_tr_b16 v[216:217], v11 offset:0
ds_read_b64_tr_b16 v[218:219], v11 offset:1536
ds_read_b128 v[228:231], v5 offset:0
ds_read_b128 v[232:235], v5 offset:2048
ds_read_b128 v[236:239], v5 offset:4096
ds_read_b128 v[240:243], v5 offset:6144
ds_read_b128 v[244:247], v5 offset:8192
ds_read_b64_tr_b16 v[220:221], v12 offset:0
ds_read_b64_tr_b16 v[222:223], v12 offset:1536
ds_read_b64_tr_b16 v[224:225], v13 offset:0
ds_read_b64_tr_b16 v[226:227], v13 offset:1536
s_waitcnt lgkmcnt(0)
s_barrier
v_mfma_f32_16x16x32_bf16 v[156:159], v[216:219], v[228:231], 0
ds_read_b64_tr_b16 v[24:25], v11 offset:12288
v_mfma_f32_16x16x32_bf16 v[160:163], v[216:219], v[232:235], 0
ds_read_b64_tr_b16 v[26:27], v11 offset:13824
v_mfma_f32_16x16x32_bf16 v[164:167], v[216:219], v[236:239], 0
ds_read_b128 v[36:39], v248 offset:0
v_mfma_f32_16x16x32_bf16 v[168:171], v[216:219], v[240:243], 0
ds_read_b128 v[40:43], v248 offset:2048
v_mfma_f32_16x16x32_bf16 v[172:175], v[216:219], v[244:247], 0
ds_read_b128 v[44:47], v248 offset:4096
v_mfma_f32_16x16x32_bf16 v[176:179], v[220:223], v[228:231], 0
ds_read_b128 v[48:51], v248 offset:6144
v_mfma_f32_16x16x32_bf16 v[180:183], v[220:223], v[232:235], 0
ds_read_b128 v[52:55], v248 offset:8192
v_mfma_f32_16x16x32_bf16 v[184:187], v[220:223], v[236:239], 0
ds_read_b64_tr_b16 v[28:29], v12 offset:12288
v_mfma_f32_16x16x32_bf16 v[188:191], v[220:223], v[240:243], 0
ds_read_b64_tr_b16 v[30:31], v12 offset:13824
v_mfma_f32_16x16x32_bf16 v[192:195], v[220:223], v[244:247], 0
ds_read_b64_tr_b16 v[32:33], v13 offset:12288
v_mfma_f32_16x16x32_bf16 v[196:199], v[224:227], v[228:231], 0
ds_read_b64_tr_b16 v[34:35], v13 offset:13824
v_mfma_f32_16x16x32_bf16 v[200:203], v[224:227], v[232:235], 0
v_mfma_f32_16x16x32_bf16 v[204:207], v[224:227], v[236:239], 0
v_mfma_f32_16x16x32_bf16 v[208:211], v[224:227], v[240:243], 0
v_mfma_f32_16x16x32_bf16 v[212:215], v[224:227], v[244:247], 0
s_waitcnt lgkmcnt(0)
s_barrier
v_mfma_f32_16x16x32_bf16 v[156:159], v[24:27], v[36:39], v[156:159]
ds_read_b64_tr_b16 v[216:217], v11 offset:24576
v_mfma_f32_16x16x32_bf16 v[160:163], v[24:27], v[40:43], v[160:163]
ds_read_b64_tr_b16 v[218:219], v11 offset:26112
v_mfma_f32_16x16x32_bf16 v[164:167], v[24:27], v[44:47], v[164:167]
ds_read_b128 v[228:231], v5 offset:10240
v_mfma_f32_16x16x32_bf16 v[168:171], v[24:27], v[48:51], v[168:171]
ds_read_b128 v[232:235], v5 offset:12288
v_mfma_f32_16x16x32_bf16 v[172:175], v[24:27], v[52:55], v[172:175]
ds_read_b128 v[236:239], v5 offset:14336
v_mfma_f32_16x16x32_bf16 v[176:179], v[28:31], v[36:39], v[176:179]
ds_read_b128 v[240:243], v5 offset:16384
v_mfma_f32_16x16x32_bf16 v[180:183], v[28:31], v[40:43], v[180:183]
ds_read_b128 v[244:247], v5 offset:18432
v_mfma_f32_16x16x32_bf16 v[184:187], v[28:31], v[44:47], v[184:187]
ds_read_b64_tr_b16 v[220:221], v12 offset:24576
v_mfma_f32_16x16x32_bf16 v[188:191], v[28:31], v[48:51], v[188:191]
ds_read_b64_tr_b16 v[222:223], v12 offset:26112
v_mfma_f32_16x16x32_bf16 v[192:195], v[28:31], v[52:55], v[192:195]
ds_read_b64_tr_b16 v[224:225], v13 offset:24576
v_mfma_f32_16x16x32_bf16 v[196:199], v[32:35], v[36:39], v[196:199]
ds_read_b64_tr_b16 v[226:227], v13 offset:26112
v_mfma_f32_16x16x32_bf16 v[200:203], v[32:35], v[40:43], v[200:203]
v_mfma_f32_16x16x32_bf16 v[204:207], v[32:35], v[44:47], v[204:207]
v_mfma_f32_16x16x32_bf16 v[208:211], v[32:35], v[48:51], v[208:211]
v_mfma_f32_16x16x32_bf16 v[212:215], v[32:35], v[52:55], v[212:215]
s_waitcnt lgkmcnt(0)
s_barrier
v_mfma_f32_16x16x32_bf16 v[156:159], v[216:219], v[228:231], v[156:159]
ds_read_b64_tr_b16 v[24:25], v11 offset:36864
v_mfma_f32_16x16x32_bf16 v[160:163], v[216:219], v[232:235], v[160:163]
ds_read_b64_tr_b16 v[26:27], v11 offset:38400
v_mfma_f32_16x16x32_bf16 v[164:167], v[216:219], v[236:239], v[164:167]
ds_read_b128 v[36:39], v248 offset:10240
v_mfma_f32_16x16x32_bf16 v[168:171], v[216:219], v[240:243], v[168:171]
ds_read_b128 v[40:43], v248 offset:12288
v_mfma_f32_16x16x32_bf16 v[172:175], v[216:219], v[244:247], v[172:175]
ds_read_b128 v[44:47], v248 offset:14336
v_mfma_f32_16x16x32_bf16 v[176:179], v[220:223], v[228:231], v[176:179]
ds_read_b128 v[48:51], v248 offset:16384
v_mfma_f32_16x16x32_bf16 v[180:183], v[220:223], v[232:235], v[180:183]
ds_read_b128 v[52:55], v248 offset:18432
v_mfma_f32_16x16x32_bf16 v[184:187], v[220:223], v[236:239], v[184:187]
ds_read_b64_tr_b16 v[28:29], v12 offset:36864
v_mfma_f32_16x16x32_bf16 v[188:191], v[220:223], v[240:243], v[188:191]
ds_read_b64_tr_b16 v[30:31], v12 offset:38400
v_mfma_f32_16x16x32_bf16 v[192:195], v[220:223], v[244:247], v[192:195]
ds_read_b64_tr_b16 v[32:33], v13 offset:36864
v_mfma_f32_16x16x32_bf16 v[196:199], v[224:227], v[228:231], v[196:199]
ds_read_b64_tr_b16 v[34:35], v13 offset:38400
v_mfma_f32_16x16x32_bf16 v[200:203], v[224:227], v[232:235], v[200:203]
v_mfma_f32_16x16x32_bf16 v[204:207], v[224:227], v[236:239], v[204:207]
v_mfma_f32_16x16x32_bf16 v[208:211], v[224:227], v[240:243], v[208:211]
v_mfma_f32_16x16x32_bf16 v[212:215], v[224:227], v[244:247], v[212:215]
s_waitcnt lgkmcnt(0)
s_barrier
v_mfma_f32_16x16x32_bf16 v[156:159], v[24:27], v[36:39], v[156:159]
ds_read_b64_tr_b16 v[216:217], v11 offset:0
v_mfma_f32_16x16x32_bf16 v[160:163], v[24:27], v[40:43], v[160:163]
ds_read_b64_tr_b16 v[218:219], v11 offset:1536
v_mfma_f32_16x16x32_bf16 v[164:167], v[24:27], v[44:47], v[164:167]
ds_read_b128 v[228:231], v5 offset:0
v_mfma_f32_16x16x32_bf16 v[168:171], v[24:27], v[48:51], v[168:171]
ds_read_b128 v[232:235], v5 offset:2048
v_mfma_f32_16x16x32_bf16 v[172:175], v[24:27], v[52:55], v[172:175]
ds_read_b128 v[236:239], v5 offset:4096
v_mfma_f32_16x16x32_bf16 v[176:179], v[28:31], v[36:39], v[176:179]
ds_read_b128 v[240:243], v5 offset:6144
v_mfma_f32_16x16x32_bf16 v[180:183], v[28:31], v[40:43], v[180:183]
ds_read_b128 v[244:247], v5 offset:8192
v_mfma_f32_16x16x32_bf16 v[184:187], v[28:31], v[44:47], v[184:187]
ds_read_b64_tr_b16 v[220:221], v12 offset:0
v_mfma_f32_16x16x32_bf16 v[188:191], v[28:31], v[48:51], v[188:191]
ds_read_b64_tr_b16 v[222:223], v12 offset:1536
v_mfma_f32_16x16x32_bf16 v[192:195], v[28:31], v[52:55], v[192:195]
ds_read_b64_tr_b16 v[224:225], v13 offset:0
v_mfma_f32_16x16x32_bf16 v[196:199], v[32:35], v[36:39], v[196:199]
ds_read_b64_tr_b16 v[226:227], v13 offset:1536
v_mfma_f32_16x16x32_bf16 v[200:203], v[32:35], v[40:43], v[200:203]
v_mfma_f32_16x16x32_bf16 v[204:207], v[32:35], v[44:47], v[204:207]
v_mfma_f32_16x16x32_bf16 v[208:211], v[32:35], v[48:51], v[208:211]
v_mfma_f32_16x16x32_bf16 v[212:215], v[32:35], v[52:55], v[212:215]
s_waitcnt lgkmcnt(0)
s_barrier
v_mfma_f32_16x16x32_bf16 v[156:159], v[216:219], v[228:231], v[156:159]
ds_read_b64_tr_b16 v[24:25], v11 offset:12288
v_mfma_f32_16x16x32_bf16 v[160:163], v[216:219], v[232:235], v[160:163]
ds_read_b64_tr_b16 v[26:27], v11 offset:13824
v_mfma_f32_16x16x32_bf16 v[164:167], v[216:219], v[236:239], v[164:167]
ds_read_b128 v[36:39], v248 offset:0
v_mfma_f32_16x16x32_bf16 v[168:171], v[216:219], v[240:243], v[168:171]
ds_read_b128 v[40:43], v248 offset:2048
v_mfma_f32_16x16x32_bf16 v[172:175], v[216:219], v[244:247], v[172:175]
ds_read_b128 v[44:47], v248 offset:4096
v_mfma_f32_16x16x32_bf16 v[176:179], v[220:223], v[228:231], v[176:179]
ds_read_b128 v[48:51], v248 offset:6144
v_mfma_f32_16x16x32_bf16 v[180:183], v[220:223], v[232:235], v[180:183]
ds_read_b128 v[52:55], v248 offset:8192
v_mfma_f32_16x16x32_bf16 v[184:187], v[220:223], v[236:239], v[184:187]
ds_read_b64_tr_b16 v[28:29], v12 offset:12288
v_mfma_f32_16x16x32_bf16 v[188:191], v[220:223], v[240:243], v[188:191]
ds_read_b64_tr_b16 v[30:31], v12 offset:13824
v_mfma_f32_16x16x32_bf16 v[192:195], v[220:223], v[244:247], v[192:195]
ds_read_b64_tr_b16 v[32:33], v13 offset:12288
v_mfma_f32_16x16x32_bf16 v[196:199], v[224:227], v[228:231], v[196:199]
ds_read_b64_tr_b16 v[34:35], v13 offset:13824
v_mfma_f32_16x16x32_bf16 v[200:203], v[224:227], v[232:235], v[200:203]
v_mfma_f32_16x16x32_bf16 v[204:207], v[224:227], v[236:239], v[204:207]
v_mfma_f32_16x16x32_bf16 v[208:211], v[224:227], v[240:243], v[208:211]
v_mfma_f32_16x16x32_bf16 v[212:215], v[224:227], v[244:247], v[212:215]
s_waitcnt lgkmcnt(0)
s_barrier
v_mfma_f32_16x16x32_bf16 v[156:159], v[24:27], v[36:39], v[156:159]
ds_read_b64_tr_b16 v[216:217], v11 offset:24576
v_mfma_f32_16x16x32_bf16 v[160:163], v[24:27], v[40:43], v[160:163]
ds_read_b64_tr_b16 v[218:219], v11 offset:26112
v_mfma_f32_16x16x32_bf16 v[164:167], v[24:27], v[44:47], v[164:167]
ds_read_b128 v[228:231], v5 offset:10240
v_mfma_f32_16x16x32_bf16 v[168:171], v[24:27], v[48:51], v[168:171]
ds_read_b128 v[232:235], v5 offset:12288
v_mfma_f32_16x16x32_bf16 v[172:175], v[24:27], v[52:55], v[172:175]
ds_read_b128 v[236:239], v5 offset:14336
v_mfma_f32_16x16x32_bf16 v[176:179], v[28:31], v[36:39], v[176:179]
ds_read_b128 v[240:243], v5 offset:16384
v_mfma_f32_16x16x32_bf16 v[180:183], v[28:31], v[40:43], v[180:183]
ds_read_b128 v[244:247], v5 offset:18432
v_mfma_f32_16x16x32_bf16 v[184:187], v[28:31], v[44:47], v[184:187]
ds_read_b64_tr_b16 v[220:221], v12 offset:24576
v_mfma_f32_16x16x32_bf16 v[188:191], v[28:31], v[48:51], v[188:191]
ds_read_b64_tr_b16 v[222:223], v12 offset:26112
v_mfma_f32_16x16x32_bf16 v[192:195], v[28:31], v[52:55], v[192:195]
ds_read_b64_tr_b16 v[224:225], v13 offset:24576
v_mfma_f32_16x16x32_bf16 v[196:199], v[32:35], v[36:39], v[196:199]
ds_read_b64_tr_b16 v[226:227], v13 offset:26112
v_mfma_f32_16x16x32_bf16 v[200:203], v[32:35], v[40:43], v[200:203]
v_mfma_f32_16x16x32_bf16 v[204:207], v[32:35], v[44:47], v[204:207]
v_mfma_f32_16x16x32_bf16 v[208:211], v[32:35], v[48:51], v[208:211]
v_mfma_f32_16x16x32_bf16 v[212:215], v[32:35], v[52:55], v[212:215]
s_waitcnt lgkmcnt(0)
s_barrier
v_mfma_f32_16x16x32_bf16 v[156:159], v[216:219], v[228:231], v[156:159]
ds_read_b64_tr_b16 v[24:25], v11 offset:36864
v_mfma_f32_16x16x32_bf16 v[160:163], v[216:219], v[232:235], v[160:163]
ds_read_b64_tr_b16 v[26:27], v11 offset:38400
v_mfma_f32_16x16x32_bf16 v[164:167], v[216:219], v[236:239], v[164:167]
ds_read_b128 v[36:39], v248 offset:10240
v_mfma_f32_16x16x32_bf16 v[168:171], v[216:219], v[240:243], v[168:171]
ds_read_b128 v[40:43], v248 offset:12288
v_mfma_f32_16x16x32_bf16 v[172:175], v[216:219], v[244:247], v[172:175]
ds_read_b128 v[44:47], v248 offset:14336
v_mfma_f32_16x16x32_bf16 v[176:179], v[220:223], v[228:231], v[176:179]
ds_read_b128 v[48:51], v248 offset:16384
v_mfma_f32_16x16x32_bf16 v[180:183], v[220:223], v[232:235], v[180:183]
ds_read_b128 v[52:55], v248 offset:18432
v_mfma_f32_16x16x32_bf16 v[184:187], v[220:223], v[236:239], v[184:187]
ds_read_b64_tr_b16 v[28:29], v12 offset:36864
v_mfma_f32_16x16x32_bf16 v[188:191], v[220:223], v[240:243], v[188:191]
ds_read_b64_tr_b16 v[30:31], v12 offset:38400
v_mfma_f32_16x16x32_bf16 v[192:195], v[220:223], v[244:247], v[192:195]
ds_read_b64_tr_b16 v[32:33], v13 offset:36864
v_mfma_f32_16x16x32_bf16 v[196:199], v[224:227], v[228:231], v[196:199]
ds_read_b64_tr_b16 v[34:35], v13 offset:38400
v_mfma_f32_16x16x32_bf16 v[200:203], v[224:227], v[232:235], v[200:203]
v_mfma_f32_16x16x32_bf16 v[204:207], v[224:227], v[236:239], v[204:207]
v_mfma_f32_16x16x32_bf16 v[208:211], v[224:227], v[240:243], v[208:211]
v_mfma_f32_16x16x32_bf16 v[212:215], v[224:227], v[244:247], v[212:215]
s_waitcnt lgkmcnt(0)
s_barrier
v_mfma_f32_16x16x32_bf16 v[156:159], v[24:27], v[36:39], v[156:159]
ds_read_b64_tr_b16 v[216:217], v11 offset:0
v_mfma_f32_16x16x32_bf16 v[160:163], v[24:27], v[40:43], v[160:163]
ds_read_b64_tr_b16 v[218:219], v11 offset:1536
v_mfma_f32_16x16x32_bf16 v[164:167], v[24:27], v[44:47], v[164:167]
ds_read_b128 v[228:231], v5 offset:0
v_mfma_f32_16x16x32_bf16 v[168:171], v[24:27], v[48:51], v[168:171]
ds_read_b128 v[232:235], v5 offset:2048
v_mfma_f32_16x16x32_bf16 v[172:175], v[24:27], v[52:55], v[172:175]
ds_read_b128 v[236:239], v5 offset:4096
v_mfma_f32_16x16x32_bf16 v[176:179], v[28:31], v[36:39], v[176:179]
ds_read_b128 v[240:243], v5 offset:6144
v_mfma_f32_16x16x32_bf16 v[180:183], v[28:31], v[40:43], v[180:183]
ds_read_b128 v[244:247], v5 offset:8192
v_mfma_f32_16x16x32_bf16 v[184:187], v[28:31], v[44:47], v[184:187]
ds_read_b64_tr_b16 v[220:221], v12 offset:0
v_mfma_f32_16x16x32_bf16 v[188:191], v[28:31], v[48:51], v[188:191]
ds_read_b64_tr_b16 v[222:223], v12 offset:1536
v_mfma_f32_16x16x32_bf16 v[192:195], v[28:31], v[52:55], v[192:195]
ds_read_b64_tr_b16 v[224:225], v13 offset:0
v_mfma_f32_16x16x32_bf16 v[196:199], v[32:35], v[36:39], v[196:199]
ds_read_b64_tr_b16 v[226:227], v13 offset:1536
v_mfma_f32_16x16x32_bf16 v[200:203], v[32:35], v[40:43], v[200:203]
v_mfma_f32_16x16x32_bf16 v[204:207], v[32:35], v[44:47], v[204:207]
v_mfma_f32_16x16x32_bf16 v[208:211], v[32:35], v[48:51], v[208:211]
v_mfma_f32_16x16x32_bf16 v[212:215], v[32:35], v[52:55], v[212:215]
s_waitcnt lgkmcnt(0)
s_barrier
v_mfma_f32_16x16x32_bf16 v[156:159], v[216:219], v[228:231], v[156:159]
ds_read_b64_tr_b16 v[24:25], v11 offset:12288
v_mfma_f32_16x16x32_bf16 v[160:163], v[216:219], v[232:235], v[160:163]
ds_read_b64_tr_b16 v[26:27], v11 offset:13824
v_mfma_f32_16x16x32_bf16 v[164:167], v[216:219], v[236:239], v[164:167]
ds_read_b128 v[36:39], v248 offset:0
v_mfma_f32_16x16x32_bf16 v[168:171], v[216:219], v[240:243], v[168:171]
ds_read_b128 v[40:43], v248 offset:2048
v_mfma_f32_16x16x32_bf16 v[172:175], v[216:219], v[244:247], v[172:175]
ds_read_b128 v[44:47], v248 offset:4096
v_mfma_f32_16x16x32_bf16 v[176:179], v[220:223], v[228:231], v[176:179]
ds_read_b128 v[48:51], v248 offset:6144
v_mfma_f32_16x16x32_bf16 v[180:183], v[220:223], v[232:235], v[180:183]
ds_read_b128 v[52:55], v248 offset:8192
v_mfma_f32_16x16x32_bf16 v[184:187], v[220:223], v[236:239], v[184:187]
ds_read_b64_tr_b16 v[28:29], v12 offset:12288
v_mfma_f32_16x16x32_bf16 v[188:191], v[220:223], v[240:243], v[188:191]
ds_read_b64_tr_b16 v[30:31], v12 offset:13824
v_mfma_f32_16x16x32_bf16 v[192:195], v[220:223], v[244:247], v[192:195]
ds_read_b64_tr_b16 v[32:33], v13 offset:12288
v_mfma_f32_16x16x32_bf16 v[196:199], v[224:227], v[228:231], v[196:199]
ds_read_b64_tr_b16 v[34:35], v13 offset:13824
v_mfma_f32_16x16x32_bf16 v[200:203], v[224:227], v[232:235], v[200:203]
v_mfma_f32_16x16x32_bf16 v[204:207], v[224:227], v[236:239], v[204:207]
v_mfma_f32_16x16x32_bf16 v[208:211], v[224:227], v[240:243], v[208:211]
v_mfma_f32_16x16x32_bf16 v[212:215], v[224:227], v[244:247], v[212:215]
s_waitcnt lgkmcnt(0)
s_barrier
v_mfma_f32_16x16x32_bf16 v[156:159], v[24:27], v[36:39], v[156:159]
ds_read_b64_tr_b16 v[216:217], v11 offset:24576
v_mfma_f32_16x16x32_bf16 v[160:163], v[24:27], v[40:43], v[160:163]
ds_read_b64_tr_b16 v[218:219], v11 offset:26112
v_mfma_f32_16x16x32_bf16 v[164:167], v[24:27], v[44:47], v[164:167]
ds_read_b128 v[228:231], v5 offset:10240
v_mfma_f32_16x16x32_bf16 v[168:171], v[24:27], v[48:51], v[168:171]
ds_read_b128 v[232:235], v5 offset:12288
v_mfma_f32_16x16x32_bf16 v[172:175], v[24:27], v[52:55], v[172:175]
ds_read_b128 v[236:239], v5 offset:14336
v_mfma_f32_16x16x32_bf16 v[176:179], v[28:31], v[36:39], v[176:179]
ds_read_b128 v[240:243], v5 offset:16384
v_mfma_f32_16x16x32_bf16 v[180:183], v[28:31], v[40:43], v[180:183]
ds_read_b128 v[244:247], v5 offset:18432
v_mfma_f32_16x16x32_bf16 v[184:187], v[28:31], v[44:47], v[184:187]
ds_read_b64_tr_b16 v[220:221], v12 offset:24576
v_mfma_f32_16x16x32_bf16 v[188:191], v[28:31], v[48:51], v[188:191]
ds_read_b64_tr_b16 v[222:223], v12 offset:26112
v_mfma_f32_16x16x32_bf16 v[192:195], v[28:31], v[52:55], v[192:195]
ds_read_b64_tr_b16 v[224:225], v13 offset:24576
v_mfma_f32_16x16x32_bf16 v[196:199], v[32:35], v[36:39], v[196:199]
ds_read_b64_tr_b16 v[226:227], v13 offset:26112
v_mfma_f32_16x16x32_bf16 v[200:203], v[32:35], v[40:43], v[200:203]
v_mfma_f32_16x16x32_bf16 v[204:207], v[32:35], v[44:47], v[204:207]
v_mfma_f32_16x16x32_bf16 v[208:211], v[32:35], v[48:51], v[208:211]
v_mfma_f32_16x16x32_bf16 v[212:215], v[32:35], v[52:55], v[212:215]
s_waitcnt lgkmcnt(0)
s_barrier
v_mfma_f32_16x16x32_bf16 v[156:159], v[216:219], v[228:231], v[156:159]
ds_read_b64_tr_b16 v[24:25], v11 offset:36864
v_mfma_f32_16x16x32_bf16 v[160:163], v[216:219], v[232:235], v[160:163]
ds_read_b64_tr_b16 v[26:27], v11 offset:38400
v_mfma_f32_16x16x32_bf16 v[164:167], v[216:219], v[236:239], v[164:167]
ds_read_b128 v[36:39], v248 offset:10240
v_mfma_f32_16x16x32_bf16 v[168:171], v[216:219], v[240:243], v[168:171]
ds_read_b128 v[40:43], v248 offset:12288
v_mfma_f32_16x16x32_bf16 v[172:175], v[216:219], v[244:247], v[172:175]
ds_read_b128 v[44:47], v248 offset:14336
v_mfma_f32_16x16x32_bf16 v[176:179], v[220:223], v[228:231], v[176:179]
ds_read_b128 v[48:51], v248 offset:16384
v_mfma_f32_16x16x32_bf16 v[180:183], v[220:223], v[232:235], v[180:183]
ds_read_b128 v[52:55], v248 offset:18432
v_mfma_f32_16x16x32_bf16 v[184:187], v[220:223], v[236:239], v[184:187]
ds_read_b64_tr_b16 v[28:29], v12 offset:36864
v_mfma_f32_16x16x32_bf16 v[188:191], v[220:223], v[240:243], v[188:191]
ds_read_b64_tr_b16 v[30:31], v12 offset:38400
v_mfma_f32_16x16x32_bf16 v[192:195], v[220:223], v[244:247], v[192:195]
ds_read_b64_tr_b16 v[32:33], v13 offset:36864
v_mfma_f32_16x16x32_bf16 v[196:199], v[224:227], v[228:231], v[196:199]
ds_read_b64_tr_b16 v[34:35], v13 offset:38400
v_mfma_f32_16x16x32_bf16 v[200:203], v[224:227], v[232:235], v[200:203]
v_mfma_f32_16x16x32_bf16 v[204:207], v[224:227], v[236:239], v[204:207]
v_mfma_f32_16x16x32_bf16 v[208:211], v[224:227], v[240:243], v[208:211]
v_mfma_f32_16x16x32_bf16 v[212:215], v[224:227], v[244:247], v[212:215]
s_waitcnt lgkmcnt(0)
s_barrier
v_mfma_f32_16x16x32_bf16 v[156:159], v[24:27], v[36:39], v[156:159]
ds_read_b64_tr_b16 v[216:217], v11 offset:0
v_mfma_f32_16x16x32_bf16 v[160:163], v[24:27], v[40:43], v[160:163]
ds_read_b64_tr_b16 v[218:219], v11 offset:1536
v_mfma_f32_16x16x32_bf16 v[164:167], v[24:27], v[44:47], v[164:167]
ds_read_b128 v[228:231], v5 offset:0
v_mfma_f32_16x16x32_bf16 v[168:171], v[24:27], v[48:51], v[168:171]
ds_read_b128 v[232:235], v5 offset:2048
v_mfma_f32_16x16x32_bf16 v[172:175], v[24:27], v[52:55], v[172:175]
ds_read_b128 v[236:239], v5 offset:4096
v_mfma_f32_16x16x32_bf16 v[176:179], v[28:31], v[36:39], v[176:179]
ds_read_b128 v[240:243], v5 offset:6144
v_mfma_f32_16x16x32_bf16 v[180:183], v[28:31], v[40:43], v[180:183]
ds_read_b128 v[244:247], v5 offset:8192
v_mfma_f32_16x16x32_bf16 v[184:187], v[28:31], v[44:47], v[184:187]
ds_read_b64_tr_b16 v[220:221], v12 offset:0
v_mfma_f32_16x16x32_bf16 v[188:191], v[28:31], v[48:51], v[188:191]
ds_read_b64_tr_b16 v[222:223], v12 offset:1536
v_mfma_f32_16x16x32_bf16 v[192:195], v[28:31], v[52:55], v[192:195]
ds_read_b64_tr_b16 v[224:225], v13 offset:0
v_mfma_f32_16x16x32_bf16 v[196:199], v[32:35], v[36:39], v[196:199]
ds_read_b64_tr_b16 v[226:227], v13 offset:1536
v_mfma_f32_16x16x32_bf16 v[200:203], v[32:35], v[40:43], v[200:203]
v_mfma_f32_16x16x32_bf16 v[204:207], v[32:35], v[44:47], v[204:207]
v_mfma_f32_16x16x32_bf16 v[208:211], v[32:35], v[48:51], v[208:211]
v_mfma_f32_16x16x32_bf16 v[212:215], v[32:35], v[52:55], v[212:215]
s_waitcnt lgkmcnt(0)
s_barrier
v_mfma_f32_16x16x32_bf16 v[156:159], v[216:219], v[228:231], v[156:159]
ds_read_b64_tr_b16 v[24:25], v11 offset:12288
v_mfma_f32_16x16x32_bf16 v[160:163], v[216:219], v[232:235], v[160:163]
ds_read_b64_tr_b16 v[26:27], v11 offset:13824
v_mfma_f32_16x16x32_bf16 v[164:167], v[216:219], v[236:239], v[164:167]
ds_read_b128 v[36:39], v248 offset:0
v_mfma_f32_16x16x32_bf16 v[168:171], v[216:219], v[240:243], v[168:171]
ds_read_b128 v[40:43], v248 offset:2048
v_mfma_f32_16x16x32_bf16 v[172:175], v[216:219], v[244:247], v[172:175]
ds_read_b128 v[44:47], v248 offset:4096
v_mfma_f32_16x16x32_bf16 v[176:179], v[220:223], v[228:231], v[176:179]
ds_read_b128 v[48:51], v248 offset:6144
v_mfma_f32_16x16x32_bf16 v[180:183], v[220:223], v[232:235], v[180:183]
ds_read_b128 v[52:55], v248 offset:8192
v_mfma_f32_16x16x32_bf16 v[184:187], v[220:223], v[236:239], v[184:187]
ds_read_b64_tr_b16 v[28:29], v12 offset:12288
v_mfma_f32_16x16x32_bf16 v[188:191], v[220:223], v[240:243], v[188:191]
ds_read_b64_tr_b16 v[30:31], v12 offset:13824
v_mfma_f32_16x16x32_bf16 v[192:195], v[220:223], v[244:247], v[192:195]
ds_read_b64_tr_b16 v[32:33], v13 offset:12288
v_mfma_f32_16x16x32_bf16 v[196:199], v[224:227], v[228:231], v[196:199]
ds_read_b64_tr_b16 v[34:35], v13 offset:13824
v_mfma_f32_16x16x32_bf16 v[200:203], v[224:227], v[232:235], v[200:203]
v_mfma_f32_16x16x32_bf16 v[204:207], v[224:227], v[236:239], v[204:207]
v_mfma_f32_16x16x32_bf16 v[208:211], v[224:227], v[240:243], v[208:211]
v_mfma_f32_16x16x32_bf16 v[212:215], v[224:227], v[244:247], v[212:215]
s_waitcnt lgkmcnt(0)
s_barrier
v_mfma_f32_16x16x32_bf16 v[156:159], v[24:27], v[36:39], v[156:159]
ds_read_b64_tr_b16 v[216:217], v11 offset:24576
v_mfma_f32_16x16x32_bf16 v[160:163], v[24:27], v[40:43], v[160:163]
ds_read_b64_tr_b16 v[218:219], v11 offset:26112
v_mfma_f32_16x16x32_bf16 v[164:167], v[24:27], v[44:47], v[164:167]
ds_read_b128 v[228:231], v5 offset:10240
v_mfma_f32_16x16x32_bf16 v[168:171], v[24:27], v[48:51], v[168:171]
ds_read_b128 v[232:235], v5 offset:12288
v_mfma_f32_16x16x32_bf16 v[172:175], v[24:27], v[52:55], v[172:175]
ds_read_b128 v[236:239], v5 offset:14336
v_mfma_f32_16x16x32_bf16 v[176:179], v[28:31], v[36:39], v[176:179]
ds_read_b128 v[240:243], v5 offset:16384
v_mfma_f32_16x16x32_bf16 v[180:183], v[28:31], v[40:43], v[180:183]
ds_read_b128 v[244:247], v5 offset:18432
v_mfma_f32_16x16x32_bf16 v[184:187], v[28:31], v[44:47], v[184:187]
ds_read_b64_tr_b16 v[220:221], v12 offset:24576
v_mfma_f32_16x16x32_bf16 v[188:191], v[28:31], v[48:51], v[188:191]
ds_read_b64_tr_b16 v[222:223], v12 offset:26112
v_mfma_f32_16x16x32_bf16 v[192:195], v[28:31], v[52:55], v[192:195]
ds_read_b64_tr_b16 v[224:225], v13 offset:24576
v_mfma_f32_16x16x32_bf16 v[196:199], v[32:35], v[36:39], v[196:199]
ds_read_b64_tr_b16 v[226:227], v13 offset:26112
v_mfma_f32_16x16x32_bf16 v[200:203], v[32:35], v[40:43], v[200:203]
v_mfma_f32_16x16x32_bf16 v[204:207], v[32:35], v[44:47], v[204:207]
v_mfma_f32_16x16x32_bf16 v[208:211], v[32:35], v[48:51], v[208:211]
v_mfma_f32_16x16x32_bf16 v[212:215], v[32:35], v[52:55], v[212:215]
s_waitcnt lgkmcnt(0)
s_barrier
v_mfma_f32_16x16x32_bf16 v[156:159], v[216:219], v[228:231], v[156:159]
ds_read_b64_tr_b16 v[24:25], v11 offset:36864
v_mfma_f32_16x16x32_bf16 v[160:163], v[216:219], v[232:235], v[160:163]
ds_read_b64_tr_b16 v[26:27], v11 offset:38400
v_mfma_f32_16x16x32_bf16 v[164:167], v[216:219], v[236:239], v[164:167]
ds_read_b128 v[36:39], v248 offset:10240
v_mfma_f32_16x16x32_bf16 v[168:171], v[216:219], v[240:243], v[168:171]
ds_read_b128 v[40:43], v248 offset:12288
v_mfma_f32_16x16x32_bf16 v[172:175], v[216:219], v[244:247], v[172:175]
ds_read_b128 v[44:47], v248 offset:14336
v_mfma_f32_16x16x32_bf16 v[176:179], v[220:223], v[228:231], v[176:179]
ds_read_b128 v[48:51], v248 offset:16384
v_mfma_f32_16x16x32_bf16 v[180:183], v[220:223], v[232:235], v[180:183]
ds_read_b128 v[52:55], v248 offset:18432
v_mfma_f32_16x16x32_bf16 v[184:187], v[220:223], v[236:239], v[184:187]
ds_read_b64_tr_b16 v[28:29], v12 offset:36864
v_mfma_f32_16x16x32_bf16 v[188:191], v[220:223], v[240:243], v[188:191]
ds_read_b64_tr_b16 v[30:31], v12 offset:38400
v_mfma_f32_16x16x32_bf16 v[192:195], v[220:223], v[244:247], v[192:195]
ds_read_b64_tr_b16 v[32:33], v13 offset:36864
v_mfma_f32_16x16x32_bf16 v[196:199], v[224:227], v[228:231], v[196:199]
ds_read_b64_tr_b16 v[34:35], v13 offset:38400
v_mfma_f32_16x16x32_bf16 v[200:203], v[224:227], v[232:235], v[200:203]
v_mfma_f32_16x16x32_bf16 v[204:207], v[224:227], v[236:239], v[204:207]
v_mfma_f32_16x16x32_bf16 v[208:211], v[224:227], v[240:243], v[208:211]
v_mfma_f32_16x16x32_bf16 v[212:215], v[224:227], v[244:247], v[212:215]
s_waitcnt lgkmcnt(0)
s_barrier
v_mfma_f32_16x16x32_bf16 v[156:159], v[24:27], v[36:39], v[156:159]
ds_read_b64_tr_b16 v[216:217], v11 offset:0
v_mfma_f32_16x16x32_bf16 v[160:163], v[24:27], v[40:43], v[160:163]
ds_read_b64_tr_b16 v[218:219], v11 offset:1536
v_mfma_f32_16x16x32_bf16 v[164:167], v[24:27], v[44:47], v[164:167]
ds_read_b128 v[228:231], v5 offset:0
v_mfma_f32_16x16x32_bf16 v[168:171], v[24:27], v[48:51], v[168:171]
ds_read_b128 v[232:235], v5 offset:2048
v_mfma_f32_16x16x32_bf16 v[172:175], v[24:27], v[52:55], v[172:175]
ds_read_b128 v[236:239], v5 offset:4096
v_mfma_f32_16x16x32_bf16 v[176:179], v[28:31], v[36:39], v[176:179]
ds_read_b128 v[240:243], v5 offset:6144
v_mfma_f32_16x16x32_bf16 v[180:183], v[28:31], v[40:43], v[180:183]
ds_read_b128 v[244:247], v5 offset:8192
v_mfma_f32_16x16x32_bf16 v[184:187], v[28:31], v[44:47], v[184:187]
ds_read_b64_tr_b16 v[220:221], v12 offset:0
v_mfma_f32_16x16x32_bf16 v[188:191], v[28:31], v[48:51], v[188:191]
ds_read_b64_tr_b16 v[222:223], v12 offset:1536
v_mfma_f32_16x16x32_bf16 v[192:195], v[28:31], v[52:55], v[192:195]
ds_read_b64_tr_b16 v[224:225], v13 offset:0
v_mfma_f32_16x16x32_bf16 v[196:199], v[32:35], v[36:39], v[196:199]
ds_read_b64_tr_b16 v[226:227], v13 offset:1536
v_mfma_f32_16x16x32_bf16 v[200:203], v[32:35], v[40:43], v[200:203]
v_mfma_f32_16x16x32_bf16 v[204:207], v[32:35], v[44:47], v[204:207]
v_mfma_f32_16x16x32_bf16 v[208:211], v[32:35], v[48:51], v[208:211]
v_mfma_f32_16x16x32_bf16 v[212:215], v[32:35], v[52:55], v[212:215]
s_waitcnt lgkmcnt(0)
s_barrier
v_mfma_f32_16x16x32_bf16 v[156:159], v[216:219], v[228:231], v[156:159]
ds_read_b64_tr_b16 v[24:25], v11 offset:12288
v_mfma_f32_16x16x32_bf16 v[160:163], v[216:219], v[232:235], v[160:163]
ds_read_b64_tr_b16 v[26:27], v11 offset:13824
v_mfma_f32_16x16x32_bf16 v[164:167], v[216:219], v[236:239], v[164:167]
ds_read_b128 v[36:39], v248 offset:0
v_mfma_f32_16x16x32_bf16 v[168:171], v[216:219], v[240:243], v[168:171]
ds_read_b128 v[40:43], v248 offset:2048
v_mfma_f32_16x16x32_bf16 v[172:175], v[216:219], v[244:247], v[172:175]
ds_read_b128 v[44:47], v248 offset:4096
v_mfma_f32_16x16x32_bf16 v[176:179], v[220:223], v[228:231], v[176:179]
ds_read_b128 v[48:51], v248 offset:6144
v_mfma_f32_16x16x32_bf16 v[180:183], v[220:223], v[232:235], v[180:183]
ds_read_b128 v[52:55], v248 offset:8192
v_mfma_f32_16x16x32_bf16 v[184:187], v[220:223], v[236:239], v[184:187]
ds_read_b64_tr_b16 v[28:29], v12 offset:12288
v_mfma_f32_16x16x32_bf16 v[188:191], v[220:223], v[240:243], v[188:191]
ds_read_b64_tr_b16 v[30:31], v12 offset:13824
v_mfma_f32_16x16x32_bf16 v[192:195], v[220:223], v[244:247], v[192:195]
ds_read_b64_tr_b16 v[32:33], v13 offset:12288
v_mfma_f32_16x16x32_bf16 v[196:199], v[224:227], v[228:231], v[196:199]
ds_read_b64_tr_b16 v[34:35], v13 offset:13824
v_mfma_f32_16x16x32_bf16 v[200:203], v[224:227], v[232:235], v[200:203]
v_mfma_f32_16x16x32_bf16 v[204:207], v[224:227], v[236:239], v[204:207]
v_mfma_f32_16x16x32_bf16 v[208:211], v[224:227], v[240:243], v[208:211]
v_mfma_f32_16x16x32_bf16 v[212:215], v[224:227], v[244:247], v[212:215]
s_waitcnt lgkmcnt(0)
s_barrier
v_mfma_f32_16x16x32_bf16 v[156:159], v[24:27], v[36:39], v[156:159]
ds_read_b64_tr_b16 v[216:217], v11 offset:24576
v_mfma_f32_16x16x32_bf16 v[160:163], v[24:27], v[40:43], v[160:163]
ds_read_b64_tr_b16 v[218:219], v11 offset:26112
v_mfma_f32_16x16x32_bf16 v[164:167], v[24:27], v[44:47], v[164:167]
ds_read_b128 v[228:231], v5 offset:10240
v_mfma_f32_16x16x32_bf16 v[168:171], v[24:27], v[48:51], v[168:171]
ds_read_b128 v[232:235], v5 offset:12288
v_mfma_f32_16x16x32_bf16 v[172:175], v[24:27], v[52:55], v[172:175]
ds_read_b128 v[236:239], v5 offset:14336
v_mfma_f32_16x16x32_bf16 v[176:179], v[28:31], v[36:39], v[176:179]
ds_read_b128 v[240:243], v5 offset:16384
v_mfma_f32_16x16x32_bf16 v[180:183], v[28:31], v[40:43], v[180:183]
ds_read_b128 v[244:247], v5 offset:18432
v_mfma_f32_16x16x32_bf16 v[184:187], v[28:31], v[44:47], v[184:187]
ds_read_b64_tr_b16 v[220:221], v12 offset:24576
v_mfma_f32_16x16x32_bf16 v[188:191], v[28:31], v[48:51], v[188:191]
ds_read_b64_tr_b16 v[222:223], v12 offset:26112
v_mfma_f32_16x16x32_bf16 v[192:195], v[28:31], v[52:55], v[192:195]
ds_read_b64_tr_b16 v[224:225], v13 offset:24576
v_mfma_f32_16x16x32_bf16 v[196:199], v[32:35], v[36:39], v[196:199]
ds_read_b64_tr_b16 v[226:227], v13 offset:26112
v_mfma_f32_16x16x32_bf16 v[200:203], v[32:35], v[40:43], v[200:203]
v_mfma_f32_16x16x32_bf16 v[204:207], v[32:35], v[44:47], v[204:207]
v_mfma_f32_16x16x32_bf16 v[208:211], v[32:35], v[48:51], v[208:211]
v_mfma_f32_16x16x32_bf16 v[212:215], v[32:35], v[52:55], v[212:215]
s_waitcnt lgkmcnt(0)
s_barrier
v_mfma_f32_16x16x32_bf16 v[156:159], v[216:219], v[228:231], v[156:159]
ds_read_b64_tr_b16 v[24:25], v11 offset:36864
v_mfma_f32_16x16x32_bf16 v[160:163], v[216:219], v[232:235], v[160:163]
ds_read_b64_tr_b16 v[26:27], v11 offset:38400
v_mfma_f32_16x16x32_bf16 v[164:167], v[216:219], v[236:239], v[164:167]
ds_read_b128 v[36:39], v248 offset:10240
v_mfma_f32_16x16x32_bf16 v[168:171], v[216:219], v[240:243], v[168:171]
ds_read_b128 v[40:43], v248 offset:12288
v_mfma_f32_16x16x32_bf16 v[172:175], v[216:219], v[244:247], v[172:175]
ds_read_b128 v[44:47], v248 offset:14336
v_mfma_f32_16x16x32_bf16 v[176:179], v[220:223], v[228:231], v[176:179]
ds_read_b128 v[48:51], v248 offset:16384
v_mfma_f32_16x16x32_bf16 v[180:183], v[220:223], v[232:235], v[180:183]
ds_read_b128 v[52:55], v248 offset:18432
v_mfma_f32_16x16x32_bf16 v[184:187], v[220:223], v[236:239], v[184:187]
ds_read_b64_tr_b16 v[28:29], v12 offset:36864
v_mfma_f32_16x16x32_bf16 v[188:191], v[220:223], v[240:243], v[188:191]
ds_read_b64_tr_b16 v[30:31], v12 offset:38400
v_mfma_f32_16x16x32_bf16 v[192:195], v[220:223], v[244:247], v[192:195]
ds_read_b64_tr_b16 v[32:33], v13 offset:36864
v_mfma_f32_16x16x32_bf16 v[196:199], v[224:227], v[228:231], v[196:199]
ds_read_b64_tr_b16 v[34:35], v13 offset:38400
v_mfma_f32_16x16x32_bf16 v[200:203], v[224:227], v[232:235], v[200:203]
v_mfma_f32_16x16x32_bf16 v[204:207], v[224:227], v[236:239], v[204:207]
v_mfma_f32_16x16x32_bf16 v[208:211], v[224:227], v[240:243], v[208:211]
v_mfma_f32_16x16x32_bf16 v[212:215], v[224:227], v[244:247], v[212:215]
s_waitcnt lgkmcnt(0)
s_barrier
v_mfma_f32_16x16x32_bf16 v[156:159], v[24:27], v[36:39], v[156:159]
v_mfma_f32_16x16x32_bf16 v[160:163], v[24:27], v[40:43], v[160:163]
v_mfma_f32_16x16x32_bf16 v[164:167], v[24:27], v[44:47], v[164:167]
v_mfma_f32_16x16x32_bf16 v[168:171], v[24:27], v[48:51], v[168:171]
v_mfma_f32_16x16x32_bf16 v[172:175], v[24:27], v[52:55], v[172:175]
v_mfma_f32_16x16x32_bf16 v[176:179], v[28:31], v[36:39], v[176:179]
v_mfma_f32_16x16x32_bf16 v[180:183], v[28:31], v[40:43], v[180:183]
v_mfma_f32_16x16x32_bf16 v[184:187], v[28:31], v[44:47], v[184:187]
v_mfma_f32_16x16x32_bf16 v[188:191], v[28:31], v[48:51], v[188:191]
v_mfma_f32_16x16x32_bf16 v[192:195], v[28:31], v[52:55], v[192:195]
v_mfma_f32_16x16x32_bf16 v[196:199], v[32:35], v[36:39], v[196:199]
v_mfma_f32_16x16x32_bf16 v[200:203], v[32:35], v[40:43], v[200:203]
v_mfma_f32_16x16x32_bf16 v[204:207], v[32:35], v[44:47], v[204:207]
v_mfma_f32_16x16x32_bf16 v[208:211], v[32:35], v[48:51], v[208:211]
v_mfma_f32_16x16x32_bf16 v[212:215], v[32:35], v[52:55], v[212:215]
s_nop 7
v_cvt_pk_bf16_f32 v156, v156, v157
v_cvt_pk_bf16_f32 v157, v158, v159
ds_write_b64 v14, v[156:157] offset:0
v_cvt_pk_bf16_f32 v160, v160, v161
v_cvt_pk_bf16_f32 v161, v162, v163
ds_write_b64 v14, v[160:161] offset:1024
v_cvt_pk_bf16_f32 v164, v164, v165
v_cvt_pk_bf16_f32 v165, v166, v167
ds_write_b64 v14, v[164:165] offset:2048
v_cvt_pk_bf16_f32 v168, v168, v169
v_cvt_pk_bf16_f32 v169, v170, v171
ds_write_b64 v14, v[168:169] offset:3072
v_cvt_pk_bf16_f32 v172, v172, v173
v_cvt_pk_bf16_f32 v173, v174, v175
ds_write_b64 v14, v[172:173] offset:4096
v_cvt_pk_bf16_f32 v176, v176, v177
v_cvt_pk_bf16_f32 v177, v178, v179
ds_write_b64 v15, v[176:177] offset:0
v_cvt_pk_bf16_f32 v180, v180, v181
v_cvt_pk_bf16_f32 v181, v182, v183
ds_write_b64 v15, v[180:181] offset:1024
v_cvt_pk_bf16_f32 v184, v184, v185
v_cvt_pk_bf16_f32 v185, v186, v187
ds_write_b64 v15, v[184:185] offset:2048
v_cvt_pk_bf16_f32 v188, v188, v189
v_cvt_pk_bf16_f32 v189, v190, v191
ds_write_b64 v15, v[188:189] offset:3072
v_cvt_pk_bf16_f32 v192, v192, v193
v_cvt_pk_bf16_f32 v193, v194, v195
ds_write_b64 v15, v[192:193] offset:4096
v_cvt_pk_bf16_f32 v196, v196, v197
v_cvt_pk_bf16_f32 v197, v198, v199
ds_write_b64 v16, v[196:197] offset:0
v_cvt_pk_bf16_f32 v200, v200, v201
v_cvt_pk_bf16_f32 v201, v202, v203
ds_write_b64 v16, v[200:201] offset:1024
v_cvt_pk_bf16_f32 v204, v204, v205
v_cvt_pk_bf16_f32 v205, v206, v207
ds_write_b64 v16, v[204:205] offset:2048
v_cvt_pk_bf16_f32 v208, v208, v209
v_cvt_pk_bf16_f32 v209, v210, v211
ds_write_b64 v16, v[208:209] offset:3072
v_cvt_pk_bf16_f32 v212, v212, v213
v_cvt_pk_bf16_f32 v213, v214, v215
ds_write_b64 v16, v[212:213] offset:4096
s_waitcnt lgkmcnt(0)
s_barrier
s_cmp_lg_u32 s50, 0
s_cbranch_scc1 .Lnoarr
s_sub_u32 s3, s69, 26214400
s_lshr_b32 s3, s3, 10
s_lshl_b32 s3, s3, 3
s_waitcnt vmcnt(0)
v_mov_b32 v249, s3
v_mov_b32 v250, 1
s_mov_b64 exec, 1
global_atomic_add v249, v250, s[42:43]
s_mov_b64 exec, -1
.Lnoarr:
.LA_loop:
s_add_u32 s3, s38, 0
s_and_b32 s3, s3, 3
s_xor_b32 s3, s3, s67
s_mul_i32 s34, s3, 196608
s_add_u32 s34, s34, s33
ds_read_b128 v[48:51], v6 offset:0
ds_read_b128 v[52:55], v7 offset:0
ds_read_b128 v[56:59], v6 offset:128
ds_read_b128 v[60:63], v7 offset:128
ds_read_b128 v[64:67], v6 offset:256
ds_read_b128 v[68:71], v7 offset:256
ds_read_b128 v[72:75], v6 offset:6144
ds_read_b128 v[76:79], v7 offset:6144
ds_read_b128 v[80:83], v6 offset:6272
ds_read_b128 v[84:87], v7 offset:6272
ds_read_b128 v[88:91], v6 offset:6400
ds_read_b128 v[92:95], v7 offset:6400
ds_read_b128 v[24:27], v4 offset:0
ds_read_b128 v[28:31], v4 offset:1024
ds_read_b128 v[32:35], v4 offset:2048
s_waitcnt lgkmcnt(3)
ds_read_b128 v[36:39], v4 offset:3072
ds_read_b128 v[40:43], v4 offset:4096
s_waitcnt lgkmcnt(4)
v_mfma_f32_16x16x32_bf16 v[96:99], v[48:51], v[24:27], 0
v_mfma_f32_16x16x32_bf16 v[116:119], v[72:75], v[24:27], 0
s_add_u32 m0, s33, 0
s_add_u32 s61, s34, 49152
buffer_load_dwordx4 v1, s[8:11], s61 offen offset:0 nt lds
ds_read_b128 v[44:47], v4 offset:5120
s_waitcnt lgkmcnt(4)
v_mfma_f32_16x16x32_bf16 v[100:103], v[48:51], v[28:31], 0
v_mfma_f32_16x16x32_bf16 v[120:123], v[72:75], v[28:31], 0
buffer_load_dwordx4 v2, s[8:11], s61 offen offset:1024 nt lds
ds_read_b128 v[24:27], v4 offset:6144
s_waitcnt lgkmcnt(4)
v_mfma_f32_16x16x32_bf16 v[104:107], v[48:51], v[32:35], 0
v_mfma_f32_16x16x32_bf16 v[124:127], v[72:75], v[32:35], 0
buffer_load_dwordx4 v3, s[8:11], s61 offen offset:2048 nt lds
ds_read_b128 v[28:31], v4 offset:7168
s_waitcnt lgkmcnt(4)
v_mfma_f32_16x16x32_bf16 v[108:111], v[48:51], v[36:39], 0
v_mfma_f32_16x16x32_bf16 v[128:131], v[72:75], v[36:39], 0
s_add_u32 m0, s33, 3072
s_add_u32 s61, s34, 52224
buffer_load_dwordx4 v1, s[8:11], s61 offen offset:0 nt lds
ds_read_b128 v[32:35], v4 offset:8192
s_waitcnt lgkmcnt(4)
v_mfma_f32_16x16x32_bf16 v[112:115], v[48:51], v[40:43], 0
v_mfma_f32_16x16x32_bf16 v[132:135], v[72:75], v[40:43], 0
buffer_load_dwordx4 v2, s[8:11], s61 offen offset:1024 nt lds
ds_read_b128 v[36:39], v4 offset:9216
s_waitcnt lgkmcnt(4)
v_mfma_f32_16x16x32_bf16 v[96:99], v[52:55], v[44:47], v[96:99]
v_mfma_f32_16x16x32_bf16 v[116:119], v[76:79], v[44:47], v[116:119]
buffer_load_dwordx4 v3, s[8:11], s61 offen offset:2048 nt lds
ds_read_b128 v[40:43], v4 offset:10240
s_waitcnt lgkmcnt(4)
v_mfma_f32_16x16x32_bf16 v[100:103], v[52:55], v[24:27], v[100:103]
v_mfma_f32_16x16x32_bf16 v[120:123], v[76:79], v[24:27], v[120:123]
s_add_u32 m0, s33, 6144
s_add_u32 s61, s34, 55296
buffer_load_dwordx4 v1, s[8:11], s61 offen offset:0 nt lds
ds_read_b128 v[44:47], v4 offset:11264
s_waitcnt lgkmcnt(4)
v_mfma_f32_16x16x32_bf16 v[104:107], v[52:55], v[28:31], v[104:107]
v_mfma_f32_16x16x32_bf16 v[124:127], v[76:79], v[28:31], v[124:127]
buffer_load_dwordx4 v2, s[8:11], s61 offen offset:1024 nt lds
ds_read_b128 v[24:27], v4 offset:12288
s_waitcnt lgkmcnt(4)
v_mfma_f32_16x16x32_bf16 v[108:111], v[52:55], v[32:35], v[108:111]
v_mfma_f32_16x16x32_bf16 v[128:131], v[76:79], v[32:35], v[128:131]
buffer_load_dwordx4 v3, s[8:11], s61 offen offset:2048 nt lds
ds_read_b128 v[28:31], v4 offset:13312
s_waitcnt lgkmcnt(4)
v_mfma_f32_16x16x32_bf16 v[112:115], v[52:55], v[36:39], v[112:115]
v_mfma_f32_16x16x32_bf16 v[132:135], v[76:79], v[36:39], v[132:135]
s_add_u32 m0, s33, 9216
s_add_u32 s61, s34, 58368
buffer_load_dwordx4 v1, s[8:11], s61 offen offset:0 nt lds
ds_read_b128 v[32:35], v4 offset:14336
s_waitcnt lgkmcnt(4)
v_mfma_f32_16x16x32_bf16 v[96:99], v[56:59], v[40:43], v[96:99]
v_mfma_f32_16x16x32_bf16 v[116:119], v[80:83], v[40:43], v[116:119]
buffer_load_dwordx4 v2, s[8:11], s61 offen offset:1024 nt lds
ds_read_b128 v[36:39], v4 offset:15360
s_waitcnt lgkmcnt(4)
v_mfma_f32_16x16x32_bf16 v[100:103], v[56:59], v[44:47], v[100:103]
v_mfma_f32_16x16x32_bf16 v[120:123], v[80:83], v[44:47], v[120:123]
buffer_load_dwordx4 v3, s[8:11], s61 offen offset:2048 nt lds
ds_read_b128 v[40:43], v4 offset:16384
s_waitcnt lgkmcnt(4)
v_mfma_f32_16x16x32_bf16 v[104:107], v[56:59], v[24:27], v[104:107]
v_mfma_f32_16x16x32_bf16 v[124:127], v[80:83], v[24:27], v[124:127]
ds_read_b128 v[44:47], v4 offset:17408
s_waitcnt lgkmcnt(4)
v_mfma_f32_16x16x32_bf16 v[108:111], v[56:59], v[28:31], v[108:111]
v_mfma_f32_16x16x32_bf16 v[128:131], v[80:83], v[28:31], v[128:131]
ds_read_b128 v[24:27], v4 offset:18432
s_waitcnt lgkmcnt(4)
v_mfma_f32_16x16x32_bf16 v[112:115], v[56:59], v[32:35], v[112:115]
v_mfma_f32_16x16x32_bf16 v[132:135], v[80:83], v[32:35], v[132:135]
ds_read_b128 v[28:31], v4 offset:19456
s_waitcnt lgkmcnt(4)
v_mfma_f32_16x16x32_bf16 v[96:99], v[60:63], v[36:39], v[96:99]
v_mfma_f32_16x16x32_bf16 v[116:119], v[84:87], v[36:39], v[116:119]
ds_read_b128 v[32:35], v4 offset:20480
s_waitcnt lgkmcnt(4)
v_mfma_f32_16x16x32_bf16 v[100:103], v[60:63], v[40:43], v[100:103]
v_mfma_f32_16x16x32_bf16 v[120:123], v[84:87], v[40:43], v[120:123]
ds_read_b128 v[36:39], v4 offset:21504
s_waitcnt lgkmcnt(4)
v_mfma_f32_16x16x32_bf16 v[104:107], v[60:63], v[44:47], v[104:107]
v_mfma_f32_16x16x32_bf16 v[124:127], v[84:87], v[44:47], v[124:127]
ds_read_b128 v[40:43], v4 offset:22528
s_waitcnt lgkmcnt(4)
v_mfma_f32_16x16x32_bf16 v[108:111], v[60:63], v[24:27], v[108:111]
v_mfma_f32_16x16x32_bf16 v[128:131], v[84:87], v[24:27], v[128:131]
ds_read_b128 v[44:47], v4 offset:23552
s_waitcnt lgkmcnt(4)
v_mfma_f32_16x16x32_bf16 v[112:115], v[60:63], v[28:31], v[112:115]
v_mfma_f32_16x16x32_bf16 v[132:135], v[84:87], v[28:31], v[132:135]
ds_read_b128 v[24:27], v4 offset:24576
s_waitcnt lgkmcnt(4)
v_mfma_f32_16x16x32_bf16 v[96:99], v[64:67], v[32:35], v[96:99]
v_mfma_f32_16x16x32_bf16 v[116:119], v[88:91], v[32:35], v[116:119]
ds_read_b128 v[28:31], v4 offset:25600
s_waitcnt lgkmcnt(4)
v_mfma_f32_16x16x32_bf16 v[100:103], v[64:67], v[36:39], v[100:103]
v_mfma_f32_16x16x32_bf16 v[120:123], v[88:91], v[36:39], v[120:123]
ds_read_b128 v[32:35], v4 offset:26624
s_waitcnt lgkmcnt(4)
v_mfma_f32_16x16x32_bf16 v[104:107], v[64:67], v[40:43], v[104:107]
v_mfma_f32_16x16x32_bf16 v[124:127], v[88:91], v[40:43], v[124:127]
ds_read_b128 v[36:39], v4 offset:27648
s_waitcnt lgkmcnt(4)
v_mfma_f32_16x16x32_bf16 v[108:111], v[64:67], v[44:47], v[108:111]
v_mfma_f32_16x16x32_bf16 v[128:131], v[88:91], v[44:47], v[128:131]
ds_read_b128 v[40:43], v4 offset:28672
s_waitcnt lgkmcnt(4)
v_mfma_f32_16x16x32_bf16 v[112:115], v[64:67], v[24:27], v[112:115]
v_mfma_f32_16x16x32_bf16 v[132:135], v[88:91], v[24:27], v[132:135]
ds_read_b128 v[44:47], v4 offset:29696
s_waitcnt lgkmcnt(4)
v_mfma_f32_16x16x32_bf16 v[96:99], v[68:71], v[28:31], v[96:99]
v_mfma_f32_16x16x32_bf16 v[116:119], v[92:95], v[28:31], v[116:119]
s_waitcnt lgkmcnt(3)
v_mfma_f32_16x16x32_bf16 v[100:103], v[68:71], v[32:35], v[100:103]
v_mfma_f32_16x16x32_bf16 v[120:123], v[92:95], v[32:35], v[120:123]
s_waitcnt lgkmcnt(2)
v_mfma_f32_16x16x32_bf16 v[104:107], v[68:71], v[36:39], v[104:107]
v_mfma_f32_16x16x32_bf16 v[124:127], v[92:95], v[36:39], v[124:127]
s_waitcnt lgkmcnt(1)
v_mfma_f32_16x16x32_bf16 v[108:111], v[68:71], v[40:43], v[108:111]
v_mfma_f32_16x16x32_bf16 v[128:131], v[92:95], v[40:43], v[128:131]
s_waitcnt lgkmcnt(0)
v_mfma_f32_16x16x32_bf16 v[112:115], v[68:71], v[44:47], v[112:115]
v_mfma_f32_16x16x32_bf16 v[132:135], v[92:95], v[44:47], v[132:135]
s_nop 7
v_max3_f32 v19, v96, v97, v98
v_max_f32 v19, v19, v99
v_max3_f32 v20, v100, v101, v102
v_max_f32 v20, v20, v103
v_max3_f32 v21, v104, v105, v106
v_max_f32 v21, v21, v107
v_max3_f32 v22, v108, v109, v110
v_max_f32 v22, v22, v111
v_max3_f32 v23, v112, v113, v114
v_max_f32 v23, v23, v115
v_max3_f32 v19, v19, v116, v117
v_max3_f32 v19, v19, v118, v119
v_max3_f32 v20, v20, v120, v121
v_max3_f32 v20, v20, v122, v123
v_max3_f32 v21, v21, v124, v125
v_max3_f32 v21, v21, v126, v127
v_max3_f32 v22, v22, v128, v129
v_max3_f32 v22, v22, v130, v131
v_max3_f32 v23, v23, v132, v133
v_max3_f32 v23, v23, v134, v135
s_waitcnt vmcnt(0)
ds_read_b128 v[48:51], v6 offset:0
ds_read_b128 v[52:55], v7 offset:0
ds_read_b128 v[56:59], v6 offset:128
ds_read_b128 v[60:63], v7 offset:128
ds_read_b128 v[64:67], v6 offset:256
ds_read_b128 v[68:71], v7 offset:256
ds_read_b128 v[72:75], v6 offset:6144
ds_read_b128 v[76:79], v7 offset:6144
ds_read_b128 v[80:83], v6 offset:6272
ds_read_b128 v[84:87], v7 offset:6272
ds_read_b128 v[88:91], v6 offset:6400
ds_read_b128 v[92:95], v7 offset:6400
ds_read_b128 v[24:27], v4 offset:0
ds_read_b128 v[28:31], v4 offset:1024
ds_read_b128 v[32:35], v4 offset:2048
s_waitcnt lgkmcnt(3)
ds_read_b128 v[36:39], v4 offset:3072
ds_read_b128 v[40:43], v4 offset:4096
s_waitcnt lgkmcnt(4)
v_mfma_f32_16x16x32_bf16 v[136:139], v[48:51], v[24:27], 0
v_mfma_f32_16x16x32_bf16 v[156:159], v[72:75], v[24:27], 0
s_add_u32 m0, s33, 0
s_add_u32 s61, s34, 98304
buffer_load_dwordx4 v1, s[8:11], s61 offen offset:0 nt lds
ds_read_b128 v[44:47], v4 offset:5120
s_waitcnt lgkmcnt(4)
v_mfma_f32_16x16x32_bf16 v[140:143], v[48:51], v[28:31], 0
v_mfma_f32_16x16x32_bf16 v[160:163], v[72:75], v[28:31], 0
buffer_load_dwordx4 v2, s[8:11], s61 offen offset:1024 nt lds
ds_read_b128 v[24:27], v4 offset:6144
s_waitcnt lgkmcnt(4)
v_mfma_f32_16x16x32_bf16 v[144:147], v[48:51], v[32:35], 0
v_mfma_f32_16x16x32_bf16 v[164:167], v[72:75], v[32:35], 0
buffer_load_dwordx4 v3, s[8:11], s61 offen offset:2048 nt lds
ds_read_b128 v[28:31], v4 offset:7168
s_waitcnt lgkmcnt(4)
v_mfma_f32_16x16x32_bf16 v[148:151], v[48:51], v[36:39], 0
v_mfma_f32_16x16x32_bf16 v[168:171], v[72:75], v[36:39], 0
s_add_u32 m0, s33, 3072
s_add_u32 s61, s34, 101376
buffer_load_dwordx4 v1, s[8:11], s61 offen offset:0 nt lds
ds_read_b128 v[32:35], v4 offset:8192
s_waitcnt lgkmcnt(4)
v_mfma_f32_16x16x32_bf16 v[152:155], v[48:51], v[40:43], 0
v_mfma_f32_16x16x32_bf16 v[172:175], v[72:75], v[40:43], 0
buffer_load_dwordx4 v2, s[8:11], s61 offen offset:1024 nt lds
ds_read_b128 v[36:39], v4 offset:9216
s_waitcnt lgkmcnt(4)
v_mfma_f32_16x16x32_bf16 v[136:139], v[52:55], v[44:47], v[136:139]
v_mfma_f32_16x16x32_bf16 v[156:159], v[76:79], v[44:47], v[156:159]
buffer_load_dwordx4 v3, s[8:11], s61 offen offset:2048 nt lds
ds_read_b128 v[40:43], v4 offset:10240
s_waitcnt lgkmcnt(4)
v_mfma_f32_16x16x32_bf16 v[140:143], v[52:55], v[24:27], v[140:143]
v_mfma_f32_16x16x32_bf16 v[160:163], v[76:79], v[24:27], v[160:163]
s_add_u32 m0, s33, 6144
s_add_u32 s61, s34, 104448
buffer_load_dwordx4 v1, s[8:11], s61 offen offset:0 nt lds
ds_read_b128 v[44:47], v4 offset:11264
s_waitcnt lgkmcnt(4)
v_mfma_f32_16x16x32_bf16 v[144:147], v[52:55], v[28:31], v[144:147]
v_mfma_f32_16x16x32_bf16 v[164:167], v[76:79], v[28:31], v[164:167]
buffer_load_dwordx4 v2, s[8:11], s61 offen offset:1024 nt lds
ds_read_b128 v[24:27], v4 offset:12288
s_waitcnt lgkmcnt(4)
v_mfma_f32_16x16x32_bf16 v[148:151], v[52:55], v[32:35], v[148:151]
v_mfma_f32_16x16x32_bf16 v[168:171], v[76:79], v[32:35], v[168:171]
buffer_load_dwordx4 v3, s[8:11], s61 offen offset:2048 nt lds
ds_read_b128 v[28:31], v4 offset:13312
s_waitcnt lgkmcnt(4)
v_mfma_f32_16x16x32_bf16 v[152:155], v[52:55], v[36:39], v[152:155]
v_mfma_f32_16x16x32_bf16 v[172:175], v[76:79], v[36:39], v[172:175]
s_add_u32 m0, s33, 9216
s_add_u32 s61, s34, 107520
buffer_load_dwordx4 v1, s[8:11], s61 offen offset:0 nt lds
ds_read_b128 v[32:35], v4 offset:14336
s_waitcnt lgkmcnt(4)
v_mfma_f32_16x16x32_bf16 v[136:139], v[56:59], v[40:43], v[136:139]
v_mfma_f32_16x16x32_bf16 v[156:159], v[80:83], v[40:43], v[156:159]
buffer_load_dwordx4 v2, s[8:11], s61 offen offset:1024 nt lds
ds_read_b128 v[36:39], v4 offset:15360
s_waitcnt lgkmcnt(4)
v_mfma_f32_16x16x32_bf16 v[140:143], v[56:59], v[44:47], v[140:143]
v_mfma_f32_16x16x32_bf16 v[160:163], v[80:83], v[44:47], v[160:163]
buffer_load_dwordx4 v3, s[8:11], s61 offen offset:2048 nt lds
ds_read_b128 v[40:43], v4 offset:16384
s_waitcnt lgkmcnt(4)
v_mfma_f32_16x16x32_bf16 v[144:147], v[56:59], v[24:27], v[144:147]
v_mfma_f32_16x16x32_bf16 v[164:167], v[80:83], v[24:27], v[164:167]
ds_read_b128 v[44:47], v4 offset:17408
s_waitcnt lgkmcnt(4)
v_mfma_f32_16x16x32_bf16 v[148:151], v[56:59], v[28:31], v[148:151]
v_mfma_f32_16x16x32_bf16 v[168:171], v[80:83], v[28:31], v[168:171]
ds_read_b128 v[24:27], v4 offset:18432
s_waitcnt lgkmcnt(4)
v_mfma_f32_16x16x32_bf16 v[152:155], v[56:59], v[32:35], v[152:155]
v_mfma_f32_16x16x32_bf16 v[172:175], v[80:83], v[32:35], v[172:175]
ds_read_b128 v[28:31], v4 offset:19456
s_waitcnt lgkmcnt(4)
v_mfma_f32_16x16x32_bf16 v[136:139], v[60:63], v[36:39], v[136:139]
v_mfma_f32_16x16x32_bf16 v[156:159], v[84:87], v[36:39], v[156:159]
ds_read_b128 v[32:35], v4 offset:20480
s_waitcnt lgkmcnt(4)
v_mfma_f32_16x16x32_bf16 v[140:143], v[60:63], v[40:43], v[140:143]
v_mfma_f32_16x16x32_bf16 v[160:163], v[84:87], v[40:43], v[160:163]
ds_read_b128 v[36:39], v4 offset:21504
s_waitcnt lgkmcnt(4)
v_mfma_f32_16x16x32_bf16 v[144:147], v[60:63], v[44:47], v[144:147]
v_mfma_f32_16x16x32_bf16 v[164:167], v[84:87], v[44:47], v[164:167]
ds_read_b128 v[40:43], v4 offset:22528
s_waitcnt lgkmcnt(4)
v_mfma_f32_16x16x32_bf16 v[148:151], v[60:63], v[24:27], v[148:151]
v_mfma_f32_16x16x32_bf16 v[168:171], v[84:87], v[24:27], v[168:171]
ds_read_b128 v[44:47], v4 offset:23552
s_waitcnt lgkmcnt(4)
v_mfma_f32_16x16x32_bf16 v[152:155], v[60:63], v[28:31], v[152:155]
v_mfma_f32_16x16x32_bf16 v[172:175], v[84:87], v[28:31], v[172:175]
ds_read_b128 v[24:27], v4 offset:24576
s_waitcnt lgkmcnt(4)
v_mfma_f32_16x16x32_bf16 v[136:139], v[64:67], v[32:35], v[136:139]
v_mfma_f32_16x16x32_bf16 v[156:159], v[88:91], v[32:35], v[156:159]
ds_read_b128 v[28:31], v4 offset:25600
s_waitcnt lgkmcnt(4)
v_mfma_f32_16x16x32_bf16 v[140:143], v[64:67], v[36:39], v[140:143]
v_mfma_f32_16x16x32_bf16 v[160:163], v[88:91], v[36:39], v[160:163]
ds_read_b128 v[32:35], v4 offset:26624
s_waitcnt lgkmcnt(4)
v_mfma_f32_16x16x32_bf16 v[144:147], v[64:67], v[40:43], v[144:147]
v_mfma_f32_16x16x32_bf16 v[164:167], v[88:91], v[40:43], v[164:167]
ds_read_b128 v[36:39], v4 offset:27648
s_waitcnt lgkmcnt(4)
v_mfma_f32_16x16x32_bf16 v[148:151], v[64:67], v[44:47], v[148:151]
v_mfma_f32_16x16x32_bf16 v[168:171], v[88:91], v[44:47], v[168:171]
ds_read_b128 v[40:43], v4 offset:28672
s_waitcnt lgkmcnt(4)
v_mfma_f32_16x16x32_bf16 v[152:155], v[64:67], v[24:27], v[152:155]
v_mfma_f32_16x16x32_bf16 v[172:175], v[88:91], v[24:27], v[172:175]
ds_read_b128 v[44:47], v4 offset:29696
s_waitcnt lgkmcnt(4)
v_mfma_f32_16x16x32_bf16 v[136:139], v[68:71], v[28:31], v[136:139]
v_mfma_f32_16x16x32_bf16 v[156:159], v[92:95], v[28:31], v[156:159]
s_waitcnt lgkmcnt(3)
v_mfma_f32_16x16x32_bf16 v[140:143], v[68:71], v[32:35], v[140:143]
v_mfma_f32_16x16x32_bf16 v[160:163], v[92:95], v[32:35], v[160:163]
s_waitcnt lgkmcnt(2)
v_mfma_f32_16x16x32_bf16 v[144:147], v[68:71], v[36:39], v[144:147]
v_mfma_f32_16x16x32_bf16 v[164:167], v[92:95], v[36:39], v[164:167]
s_waitcnt lgkmcnt(1)
v_mfma_f32_16x16x32_bf16 v[148:151], v[68:71], v[40:43], v[148:151]
v_mfma_f32_16x16x32_bf16 v[168:171], v[92:95], v[40:43], v[168:171]
s_waitcnt lgkmcnt(0)
v_mfma_f32_16x16x32_bf16 v[152:155], v[68:71], v[44:47], v[152:155]
v_mfma_f32_16x16x32_bf16 v[172:175], v[92:95], v[44:47], v[172:175]
s_nop 7
v_max3_f32 v19, v19, v136, v137
v_max3_f32 v19, v19, v138, v139
v_max3_f32 v20, v20, v140, v141
v_max3_f32 v20, v20, v142, v143
v_max3_f32 v21, v21, v144, v145
v_max3_f32 v21, v21, v146, v147
v_max3_f32 v22, v22, v148, v149
v_max3_f32 v22, v22, v150, v151
v_max3_f32 v23, v23, v152, v153
v_max3_f32 v23, v23, v154, v155
v_max3_f32 v19, v19, v156, v157
v_max3_f32 v19, v19, v158, v159
v_max3_f32 v20, v20, v160, v161
v_max3_f32 v20, v20, v162, v163
v_max3_f32 v21, v21, v164, v165
v_max3_f32 v21, v21, v166, v167
v_max3_f32 v22, v22, v168, v169
v_max3_f32 v22, v22, v170, v171
v_max3_f32 v23, v23, v172, v173
v_max3_f32 v23, v23, v174, v175
s_waitcnt vmcnt(0)
ds_read_b128 v[48:51], v6 offset:0
ds_read_b128 v[52:55], v7 offset:0
ds_read_b128 v[56:59], v6 offset:128
ds_read_b128 v[60:63], v7 offset:128
ds_read_b128 v[64:67], v6 offset:256
ds_read_b128 v[68:71], v7 offset:256
ds_read_b128 v[72:75], v6 offset:6144
ds_read_b128 v[76:79], v7 offset:6144
ds_read_b128 v[80:83], v6 offset:6272
ds_read_b128 v[84:87], v7 offset:6272
ds_read_b128 v[88:91], v6 offset:6400
ds_read_b128 v[92:95], v7 offset:6400
ds_read_b128 v[24:27], v4 offset:0
ds_read_b128 v[28:31], v4 offset:1024
ds_read_b128 v[32:35], v4 offset:2048
s_waitcnt lgkmcnt(3)
ds_read_b128 v[36:39], v4 offset:3072
ds_read_b128 v[40:43], v4 offset:4096
s_waitcnt lgkmcnt(4)
v_mfma_f32_16x16x32_bf16 v[176:179], v[48:51], v[24:27], 0
v_mfma_f32_16x16x32_bf16 v[196:199], v[72:75], v[24:27], 0
s_add_u32 m0, s33, 0
s_add_u32 s61, s34, 147456
buffer_load_dwordx4 v1, s[8:11], s61 offen offset:0 nt lds
ds_read_b128 v[44:47], v4 offset:5120
s_waitcnt lgkmcnt(4)
v_mfma_f32_16x16x32_bf16 v[180:183], v[48:51], v[28:31], 0
v_mfma_f32_16x16x32_bf16 v[200:203], v[72:75], v[28:31], 0
buffer_load_dwordx4 v2, s[8:11], s61 offen offset:1024 nt lds
ds_read_b128 v[24:27], v4 offset:6144
s_waitcnt lgkmcnt(4)
v_mfma_f32_16x16x32_bf16 v[184:187], v[48:51], v[32:35], 0
v_mfma_f32_16x16x32_bf16 v[204:207], v[72:75], v[32:35], 0
buffer_load_dwordx4 v3, s[8:11], s61 offen offset:2048 nt lds
ds_read_b128 v[28:31], v4 offset:7168
s_waitcnt lgkmcnt(4)
v_mfma_f32_16x16x32_bf16 v[188:191], v[48:51], v[36:39], 0
v_mfma_f32_16x16x32_bf16 v[208:211], v[72:75], v[36:39], 0
s_add_u32 m0, s33, 3072
s_add_u32 s61, s34, 150528
buffer_load_dwordx4 v1, s[8:11], s61 offen offset:0 nt lds
ds_read_b128 v[32:35], v4 offset:8192
s_waitcnt lgkmcnt(4)
v_mfma_f32_16x16x32_bf16 v[192:195], v[48:51], v[40:43], 0
v_mfma_f32_16x16x32_bf16 v[212:215], v[72:75], v[40:43], 0
buffer_load_dwordx4 v2, s[8:11], s61 offen offset:1024 nt lds
ds_read_b128 v[36:39], v4 offset:9216
s_waitcnt lgkmcnt(4)
v_mfma_f32_16x16x32_bf16 v[176:179], v[52:55], v[44:47], v[176:179]
v_mfma_f32_16x16x32_bf16 v[196:199], v[76:79], v[44:47], v[196:199]
buffer_load_dwordx4 v3, s[8:11], s61 offen offset:2048 nt lds
ds_read_b128 v[40:43], v4 offset:10240
s_waitcnt lgkmcnt(4)
v_mfma_f32_16x16x32_bf16 v[180:183], v[52:55], v[24:27], v[180:183]
v_mfma_f32_16x16x32_bf16 v[200:203], v[76:79], v[24:27], v[200:203]
s_add_u32 m0, s33, 6144
s_add_u32 s61, s34, 153600
buffer_load_dwordx4 v1, s[8:11], s61 offen offset:0 nt lds
ds_read_b128 v[44:47], v4 offset:11264
s_waitcnt lgkmcnt(4)
v_mfma_f32_16x16x32_bf16 v[184:187], v[52:55], v[28:31], v[184:187]
v_mfma_f32_16x16x32_bf16 v[204:207], v[76:79], v[28:31], v[204:207]
buffer_load_dwordx4 v2, s[8:11], s61 offen offset:1024 nt lds
ds_read_b128 v[24:27], v4 offset:12288
s_waitcnt lgkmcnt(4)
v_mfma_f32_16x16x32_bf16 v[188:191], v[52:55], v[32:35], v[188:191]
v_mfma_f32_16x16x32_bf16 v[208:211], v[76:79], v[32:35], v[208:211]
buffer_load_dwordx4 v3, s[8:11], s61 offen offset:2048 nt lds
ds_read_b128 v[28:31], v4 offset:13312
s_waitcnt lgkmcnt(4)
v_mfma_f32_16x16x32_bf16 v[192:195], v[52:55], v[36:39], v[192:195]
v_mfma_f32_16x16x32_bf16 v[212:215], v[76:79], v[36:39], v[212:215]
s_add_u32 m0, s33, 9216
s_add_u32 s61, s34, 156672
buffer_load_dwordx4 v1, s[8:11], s61 offen offset:0 nt lds
ds_read_b128 v[32:35], v4 offset:14336
s_waitcnt lgkmcnt(4)
v_mfma_f32_16x16x32_bf16 v[176:179], v[56:59], v[40:43], v[176:179]
v_mfma_f32_16x16x32_bf16 v[196:199], v[80:83], v[40:43], v[196:199]
buffer_load_dwordx4 v2, s[8:11], s61 offen offset:1024 nt lds
ds_read_b128 v[36:39], v4 offset:15360
s_waitcnt lgkmcnt(4)
v_mfma_f32_16x16x32_bf16 v[180:183], v[56:59], v[44:47], v[180:183]
v_mfma_f32_16x16x32_bf16 v[200:203], v[80:83], v[44:47], v[200:203]
buffer_load_dwordx4 v3, s[8:11], s61 offen offset:2048 nt lds
ds_read_b128 v[40:43], v4 offset:16384
s_waitcnt lgkmcnt(4)
v_mfma_f32_16x16x32_bf16 v[184:187], v[56:59], v[24:27], v[184:187]
v_mfma_f32_16x16x32_bf16 v[204:207], v[80:83], v[24:27], v[204:207]
ds_read_b128 v[44:47], v4 offset:17408
s_waitcnt lgkmcnt(4)
v_mfma_f32_16x16x32_bf16 v[188:191], v[56:59], v[28:31], v[188:191]
v_mfma_f32_16x16x32_bf16 v[208:211], v[80:83], v[28:31], v[208:211]
ds_read_b128 v[24:27], v4 offset:18432
s_waitcnt lgkmcnt(4)
v_mfma_f32_16x16x32_bf16 v[192:195], v[56:59], v[32:35], v[192:195]
v_mfma_f32_16x16x32_bf16 v[212:215], v[80:83], v[32:35], v[212:215]
ds_read_b128 v[28:31], v4 offset:19456
s_waitcnt lgkmcnt(4)
v_mfma_f32_16x16x32_bf16 v[176:179], v[60:63], v[36:39], v[176:179]
v_mfma_f32_16x16x32_bf16 v[196:199], v[84:87], v[36:39], v[196:199]
ds_read_b128 v[32:35], v4 offset:20480
s_waitcnt lgkmcnt(4)
v_mfma_f32_16x16x32_bf16 v[180:183], v[60:63], v[40:43], v[180:183]
v_mfma_f32_16x16x32_bf16 v[200:203], v[84:87], v[40:43], v[200:203]
ds_read_b128 v[36:39], v4 offset:21504
s_waitcnt lgkmcnt(4)
v_mfma_f32_16x16x32_bf16 v[184:187], v[60:63], v[44:47], v[184:187]
v_mfma_f32_16x16x32_bf16 v[204:207], v[84:87], v[44:47], v[204:207]
ds_read_b128 v[40:43], v4 offset:22528
s_waitcnt lgkmcnt(4)
v_mfma_f32_16x16x32_bf16 v[188:191], v[60:63], v[24:27], v[188:191]
v_mfma_f32_16x16x32_bf16 v[208:211], v[84:87], v[24:27], v[208:211]
ds_read_b128 v[44:47], v4 offset:23552
s_waitcnt lgkmcnt(4)
v_mfma_f32_16x16x32_bf16 v[192:195], v[60:63], v[28:31], v[192:195]
v_mfma_f32_16x16x32_bf16 v[212:215], v[84:87], v[28:31], v[212:215]
ds_read_b128 v[24:27], v4 offset:24576
s_waitcnt lgkmcnt(4)
v_mfma_f32_16x16x32_bf16 v[176:179], v[64:67], v[32:35], v[176:179]
v_mfma_f32_16x16x32_bf16 v[196:199], v[88:91], v[32:35], v[196:199]
ds_read_b128 v[28:31], v4 offset:25600
s_waitcnt lgkmcnt(4)
v_mfma_f32_16x16x32_bf16 v[180:183], v[64:67], v[36:39], v[180:183]
v_mfma_f32_16x16x32_bf16 v[200:203], v[88:91], v[36:39], v[200:203]
ds_read_b128 v[32:35], v4 offset:26624
s_waitcnt lgkmcnt(4)
v_mfma_f32_16x16x32_bf16 v[184:187], v[64:67], v[40:43], v[184:187]
v_mfma_f32_16x16x32_bf16 v[204:207], v[88:91], v[40:43], v[204:207]
ds_read_b128 v[36:39], v4 offset:27648
s_waitcnt lgkmcnt(4)
v_mfma_f32_16x16x32_bf16 v[188:191], v[64:67], v[44:47], v[188:191]
v_mfma_f32_16x16x32_bf16 v[208:211], v[88:91], v[44:47], v[208:211]
ds_read_b128 v[40:43], v4 offset:28672
s_waitcnt lgkmcnt(4)
v_mfma_f32_16x16x32_bf16 v[192:195], v[64:67], v[24:27], v[192:195]
v_mfma_f32_16x16x32_bf16 v[212:215], v[88:91], v[24:27], v[212:215]
ds_read_b128 v[44:47], v4 offset:29696
s_waitcnt lgkmcnt(4)
v_mfma_f32_16x16x32_bf16 v[176:179], v[68:71], v[28:31], v[176:179]
v_mfma_f32_16x16x32_bf16 v[196:199], v[92:95], v[28:31], v[196:199]
s_waitcnt lgkmcnt(3)
v_mfma_f32_16x16x32_bf16 v[180:183], v[68:71], v[32:35], v[180:183]
v_mfma_f32_16x16x32_bf16 v[200:203], v[92:95], v[32:35], v[200:203]
s_waitcnt lgkmcnt(2)
v_mfma_f32_16x16x32_bf16 v[184:187], v[68:71], v[36:39], v[184:187]
v_mfma_f32_16x16x32_bf16 v[204:207], v[92:95], v[36:39], v[204:207]
s_waitcnt lgkmcnt(1)
v_mfma_f32_16x16x32_bf16 v[188:191], v[68:71], v[40:43], v[188:191]
v_mfma_f32_16x16x32_bf16 v[208:211], v[92:95], v[40:43], v[208:211]
s_waitcnt lgkmcnt(0)
v_mfma_f32_16x16x32_bf16 v[192:195], v[68:71], v[44:47], v[192:195]
v_mfma_f32_16x16x32_bf16 v[212:215], v[92:95], v[44:47], v[212:215]
s_nop 7
v_max3_f32 v19, v19, v176, v177
v_max3_f32 v19, v19, v178, v179
v_max3_f32 v20, v20, v180, v181
v_max3_f32 v20, v20, v182, v183
v_max3_f32 v21, v21, v184, v185
v_max3_f32 v21, v21, v186, v187
v_max3_f32 v22, v22, v188, v189
v_max3_f32 v22, v22, v190, v191
v_max3_f32 v23, v23, v192, v193
v_max3_f32 v23, v23, v194, v195
v_max3_f32 v19, v19, v196, v197
v_max3_f32 v19, v19, v198, v199
v_max3_f32 v20, v20, v200, v201
v_max3_f32 v20, v20, v202, v203
v_max3_f32 v21, v21, v204, v205
v_max3_f32 v21, v21, v206, v207
v_max3_f32 v22, v22, v208, v209
v_max3_f32 v22, v22, v210, v211
v_max3_f32 v23, v23, v212, v213
v_max3_f32 v23, v23, v214, v215
s_waitcnt vmcnt(0)
ds_read_b128 v[48:51], v6 offset:0
ds_read_b128 v[52:55], v7 offset:0
ds_read_b128 v[56:59], v6 offset:128
ds_read_b128 v[60:63], v7 offset:128
ds_read_b128 v[64:67], v6 offset:256
ds_read_b128 v[68:71], v7 offset:256
ds_read_b128 v[72:75], v6 offset:6144
ds_read_b128 v[76:79], v7 offset:6144
ds_read_b128 v[80:83], v6 offset:6272
ds_read_b128 v[84:87], v7 offset:6272
ds_read_b128 v[88:91], v6 offset:6400
ds_read_b128 v[92:95], v7 offset:6400
ds_read_b128 v[24:27], v4 offset:0
ds_read_b128 v[28:31], v4 offset:1024
ds_read_b128 v[32:35], v4 offset:2048
s_waitcnt lgkmcnt(3)
ds_read_b128 v[36:39], v4 offset:3072
ds_read_b128 v[40:43], v4 offset:4096
s_waitcnt lgkmcnt(4)
v_mfma_f32_16x16x32_bf16 v[216:219], v[48:51], v[24:27], 0
v_mfma_f32_16x16x32_bf16 v[236:239], v[72:75], v[24:27], 0
ds_read_b128 v[44:47], v4 offset:5120
s_waitcnt lgkmcnt(4)
v_mfma_f32_16x16x32_bf16 v[220:223], v[48:51], v[28:31], 0
v_mfma_f32_16x16x32_bf16 v[240:243], v[72:75], v[28:31], 0
ds_read_b128 v[24:27], v4 offset:6144
s_waitcnt lgkmcnt(4)
v_mfma_f32_16x16x32_bf16 v[224:227], v[48:51], v[32:35], 0
v_mfma_f32_16x16x32_bf16 v[244:247], v[72:75], v[32:35], 0
ds_read_b128 v[28:31], v4 offset:7168
s_waitcnt lgkmcnt(4)
v_mfma_f32_16x16x32_bf16 v[228:231], v[48:51], v[36:39], 0
v_mfma_f32_16x16x32_bf16 v[248:251], v[72:75], v[36:39], 0
ds_read_b128 v[32:35], v4 offset:8192
s_waitcnt lgkmcnt(4)
v_mfma_f32_16x16x32_bf16 v[232:235], v[48:51], v[40:43], 0
v_mfma_f32_16x16x32_bf16 v[252:255], v[72:75], v[40:43], 0
ds_read_b128 v[36:39], v4 offset:9216
s_waitcnt lgkmcnt(4)
v_mfma_f32_16x16x32_bf16 v[216:219], v[52:55], v[44:47], v[216:219]
v_mfma_f32_16x16x32_bf16 v[236:239], v[76:79], v[44:47], v[236:239]
ds_read_b128 v[40:43], v4 offset:10240
s_waitcnt lgkmcnt(4)
v_mfma_f32_16x16x32_bf16 v[220:223], v[52:55], v[24:27], v[220:223]
v_mfma_f32_16x16x32_bf16 v[240:243], v[76:79], v[24:27], v[240:243]
ds_read_b128 v[44:47], v4 offset:11264
s_waitcnt lgkmcnt(4)
v_mfma_f32_16x16x32_bf16 v[224:227], v[52:55], v[28:31], v[224:227]
v_mfma_f32_16x16x32_bf16 v[244:247], v[76:79], v[28:31], v[244:247]
ds_read_b128 v[24:27], v4 offset:12288
s_waitcnt lgkmcnt(4)
v_mfma_f32_16x16x32_bf16 v[228:231], v[52:55], v[32:35], v[228:231]
v_mfma_f32_16x16x32_bf16 v[248:251], v[76:79], v[32:35], v[248:251]
ds_read_b128 v[28:31], v4 offset:13312
s_waitcnt lgkmcnt(4)
v_mfma_f32_16x16x32_bf16 v[232:235], v[52:55], v[36:39], v[232:235]
v_mfma_f32_16x16x32_bf16 v[252:255], v[76:79], v[36:39], v[252:255]
ds_read_b128 v[32:35], v4 offset:14336
s_waitcnt lgkmcnt(4)
v_mfma_f32_16x16x32_bf16 v[216:219], v[56:59], v[40:43], v[216:219]
v_mfma_f32_16x16x32_bf16 v[236:239], v[80:83], v[40:43], v[236:239]
ds_read_b128 v[36:39], v4 offset:15360
s_waitcnt lgkmcnt(4)
v_mfma_f32_16x16x32_bf16 v[220:223], v[56:59], v[44:47], v[220:223]
v_mfma_f32_16x16x32_bf16 v[240:243], v[80:83], v[44:47], v[240:243]
ds_read_b128 v[40:43], v4 offset:16384
s_waitcnt lgkmcnt(4)
v_mfma_f32_16x16x32_bf16 v[224:227], v[56:59], v[24:27], v[224:227]
v_mfma_f32_16x16x32_bf16 v[244:247], v[80:83], v[24:27], v[244:247]
ds_read_b128 v[44:47], v4 offset:17408
s_waitcnt lgkmcnt(4)
v_mfma_f32_16x16x32_bf16 v[228:231], v[56:59], v[28:31], v[228:231]
v_mfma_f32_16x16x32_bf16 v[248:251], v[80:83], v[28:31], v[248:251]
ds_read_b128 v[24:27], v4 offset:18432
s_waitcnt lgkmcnt(4)
v_mfma_f32_16x16x32_bf16 v[232:235], v[56:59], v[32:35], v[232:235]
v_mfma_f32_16x16x32_bf16 v[252:255], v[80:83], v[32:35], v[252:255]
ds_read_b128 v[28:31], v4 offset:19456
s_waitcnt lgkmcnt(4)
v_mfma_f32_16x16x32_bf16 v[216:219], v[60:63], v[36:39], v[216:219]
v_mfma_f32_16x16x32_bf16 v[236:239], v[84:87], v[36:39], v[236:239]
ds_read_b128 v[32:35], v4 offset:20480
s_waitcnt lgkmcnt(4)
v_mfma_f32_16x16x32_bf16 v[220:223], v[60:63], v[40:43], v[220:223]
v_mfma_f32_16x16x32_bf16 v[240:243], v[84:87], v[40:43], v[240:243]
ds_read_b128 v[36:39], v4 offset:21504
s_waitcnt lgkmcnt(4)
v_mfma_f32_16x16x32_bf16 v[224:227], v[60:63], v[44:47], v[224:227]
v_mfma_f32_16x16x32_bf16 v[244:247], v[84:87], v[44:47], v[244:247]
ds_read_b128 v[40:43], v4 offset:22528
s_waitcnt lgkmcnt(4)
v_mfma_f32_16x16x32_bf16 v[228:231], v[60:63], v[24:27], v[228:231]
v_mfma_f32_16x16x32_bf16 v[248:251], v[84:87], v[24:27], v[248:251]
s_add_u32 m0, s33, 0
s_add_u32 s61, s34, 0
buffer_load_dwordx4 v1, s[12:15], s61 offen offset:0 nt lds
ds_read_b128 v[44:47], v4 offset:23552
s_waitcnt lgkmcnt(4)
v_mfma_f32_16x16x32_bf16 v[232:235], v[60:63], v[28:31], v[232:235]
v_mfma_f32_16x16x32_bf16 v[252:255], v[84:87], v[28:31], v[252:255]
buffer_load_dwordx4 v2, s[12:15], s61 offen offset:1024 nt lds
ds_read_b128 v[24:27], v4 offset:24576
s_waitcnt lgkmcnt(4)
v_mfma_f32_16x16x32_bf16 v[216:219], v[64:67], v[32:35], v[216:219]
v_mfma_f32_16x16x32_bf16 v[236:239], v[88:91], v[32:35], v[236:239]
buffer_load_dwordx4 v3, s[12:15], s61 offen offset:2048 nt lds
ds_read_b128 v[28:31], v4 offset:25600
s_waitcnt lgkmcnt(4)
v_mfma_f32_16x16x32_bf16 v[220:223], v[64:67], v[36:39], v[220:223]
v_mfma_f32_16x16x32_bf16 v[240:243], v[88:91], v[36:39], v[240:243]
s_add_u32 m0, s33, 3072
s_add_u32 s61, s34, 3072
buffer_load_dwordx4 v1, s[12:15], s61 offen offset:0 nt lds
ds_read_b128 v[32:35], v4 offset:26624
s_waitcnt lgkmcnt(4)
v_mfma_f32_16x16x32_bf16 v[224:227], v[64:67], v[40:43], v[224:227]
v_mfma_f32_16x16x32_bf16 v[244:247], v[88:91], v[40:43], v[244:247]
buffer_load_dwordx4 v2, s[12:15], s61 offen offset:1024 nt lds
ds_read_b128 v[36:39], v4 offset:27648
s_waitcnt lgkmcnt(4)
v_mfma_f32_16x16x32_bf16 v[228:231], v[64:67], v[44:47], v[228:231]
v_mfma_f32_16x16x32_bf16 v[248:251], v[88:91], v[44:47], v[248:251]
buffer_load_dwordx4 v3, s[12:15], s61 offen offset:2048 nt lds
ds_read_b128 v[40:43], v4 offset:28672
s_waitcnt lgkmcnt(4)
v_mfma_f32_16x16x32_bf16 v[232:235], v[64:67], v[24:27], v[232:235]
v_mfma_f32_16x16x32_bf16 v[252:255], v[88:91], v[24:27], v[252:255]
s_add_u32 m0, s33, 6144
s_add_u32 s61, s34, 6144
buffer_load_dwordx4 v1, s[12:15], s61 offen offset:0 nt lds
ds_read_b128 v[44:47], v4 offset:29696
s_waitcnt lgkmcnt(4)
v_mfma_f32_16x16x32_bf16 v[216:219], v[68:71], v[28:31], v[216:219]
v_mfma_f32_16x16x32_bf16 v[236:239], v[92:95], v[28:31], v[236:239]
buffer_load_dwordx4 v2, s[12:15], s61 offen offset:1024 nt lds
s_waitcnt lgkmcnt(3)
v_mfma_f32_16x16x32_bf16 v[220:223], v[68:71], v[32:35], v[220:223]
v_mfma_f32_16x16x32_bf16 v[240:243], v[92:95], v[32:35], v[240:243]
buffer_load_dwordx4 v3, s[12:15], s61 offen offset:2048 nt lds
s_waitcnt lgkmcnt(2)
v_mfma_f32_16x16x32_bf16 v[224:227], v[68:71], v[36:39], v[224:227]
v_mfma_f32_16x16x32_bf16 v[244:247], v[92:95], v[36:39], v[244:247]
s_add_u32 m0, s33, 9216
s_add_u32 s61, s34, 9216
buffer_load_dwordx4 v1, s[12:15], s61 offen offset:0 nt lds
s_waitcnt lgkmcnt(1)
v_mfma_f32_16x16x32_bf16 v[228:231], v[68:71], v[40:43], v[228:231]
v_mfma_f32_16x16x32_bf16 v[248:251], v[92:95], v[40:43], v[248:251]
buffer_load_dwordx4 v2, s[12:15], s61 offen offset:1024 nt lds
s_waitcnt lgkmcnt(0)
v_mfma_f32_16x16x32_bf16 v[232:235], v[68:71], v[44:47], v[232:235]
v_mfma_f32_16x16x32_bf16 v[252:255], v[92:95], v[44:47], v[252:255]
buffer_load_dwordx4 v3, s[12:15], s61 offen offset:2048 nt lds
s_nop 7
v_max3_f32 v19, v19, v216, v217
v_max3_f32 v19, v19, v218, v219
v_max3_f32 v20, v20, v220, v221
v_max3_f32 v20, v20, v222, v223
v_max3_f32 v21, v21, v224, v225
v_max3_f32 v21, v21, v226, v227
v_max3_f32 v22, v22, v228, v229
v_max3_f32 v22, v22, v230, v231
v_max3_f32 v23, v23, v232, v233
v_max3_f32 v23, v23, v234, v235
v_max3_f32 v19, v19, v236, v237
v_max3_f32 v19, v19, v238, v239
v_max3_f32 v20, v20, v240, v241
v_max3_f32 v20, v20, v242, v243
v_max3_f32 v21, v21, v244, v245
v_max3_f32 v21, v21, v246, v247
v_max3_f32 v22, v22, v248, v249
v_max3_f32 v22, v22, v250, v251
v_max3_f32 v23, v23, v252, v253
v_max3_f32 v23, v23, v254, v255
s_add_u32 s60, s38, 1
s_and_b32 s60, s60, 3
s_xor_b32 s60, s60, s67
s_add_u32 s62, s38, 0
s_and_b32 s62, s62, 3
s_xor_b32 s62, s62, s67
s_mul_i32 s60, s60, 384
s_mul_i32 s62, s62, 245760
v_mbcnt_lo_u32_b32 v48, -1, 0
v_mbcnt_hi_u32_b32 v48, -1, v48
v_min_u32 v49, 29, v48
v_add_u32 v49, s66, v49
v_add_u32 v49, 0, v49
v_mul_u32_u24 v50, 21846, v49
v_lshrrev_b32 v50, 16, v50
v_lshlrev_b32 v49, 7, v49
v_mul_u32_u24 v50, 11904, v50
v_add_u32 v50, v50, v49
s_cmp_eq_u32 s38, 3
s_cbranch_scc1 .Lskq
buffer_load_dword v51, v50, s[16:19], s60 offen
.Lskq:
buffer_load_dword v52, v49, s[24:27], s62 offen
v_mov_b32 v24, v19
v_mov_b32 v25, v20
v_mov_b32 v26, v21
v_mov_b32 v27, v22
v_mov_b32 v28, v23
v_mov_b32 v30, v24
v_mov_b32 v31, v25
v_mov_b32 v32, v26
v_mov_b32 v33, v27
v_mov_b32 v34, v28
s_nop 1
v_permlane32_swap_b32 v24, v30
v_permlane32_swap_b32 v25, v31
v_permlane32_swap_b32 v26, v32
v_permlane32_swap_b32 v27, v33
v_permlane32_swap_b32 v28, v34
s_nop 1
v_max_f32 v24, v24, v30
v_max_f32 v25, v25, v31
v_max_f32 v26, v26, v32
v_max_f32 v27, v27, v33
v_max_f32 v28, v28, v34
v_mov_b32 v30, v24
v_mov_b32 v31, v25
v_mov_b32 v32, v26
v_mov_b32 v33, v27
v_mov_b32 v34, v28
s_nop 1
v_permlane16_swap_b32 v24, v30
v_permlane16_swap_b32 v25, v31
v_permlane16_swap_b32 v26, v32
v_permlane16_swap_b32 v27, v33
v_permlane16_swap_b32 v28, v34
s_nop 1
v_max_f32 v24, v24, v30
v_max_f32 v25, v25, v31
v_max_f32 v26, v26, v32
v_max_f32 v27, v27, v33
v_max_f32 v28, v28, v34
ds_write_b32 v17, v24 offset:0
ds_write_b32 v17, v25 offset:256
ds_write_b32 v17, v26 offset:512
ds_write_b32 v17, v27 offset:768
ds_write_b32 v17, v28 offset:1024
s_waitcnt lgkmcnt(0)
s_barrier
ds_read_b128 v[24:27], v18 offset:0
ds_read_b128 v[28:31], v18 offset:256
ds_read_b128 v[32:35], v18 offset:512
ds_read_b128 v[36:39], v18 offset:768
ds_read_b128 v[40:43], v18 offset:1024
v_mov_b32 v44, 0x3f803f80
v_mov_b32 v45, 0x3f803f80
v_mov_b32 v46, 0x3f803f80
v_mov_b32 v47, 0x3f803f80
s_waitcnt lgkmcnt(0)
v_max3_f32 v24, v24, v25, v26
v_max_f32 v24, v24, v27
v_mul_f32_e64 v19, -v24, s63
v_max3_f32 v28, v28, v29, v30
v_max_f32 v28, v28, v31
v_mul_f32_e64 v20, -v28, s63
v_max3_f32 v32, v32, v33, v34
v_max_f32 v32, v32, v35
v_mul_f32_e64 v21, -v32, s63
v_max3_f32 v36, v36, v37, v38
v_max_f32 v36, v36, v39
v_mul_f32_e64 v22, -v36, s63
v_max3_f32 v40, v40, v41, v42
v_max_f32 v40, v40, v43
v_mul_f32_e64 v23, -v40, s63
v_fma_f32 v96, v96, s63, v19
v_fma_f32 v97, v97, s63, v19
v_fma_f32 v98, v98, s63, v19
v_fma_f32 v99, v99, s63, v19
v_fma_f32 v116, v116, s63, v19
v_fma_f32 v117, v117, s63, v19
v_fma_f32 v118, v118, s63, v19
v_fma_f32 v119, v119, s63, v19
v_exp_f32 v96, v96
v_exp_f32 v97, v97
v_exp_f32 v98, v98
v_exp_f32 v99, v99
v_exp_f32 v116, v116
v_exp_f32 v117, v117
v_exp_f32 v118, v118
v_exp_f32 v119, v119
v_cvt_pk_bf16_f32 v96, v96, v97
v_cvt_pk_bf16_f32 v97, v98, v99
v_cvt_pk_bf16_f32 v98, v116, v117
v_cvt_pk_bf16_f32 v99, v118, v119
ds_write_b128 v0, v[96:99] offset:0
v_fma_f32 v100, v100, s63, v20
v_fma_f32 v101, v101, s63, v20
v_fma_f32 v102, v102, s63, v20
v_fma_f32 v103, v103, s63, v20
v_fma_f32 v120, v120, s63, v20
v_fma_f32 v121, v121, s63, v20
v_fma_f32 v122, v122, s63, v20
v_fma_f32 v123, v123, s63, v20
v_mfma_f32_16x16x32_bf16 v[24:27], v[44:47], v[96:99], 0
v_exp_f32 v100, v100
v_exp_f32 v101, v101
v_exp_f32 v102, v102
v_exp_f32 v103, v103
v_exp_f32 v120, v120
v_exp_f32 v121, v121
v_exp_f32 v122, v122
v_exp_f32 v123, v123
v_cvt_pk_bf16_f32 v100, v100, v101
v_cvt_pk_bf16_f32 v101, v102, v103
v_cvt_pk_bf16_f32 v102, v120, v121
v_cvt_pk_bf16_f32 v103, v122, v123
ds_write_b128 v0, v[100:103] offset:1024
v_fma_f32 v104, v104, s63, v21
v_fma_f32 v105, v105, s63, v21
v_fma_f32 v106, v106, s63, v21
v_fma_f32 v107, v107, s63, v21
v_fma_f32 v124, v124, s63, v21
v_fma_f32 v125, v125, s63, v21
v_fma_f32 v126, v126, s63, v21
v_fma_f32 v127, v127, s63, v21
v_mfma_f32_16x16x32_bf16 v[28:31], v[44:47], v[100:103], 0
v_exp_f32 v104, v104
v_exp_f32 v105, v105
v_exp_f32 v106, v106
v_exp_f32 v107, v107
v_exp_f32 v124, v124
v_exp_f32 v125, v125
v_exp_f32 v126, v126
v_exp_f32 v127, v127
v_cvt_pk_bf16_f32 v104, v104, v105
v_cvt_pk_bf16_f32 v105, v106, v107
v_cvt_pk_bf16_f32 v106, v124, v125
v_cvt_pk_bf16_f32 v107, v126, v127
ds_write_b128 v0, v[104:107] offset:2048
v_fma_f32 v108, v108, s63, v22
v_fma_f32 v109, v109, s63, v22
v_fma_f32 v110, v110, s63, v22
v_fma_f32 v111, v111, s63, v22
v_fma_f32 v128, v128, s63, v22
v_fma_f32 v129, v129, s63, v22
v_fma_f32 v130, v130, s63, v22
v_fma_f32 v131, v131, s63, v22
v_mfma_f32_16x16x32_bf16 v[32:35], v[44:47], v[104:107], 0
v_exp_f32 v108, v108
v_exp_f32 v109, v109
v_exp_f32 v110, v110
v_exp_f32 v111, v111
v_exp_f32 v128, v128
v_exp_f32 v129, v129
v_exp_f32 v130, v130
v_exp_f32 v131, v131
v_cvt_pk_bf16_f32 v108, v108, v109
v_cvt_pk_bf16_f32 v109, v110, v111
v_cvt_pk_bf16_f32 v110, v128, v129
v_cvt_pk_bf16_f32 v111, v130, v131
ds_write_b128 v0, v[108:111] offset:3072
v_fma_f32 v112, v112, s63, v23
v_fma_f32 v113, v113, s63, v23
v_fma_f32 v114, v114, s63, v23
v_fma_f32 v115, v115, s63, v23
v_fma_f32 v132, v132, s63, v23
v_fma_f32 v133, v133, s63, v23
v_fma_f32 v134, v134, s63, v23
v_fma_f32 v135, v135, s63, v23
v_mfma_f32_16x16x32_bf16 v[36:39], v[44:47], v[108:111], 0
v_exp_f32 v112, v112
v_exp_f32 v113, v113
v_exp_f32 v114, v114
v_exp_f32 v115, v115
v_exp_f32 v132, v132
v_exp_f32 v133, v133
v_exp_f32 v134, v134
v_exp_f32 v135, v135
v_cvt_pk_bf16_f32 v112, v112, v113
v_cvt_pk_bf16_f32 v113, v114, v115
v_cvt_pk_bf16_f32 v114, v132, v133
v_cvt_pk_bf16_f32 v115, v134, v135
ds_write_b128 v0, v[112:115] offset:4096
v_fma_f32 v136, v136, s63, v19
v_fma_f32 v137, v137, s63, v19
v_fma_f32 v138, v138, s63, v19
v_fma_f32 v139, v139, s63, v19
v_fma_f32 v156, v156, s63, v19
v_fma_f32 v157, v157, s63, v19
v_fma_f32 v158, v158, s63, v19
v_fma_f32 v159, v159, s63, v19
v_mfma_f32_16x16x32_bf16 v[40:43], v[44:47], v[112:115], 0
v_exp_f32 v136, v136
v_exp_f32 v137, v137
v_exp_f32 v138, v138
v_exp_f32 v139, v139
v_exp_f32 v156, v156
v_exp_f32 v157, v157
v_exp_f32 v158, v158
v_exp_f32 v159, v159
v_cvt_pk_bf16_f32 v136, v136, v137
v_cvt_pk_bf16_f32 v137, v138, v139
v_cvt_pk_bf16_f32 v138, v156, v157
v_cvt_pk_bf16_f32 v139, v158, v159
ds_write_b128 v0, v[136:139] offset:20480
v_fma_f32 v140, v140, s63, v20
v_fma_f32 v141, v141, s63, v20
v_fma_f32 v142, v142, s63, v20
v_fma_f32 v143, v143, s63, v20
v_fma_f32 v160, v160, s63, v20
v_fma_f32 v161, v161, s63, v20
v_fma_f32 v162, v162, s63, v20
v_fma_f32 v163, v163, s63, v20
v_mfma_f32_16x16x32_bf16 v[24:27], v[44:47], v[136:139], v[24:27]
v_exp_f32 v140, v140
v_exp_f32 v141, v141
v_exp_f32 v142, v142
v_exp_f32 v143, v143
v_exp_f32 v160, v160
v_exp_f32 v161, v161
v_exp_f32 v162, v162
v_exp_f32 v163, v163
v_cvt_pk_bf16_f32 v140, v140, v141
v_cvt_pk_bf16_f32 v141, v142, v143
v_cvt_pk_bf16_f32 v142, v160, v161
v_cvt_pk_bf16_f32 v143, v162, v163
ds_write_b128 v0, v[140:143] offset:21504
v_fma_f32 v144, v144, s63, v21
v_fma_f32 v145, v145, s63, v21
v_fma_f32 v146, v146, s63, v21
v_fma_f32 v147, v147, s63, v21
v_fma_f32 v164, v164, s63, v21
v_fma_f32 v165, v165, s63, v21
v_fma_f32 v166, v166, s63, v21
v_fma_f32 v167, v167, s63, v21
v_mfma_f32_16x16x32_bf16 v[28:31], v[44:47], v[140:143], v[28:31]
v_exp_f32 v144, v144
v_exp_f32 v145, v145
v_exp_f32 v146, v146
v_exp_f32 v147, v147
v_exp_f32 v164, v164
v_exp_f32 v165, v165
v_exp_f32 v166, v166
v_exp_f32 v167, v167
v_cvt_pk_bf16_f32 v144, v144, v145
v_cvt_pk_bf16_f32 v145, v146, v147
v_cvt_pk_bf16_f32 v146, v164, v165
v_cvt_pk_bf16_f32 v147, v166, v167
ds_write_b128 v0, v[144:147] offset:22528
v_fma_f32 v148, v148, s63, v22
v_fma_f32 v149, v149, s63, v22
v_fma_f32 v150, v150, s63, v22
v_fma_f32 v151, v151, s63, v22
v_fma_f32 v168, v168, s63, v22
v_fma_f32 v169, v169, s63, v22
v_fma_f32 v170, v170, s63, v22
v_fma_f32 v171, v171, s63, v22
v_mfma_f32_16x16x32_bf16 v[32:35], v[44:47], v[144:147], v[32:35]
v_exp_f32 v148, v148
v_exp_f32 v149, v149
v_exp_f32 v150, v150
v_exp_f32 v151, v151
v_exp_f32 v168, v168
v_exp_f32 v169, v169
v_exp_f32 v170, v170
v_exp_f32 v171, v171
v_cvt_pk_bf16_f32 v148, v148, v149
v_cvt_pk_bf16_f32 v149, v150, v151
v_cvt_pk_bf16_f32 v150, v168, v169
v_cvt_pk_bf16_f32 v151, v170, v171
ds_write_b128 v0, v[148:151] offset:23552
v_fma_f32 v152, v152, s63, v23
v_fma_f32 v153, v153, s63, v23
v_fma_f32 v154, v154, s63, v23
v_fma_f32 v155, v155, s63, v23
v_fma_f32 v172, v172, s63, v23
v_fma_f32 v173, v173, s63, v23
v_fma_f32 v174, v174, s63, v23
v_fma_f32 v175, v175, s63, v23
v_mfma_f32_16x16x32_bf16 v[36:39], v[44:47], v[148:151], v[36:39]
v_exp_f32 v152, v152
v_exp_f32 v153, v153
v_exp_f32 v154, v154
v_exp_f32 v155, v155
v_exp_f32 v172, v172
v_exp_f32 v173, v173
v_exp_f32 v174, v174
v_exp_f32 v175, v175
v_cvt_pk_bf16_f32 v152, v152, v153
v_cvt_pk_bf16_f32 v153, v154, v155
v_cvt_pk_bf16_f32 v154, v172, v173
v_cvt_pk_bf16_f32 v155, v174, v175
ds_write_b128 v0, v[152:155] offset:24576
v_fma_f32 v176, v176, s63, v19
v_fma_f32 v177, v177, s63, v19
v_fma_f32 v178, v178, s63, v19
v_fma_f32 v179, v179, s63, v19
v_fma_f32 v196, v196, s63, v19
v_fma_f32 v197, v197, s63, v19
v_fma_f32 v198, v198, s63, v19
v_fma_f32 v199, v199, s63, v19
v_mfma_f32_16x16x32_bf16 v[40:43], v[44:47], v[152:155], v[40:43]
v_exp_f32 v176, v176
v_exp_f32 v177, v177
v_exp_f32 v178, v178
v_exp_f32 v179, v179
v_exp_f32 v196, v196
v_exp_f32 v197, v197
v_exp_f32 v198, v198
v_exp_f32 v199, v199
v_cvt_pk_bf16_f32 v56, v176, v177
v_cvt_pk_bf16_f32 v57, v178, v179
v_cvt_pk_bf16_f32 v58, v196, v197
v_cvt_pk_bf16_f32 v59, v198, v199
v_fma_f32 v180, v180, s63, v20
v_fma_f32 v181, v181, s63, v20
v_fma_f32 v182, v182, s63, v20
v_fma_f32 v183, v183, s63, v20
v_fma_f32 v200, v200, s63, v20
v_fma_f32 v201, v201, s63, v20
v_fma_f32 v202, v202, s63, v20
v_fma_f32 v203, v203, s63, v20
v_mfma_f32_16x16x32_bf16 v[24:27], v[44:47], v[56:59], v[24:27]
v_exp_f32 v180, v180
v_exp_f32 v181, v181
v_exp_f32 v182, v182
v_exp_f32 v183, v183
v_exp_f32 v200, v200
v_exp_f32 v201, v201
v_exp_f32 v202, v202
v_exp_f32 v203, v203
v_cvt_pk_bf16_f32 v60, v180, v181
v_cvt_pk_bf16_f32 v61, v182, v183
v_cvt_pk_bf16_f32 v62, v200, v201
v_cvt_pk_bf16_f32 v63, v202, v203
v_fma_f32 v184, v184, s63, v21
v_fma_f32 v185, v185, s63, v21
v_fma_f32 v186, v186, s63, v21
v_fma_f32 v187, v187, s63, v21
v_fma_f32 v204, v204, s63, v21
v_fma_f32 v205, v205, s63, v21
v_fma_f32 v206, v206, s63, v21
v_fma_f32 v207, v207, s63, v21
v_mfma_f32_16x16x32_bf16 v[28:31], v[44:47], v[60:63], v[28:31]
v_exp_f32 v184, v184
v_exp_f32 v185, v185
v_exp_f32 v186, v186
v_exp_f32 v187, v187
v_exp_f32 v204, v204
v_exp_f32 v205, v205
v_exp_f32 v206, v206
v_exp_f32 v207, v207
v_cvt_pk_bf16_f32 v64, v184, v185
v_cvt_pk_bf16_f32 v65, v186, v187
v_cvt_pk_bf16_f32 v66, v204, v205
v_cvt_pk_bf16_f32 v67, v206, v207
v_fma_f32 v188, v188, s63, v22
v_fma_f32 v189, v189, s63, v22
v_fma_f32 v190, v190, s63, v22
v_fma_f32 v191, v191, s63, v22
v_fma_f32 v208, v208, s63, v22
v_fma_f32 v209, v209, s63, v22
v_fma_f32 v210, v210, s63, v22
v_fma_f32 v211, v211, s63, v22
v_mfma_f32_16x16x32_bf16 v[32:35], v[44:47], v[64:67], v[32:35]
v_exp_f32 v188, v188
v_exp_f32 v189, v189
v_exp_f32 v190, v190
v_exp_f32 v191, v191
v_exp_f32 v208, v208
v_exp_f32 v209, v209
v_exp_f32 v210, v210
v_exp_f32 v211, v211
v_cvt_pk_bf16_f32 v68, v188, v189
v_cvt_pk_bf16_f32 v69, v190, v191
v_cvt_pk_bf16_f32 v70, v208, v209
v_cvt_pk_bf16_f32 v71, v210, v211
v_fma_f32 v192, v192, s63, v23
v_fma_f32 v193, v193, s63, v23
v_fma_f32 v194, v194, s63, v23
v_fma_f32 v195, v195, s63, v23
v_fma_f32 v212, v212, s63, v23
v_fma_f32 v213, v213, s63, v23
v_fma_f32 v214, v214, s63, v23
v_fma_f32 v215, v215, s63, v23
v_mfma_f32_16x16x32_bf16 v[36:39], v[44:47], v[68:71], v[36:39]
v_exp_f32 v192, v192
v_exp_f32 v193, v193
v_exp_f32 v194, v194
v_exp_f32 v195, v195
v_exp_f32 v212, v212
v_exp_f32 v213, v213
v_exp_f32 v214, v214
v_exp_f32 v215, v215
v_cvt_pk_bf16_f32 v72, v192, v193
v_cvt_pk_bf16_f32 v73, v194, v195
v_cvt_pk_bf16_f32 v74, v212, v213
v_cvt_pk_bf16_f32 v75, v214, v215
v_fma_f32 v216, v216, s63, v19
v_fma_f32 v217, v217, s63, v19
v_fma_f32 v218, v218, s63, v19
v_fma_f32 v219, v219, s63, v19
v_fma_f32 v236, v236, s63, v19
v_fma_f32 v237, v237, s63, v19
v_fma_f32 v238, v238, s63, v19
v_fma_f32 v239, v239, s63, v19
v_mfma_f32_16x16x32_bf16 v[40:43], v[44:47], v[72:75], v[40:43]
v_exp_f32 v216, v216
v_exp_f32 v217, v217
v_exp_f32 v218, v218
v_exp_f32 v219, v219
v_exp_f32 v236, v236
v_exp_f32 v237, v237
v_exp_f32 v238, v238
v_exp_f32 v239, v239
v_cvt_pk_bf16_f32 v76, v216, v217
v_cvt_pk_bf16_f32 v77, v218, v219
v_cvt_pk_bf16_f32 v78, v236, v237
v_cvt_pk_bf16_f32 v79, v238, v239
v_fma_f32 v220, v220, s63, v20
v_fma_f32 v221, v221, s63, v20
v_fma_f32 v222, v222, s63, v20
v_fma_f32 v223, v223, s63, v20
v_fma_f32 v240, v240, s63, v20
v_fma_f32 v241, v241, s63, v20
v_fma_f32 v242, v242, s63, v20
v_fma_f32 v243, v243, s63, v20
v_mfma_f32_16x16x32_bf16 v[24:27], v[44:47], v[76:79], v[24:27]
v_exp_f32 v220, v220
v_exp_f32 v221, v221
v_exp_f32 v222, v222
v_exp_f32 v223, v223
v_exp_f32 v240, v240
v_exp_f32 v241, v241
v_exp_f32 v242, v242
v_exp_f32 v243, v243
v_cvt_pk_bf16_f32 v80, v220, v221
v_cvt_pk_bf16_f32 v81, v222, v223
v_cvt_pk_bf16_f32 v82, v240, v241
v_cvt_pk_bf16_f32 v83, v242, v243
v_fma_f32 v224, v224, s63, v21
v_fma_f32 v225, v225, s63, v21
v_fma_f32 v226, v226, s63, v21
v_fma_f32 v227, v227, s63, v21
v_fma_f32 v244, v244, s63, v21
v_fma_f32 v245, v245, s63, v21
v_fma_f32 v246, v246, s63, v21
v_fma_f32 v247, v247, s63, v21
v_mfma_f32_16x16x32_bf16 v[28:31], v[44:47], v[80:83], v[28:31]
v_exp_f32 v224, v224
v_exp_f32 v225, v225
v_exp_f32 v226, v226
v_exp_f32 v227, v227
v_exp_f32 v244, v244
v_exp_f32 v245, v245
v_exp_f32 v246, v246
v_exp_f32 v247, v247
v_cvt_pk_bf16_f32 v84, v224, v225
v_cvt_pk_bf16_f32 v85, v226, v227
v_cvt_pk_bf16_f32 v86, v244, v245
v_cvt_pk_bf16_f32 v87, v246, v247
v_fma_f32 v228, v228, s63, v22
v_fma_f32 v229, v229, s63, v22
v_fma_f32 v230, v230, s63, v22
v_fma_f32 v231, v231, s63, v22
v_fma_f32 v248, v248, s63, v22
v_fma_f32 v249, v249, s63, v22
v_fma_f32 v250, v250, s63, v22
v_fma_f32 v251, v251, s63, v22
v_mfma_f32_16x16x32_bf16 v[32:35], v[44:47], v[84:87], v[32:35]
v_exp_f32 v228, v228
v_exp_f32 v229, v229
v_exp_f32 v230, v230
v_exp_f32 v231, v231
v_exp_f32 v248, v248
v_exp_f32 v249, v249
v_exp_f32 v250, v250
v_exp_f32 v251, v251
v_cvt_pk_bf16_f32 v88, v228, v229
v_cvt_pk_bf16_f32 v89, v230, v231
v_cvt_pk_bf16_f32 v90, v248, v249
v_cvt_pk_bf16_f32 v91, v250, v251
v_fma_f32 v232, v232, s63, v23
v_fma_f32 v233, v233, s63, v23
v_fma_f32 v234, v234, s63, v23
v_fma_f32 v235, v235, s63, v23
v_fma_f32 v252, v252, s63, v23
v_fma_f32 v253, v253, s63, v23
v_fma_f32 v254, v254, s63, v23
v_fma_f32 v255, v255, s63, v23
v_mfma_f32_16x16x32_bf16 v[36:39], v[44:47], v[88:91], v[36:39]
v_exp_f32 v232, v232
v_exp_f32 v233, v233
v_exp_f32 v234, v234
v_exp_f32 v235, v235
v_exp_f32 v252, v252
v_exp_f32 v253, v253
v_exp_f32 v254, v254
v_exp_f32 v255, v255
v_cvt_pk_bf16_f32 v92, v232, v233
v_cvt_pk_bf16_f32 v93, v234, v235
v_cvt_pk_bf16_f32 v94, v252, v253
v_cvt_pk_bf16_f32 v95, v254, v255
s_nop 1
v_mfma_f32_16x16x32_bf16 v[40:43], v[44:47], v[92:95], v[40:43]
s_nop 7
ds_write_b32 v17, v24 offset:1280
ds_write_b32 v17, v28 offset:1536
ds_write_b32 v17, v32 offset:1792
ds_write_b32 v17, v36 offset:2048
ds_write_b32 v17, v40 offset:2304
s_waitcnt vmcnt(0)
s_cmp_eq_u32 s38, 3
s_cbranch_scc1 .LA_last
v_xor_b32 v248, 64, v5
s_waitcnt lgkmcnt(0)
s_barrier
ds_read_b64_tr_b16 v[216:217], v8 offset:0
ds_read_b64_tr_b16 v[218:219], v8 offset:6144
ds_read_b128 v[228:231], v4 offset:0
ds_read_b128 v[232:235], v4 offset:1024
ds_read_b128 v[236:239], v4 offset:2048
ds_read_b128 v[240:243], v4 offset:3072
ds_read_b128 v[244:247], v4 offset:4096
ds_read_b64_tr_b16 v[220:221], v9 offset:0
ds_read_b64_tr_b16 v[222:223], v9 offset:6144
ds_read_b64_tr_b16 v[224:225], v10 offset:0
ds_read_b64_tr_b16 v[226:227], v10 offset:6144
s_waitcnt lgkmcnt(0)
s_barrier
v_mfma_f32_16x16x32_bf16 v[96:99], v[216:219], v[228:231], 0
ds_read_b64_tr_b16 v[24:25], v8 offset:12288
v_mfma_f32_16x16x32_bf16 v[100:103], v[216:219], v[232:235], 0
ds_read_b64_tr_b16 v[26:27], v8 offset:18432
v_mfma_f32_16x16x32_bf16 v[104:107], v[216:219], v[236:239], 0
ds_read_b128 v[36:39], v4 offset:5120
v_mfma_f32_16x16x32_bf16 v[108:111], v[216:219], v[240:243], 0
ds_read_b128 v[40:43], v4 offset:6144
v_mfma_f32_16x16x32_bf16 v[112:115], v[216:219], v[244:247], 0
ds_read_b128 v[44:47], v4 offset:7168
v_mfma_f32_16x16x32_bf16 v[116:119], v[220:223], v[228:231], 0
ds_read_b128 v[48:51], v4 offset:8192
v_mfma_f32_16x16x32_bf16 v[120:123], v[220:223], v[232:235], 0
ds_read_b128 v[52:55], v4 offset:9216
v_mfma_f32_16x16x32_bf16 v[124:127], v[220:223], v[236:239], 0
ds_read_b64_tr_b16 v[28:29], v9 offset:12288
v_mfma_f32_16x16x32_bf16 v[128:131], v[220:223], v[240:243], 0
ds_read_b64_tr_b16 v[30:31], v9 offset:18432
v_mfma_f32_16x16x32_bf16 v[132:135], v[220:223], v[244:247], 0
ds_read_b64_tr_b16 v[32:33], v10 offset:12288
v_mfma_f32_16x16x32_bf16 v[136:139], v[224:227], v[228:231], 0
ds_read_b64_tr_b16 v[34:35], v10 offset:18432
v_mfma_f32_16x16x32_bf16 v[140:143], v[224:227], v[232:235], 0
v_mfma_f32_16x16x32_bf16 v[144:147], v[224:227], v[236:239], 0
v_mfma_f32_16x16x32_bf16 v[148:151], v[224:227], v[240:243], 0
v_mfma_f32_16x16x32_bf16 v[152:155], v[224:227], v[244:247], 0
s_waitcnt lgkmcnt(0)
s_barrier
v_mfma_f32_16x16x32_bf16 v[96:99], v[24:27], v[36:39], v[96:99]
ds_read_b64_tr_b16 v[216:217], v11 offset:0
v_mfma_f32_16x16x32_bf16 v[100:103], v[24:27], v[40:43], v[100:103]
ds_read_b64_tr_b16 v[218:219], v11 offset:1536
v_mfma_f32_16x16x32_bf16 v[104:107], v[24:27], v[44:47], v[104:107]
ds_read_b128 v[228:231], v5 offset:0
v_mfma_f32_16x16x32_bf16 v[108:111], v[24:27], v[48:51], v[108:111]
ds_read_b128 v[232:235], v5 offset:2048
v_mfma_f32_16x16x32_bf16 v[112:115], v[24:27], v[52:55], v[112:115]
ds_read_b128 v[236:239], v5 offset:4096
v_mfma_f32_16x16x32_bf16 v[116:119], v[28:31], v[36:39], v[116:119]
ds_read_b128 v[240:243], v5 offset:6144
v_mfma_f32_16x16x32_bf16 v[120:123], v[28:31], v[40:43], v[120:123]
ds_read_b128 v[244:247], v5 offset:8192
v_mfma_f32_16x16x32_bf16 v[124:127], v[28:31], v[44:47], v[124:127]
ds_read_b64_tr_b16 v[220:221], v12 offset:0
v_mfma_f32_16x16x32_bf16 v[128:131], v[28:31], v[48:51], v[128:131]
ds_read_b64_tr_b16 v[222:223], v12 offset:1536
v_mfma_f32_16x16x32_bf16 v[132:135], v[28:31], v[52:55], v[132:135]
ds_read_b64_tr_b16 v[224:225], v13 offset:0
v_mfma_f32_16x16x32_bf16 v[136:139], v[32:35], v[36:39], v[136:139]
ds_read_b64_tr_b16 v[226:227], v13 offset:1536
v_mfma_f32_16x16x32_bf16 v[140:143], v[32:35], v[40:43], v[140:143]
v_mfma_f32_16x16x32_bf16 v[144:147], v[32:35], v[44:47], v[144:147]
v_mfma_f32_16x16x32_bf16 v[148:151], v[32:35], v[48:51], v[148:151]
v_mfma_f32_16x16x32_bf16 v[152:155], v[32:35], v[52:55], v[152:155]
s_waitcnt lgkmcnt(0)
s_barrier
v_mfma_f32_16x16x32_bf16 v[156:159], v[216:219], v[228:231], 0
ds_read_b64_tr_b16 v[24:25], v11 offset:12288
v_mfma_f32_16x16x32_bf16 v[160:163], v[216:219], v[232:235], 0
ds_read_b64_tr_b16 v[26:27], v11 offset:13824
v_mfma_f32_16x16x32_bf16 v[164:167], v[216:219], v[236:239], 0
ds_read_b128 v[36:39], v248 offset:0
v_mfma_f32_16x16x32_bf16 v[168:171], v[216:219], v[240:243], 0
ds_read_b128 v[40:43], v248 offset:2048
v_mfma_f32_16x16x32_bf16 v[172:175], v[216:219], v[244:247], 0
ds_read_b128 v[44:47], v248 offset:4096
v_mfma_f32_16x16x32_bf16 v[176:179], v[220:223], v[228:231], 0
ds_read_b128 v[48:51], v248 offset:6144
v_mfma_f32_16x16x32_bf16 v[180:183], v[220:223], v[232:235], 0
ds_read_b128 v[52:55], v248 offset:8192
v_mfma_f32_16x16x32_bf16 v[184:187], v[220:223], v[236:239], 0
ds_read_b64_tr_b16 v[28:29], v12 offset:12288
v_mfma_f32_16x16x32_bf16 v[188:191], v[220:223], v[240:243], 0
ds_read_b64_tr_b16 v[30:31], v12 offset:13824
v_mfma_f32_16x16x32_bf16 v[192:195], v[220:223], v[244:247], 0
ds_read_b64_tr_b16 v[32:33], v13 offset:12288
v_mfma_f32_16x16x32_bf16 v[196:199], v[224:227], v[228:231], 0
ds_read_b64_tr_b16 v[34:35], v13 offset:13824
v_mfma_f32_16x16x32_bf16 v[200:203], v[224:227], v[232:235], 0
v_mfma_f32_16x16x32_bf16 v[204:207], v[224:227], v[236:239], 0
v_mfma_f32_16x16x32_bf16 v[208:211], v[224:227], v[240:243], 0
v_mfma_f32_16x16x32_bf16 v[212:215], v[224:227], v[244:247], 0
s_waitcnt lgkmcnt(0)
s_barrier
v_mfma_f32_16x16x32_bf16 v[156:159], v[24:27], v[36:39], v[156:159]
ds_read_b64_tr_b16 v[216:217], v11 offset:24576
v_mfma_f32_16x16x32_bf16 v[160:163], v[24:27], v[40:43], v[160:163]
ds_read_b64_tr_b16 v[218:219], v11 offset:26112
v_mfma_f32_16x16x32_bf16 v[164:167], v[24:27], v[44:47], v[164:167]
ds_read_b128 v[228:231], v5 offset:10240
v_mfma_f32_16x16x32_bf16 v[168:171], v[24:27], v[48:51], v[168:171]
ds_read_b128 v[232:235], v5 offset:12288
v_mfma_f32_16x16x32_bf16 v[172:175], v[24:27], v[52:55], v[172:175]
ds_read_b128 v[236:239], v5 offset:14336
v_mfma_f32_16x16x32_bf16 v[176:179], v[28:31], v[36:39], v[176:179]
ds_read_b128 v[240:243], v5 offset:16384
v_mfma_f32_16x16x32_bf16 v[180:183], v[28:31], v[40:43], v[180:183]
ds_read_b128 v[244:247], v5 offset:18432
v_mfma_f32_16x16x32_bf16 v[184:187], v[28:31], v[44:47], v[184:187]
ds_read_b64_tr_b16 v[220:221], v12 offset:24576
v_mfma_f32_16x16x32_bf16 v[188:191], v[28:31], v[48:51], v[188:191]
ds_read_b64_tr_b16 v[222:223], v12 offset:26112
v_mfma_f32_16x16x32_bf16 v[192:195], v[28:31], v[52:55], v[192:195]
ds_read_b64_tr_b16 v[224:225], v13 offset:24576
v_mfma_f32_16x16x32_bf16 v[196:199], v[32:35], v[36:39], v[196:199]
ds_read_b64_tr_b16 v[226:227], v13 offset:26112
v_mfma_f32_16x16x32_bf16 v[200:203], v[32:35], v[40:43], v[200:203]
v_mfma_f32_16x16x32_bf16 v[204:207], v[32:35], v[44:47], v[204:207]
v_mfma_f32_16x16x32_bf16 v[208:211], v[32:35], v[48:51], v[208:211]
v_mfma_f32_16x16x32_bf16 v[212:215], v[32:35], v[52:55], v[212:215]
s_waitcnt lgkmcnt(0)
s_barrier
v_mfma_f32_16x16x32_bf16 v[156:159], v[216:219], v[228:231], v[156:159]
ds_read_b64_tr_b16 v[24:25], v8 offset:24576
v_mfma_f32_16x16x32_bf16 v[160:163], v[216:219], v[232:235], v[160:163]
ds_read_b64_tr_b16 v[26:27], v8 offset:30720
v_mfma_f32_16x16x32_bf16 v[164:167], v[216:219], v[236:239], v[164:167]
ds_read_b128 v[36:39], v4 offset:10240
v_mfma_f32_16x16x32_bf16 v[168:171], v[216:219], v[240:243], v[168:171]
ds_read_b128 v[40:43], v4 offset:11264
v_mfma_f32_16x16x32_bf16 v[172:175], v[216:219], v[244:247], v[172:175]
ds_read_b128 v[44:47], v4 offset:12288
v_mfma_f32_16x16x32_bf16 v[176:179], v[220:223], v[228:231], v[176:179]
ds_read_b128 v[48:51], v4 offset:13312
v_mfma_f32_16x16x32_bf16 v[180:183], v[220:223], v[232:235], v[180:183]
ds_read_b128 v[52:55], v4 offset:14336
v_mfma_f32_16x16x32_bf16 v[184:187], v[220:223], v[236:239], v[184:187]
ds_read_b64_tr_b16 v[28:29], v9 offset:24576
v_mfma_f32_16x16x32_bf16 v[188:191], v[220:223], v[240:243], v[188:191]
ds_read_b64_tr_b16 v[30:31], v9 offset:30720
v_mfma_f32_16x16x32_bf16 v[192:195], v[220:223], v[244:247], v[192:195]
ds_read_b64_tr_b16 v[32:33], v10 offset:24576
v_mfma_f32_16x16x32_bf16 v[196:199], v[224:227], v[228:231], v[196:199]
ds_read_b64_tr_b16 v[34:35], v10 offset:30720
v_mfma_f32_16x16x32_bf16 v[200:203], v[224:227], v[232:235], v[200:203]
v_mfma_f32_16x16x32_bf16 v[204:207], v[224:227], v[236:239], v[204:207]
v_mfma_f32_16x16x32_bf16 v[208:211], v[224:227], v[240:243], v[208:211]
v_mfma_f32_16x16x32_bf16 v[212:215], v[224:227], v[244:247], v[212:215]
s_waitcnt lgkmcnt(0)
s_barrier
v_mfma_f32_16x16x32_bf16 v[96:99], v[24:27], v[36:39], v[96:99]
ds_read_b64_tr_b16 v[216:217], v8 offset:36864
v_mfma_f32_16x16x32_bf16 v[100:103], v[24:27], v[40:43], v[100:103]
ds_read_b64_tr_b16 v[218:219], v8 offset:43008
v_mfma_f32_16x16x32_bf16 v[104:107], v[24:27], v[44:47], v[104:107]
ds_read_b128 v[228:231], v4 offset:15360
v_mfma_f32_16x16x32_bf16 v[108:111], v[24:27], v[48:51], v[108:111]
ds_read_b128 v[232:235], v4 offset:16384
v_mfma_f32_16x16x32_bf16 v[112:115], v[24:27], v[52:55], v[112:115]
ds_read_b128 v[236:239], v4 offset:17408
v_mfma_f32_16x16x32_bf16 v[116:119], v[28:31], v[36:39], v[116:119]
ds_read_b128 v[240:243], v4 offset:18432
v_mfma_f32_16x16x32_bf16 v[120:123], v[28:31], v[40:43], v[120:123]
ds_read_b128 v[244:247], v4 offset:19456
v_mfma_f32_16x16x32_bf16 v[124:127], v[28:31], v[44:47], v[124:127]
ds_read_b64_tr_b16 v[220:221], v9 offset:36864
v_mfma_f32_16x16x32_bf16 v[128:131], v[28:31], v[48:51], v[128:131]
ds_read_b64_tr_b16 v[222:223], v9 offset:43008
v_mfma_f32_16x16x32_bf16 v[132:135], v[28:31], v[52:55], v[132:135]
ds_read_b64_tr_b16 v[224:225], v10 offset:36864
v_mfma_f32_16x16x32_bf16 v[136:139], v[32:35], v[36:39], v[136:139]
ds_read_b64_tr_b16 v[226:227], v10 offset:43008
v_mfma_f32_16x16x32_bf16 v[140:143], v[32:35], v[40:43], v[140:143]
v_mfma_f32_16x16x32_bf16 v[144:147], v[32:35], v[44:47], v[144:147]
v_mfma_f32_16x16x32_bf16 v[148:151], v[32:35], v[48:51], v[148:151]
v_mfma_f32_16x16x32_bf16 v[152:155], v[32:35], v[52:55], v[152:155]
s_waitcnt lgkmcnt(0)
s_barrier
v_mfma_f32_16x16x32_bf16 v[96:99], v[216:219], v[228:231], v[96:99]
ds_read_b64_tr_b16 v[24:25], v11 offset:36864
v_mfma_f32_16x16x32_bf16 v[100:103], v[216:219], v[232:235], v[100:103]
ds_read_b64_tr_b16 v[26:27], v11 offset:38400
v_mfma_f32_16x16x32_bf16 v[104:107], v[216:219], v[236:239], v[104:107]
ds_read_b128 v[36:39], v248 offset:10240
v_mfma_f32_16x16x32_bf16 v[108:111], v[216:219], v[240:243], v[108:111]
ds_read_b128 v[40:43], v248 offset:12288
v_mfma_f32_16x16x32_bf16 v[112:115], v[216:219], v[244:247], v[112:115]
ds_read_b128 v[44:47], v248 offset:14336
v_mfma_f32_16x16x32_bf16 v[116:119], v[220:223], v[228:231], v[116:119]
ds_read_b128 v[48:51], v248 offset:16384
v_mfma_f32_16x16x32_bf16 v[120:123], v[220:223], v[232:235], v[120:123]
ds_read_b128 v[52:55], v248 offset:18432
v_mfma_f32_16x16x32_bf16 v[124:127], v[220:223], v[236:239], v[124:127]
ds_read_b64_tr_b16 v[28:29], v12 offset:36864
v_mfma_f32_16x16x32_bf16 v[128:131], v[220:223], v[240:243], v[128:131]
ds_read_b64_tr_b16 v[30:31], v12 offset:38400
v_mfma_f32_16x16x32_bf16 v[132:135], v[220:223], v[244:247], v[132:135]
ds_read_b64_tr_b16 v[32:33], v13 offset:36864
v_mfma_f32_16x16x32_bf16 v[136:139], v[224:227], v[228:231], v[136:139]
ds_read_b64_tr_b16 v[34:35], v13 offset:38400
v_mfma_f32_16x16x32_bf16 v[140:143], v[224:227], v[232:235], v[140:143]
ds_write_b128 v0, v[56:59] offset:0
v_mfma_f32_16x16x32_bf16 v[144:147], v[224:227], v[236:239], v[144:147]
ds_write_b128 v0, v[60:63] offset:1024
v_mfma_f32_16x16x32_bf16 v[148:151], v[224:227], v[240:243], v[148:151]
ds_write_b128 v0, v[64:67] offset:2048
v_mfma_f32_16x16x32_bf16 v[152:155], v[224:227], v[244:247], v[152:155]
ds_write_b128 v0, v[68:71] offset:3072
ds_write_b128 v0, v[72:75] offset:4096
s_waitcnt lgkmcnt(0)
s_barrier
v_mfma_f32_16x16x32_bf16 v[156:159], v[24:27], v[36:39], v[156:159]
ds_read_b64_tr_b16 v[216:217], v11 offset:0
v_mfma_f32_16x16x32_bf16 v[160:163], v[24:27], v[40:43], v[160:163]
ds_read_b64_tr_b16 v[218:219], v11 offset:1536
v_mfma_f32_16x16x32_bf16 v[164:167], v[24:27], v[44:47], v[164:167]
ds_read_b128 v[228:231], v5 offset:0
v_mfma_f32_16x16x32_bf16 v[168:171], v[24:27], v[48:51], v[168:171]
ds_read_b128 v[232:235], v5 offset:2048
v_mfma_f32_16x16x32_bf16 v[172:175], v[24:27], v[52:55], v[172:175]
ds_read_b128 v[236:239], v5 offset:4096
v_mfma_f32_16x16x32_bf16 v[176:179], v[28:31], v[36:39], v[176:179]
ds_read_b128 v[240:243], v5 offset:6144
v_mfma_f32_16x16x32_bf16 v[180:183], v[28:31], v[40:43], v[180:183]
ds_read_b128 v[244:247], v5 offset:8192
v_mfma_f32_16x16x32_bf16 v[184:187], v[28:31], v[44:47], v[184:187]
ds_read_b64_tr_b16 v[220:221], v12 offset:0
v_mfma_f32_16x16x32_bf16 v[188:191], v[28:31], v[48:51], v[188:191]
ds_read_b64_tr_b16 v[222:223], v12 offset:1536
v_mfma_f32_16x16x32_bf16 v[192:195], v[28:31], v[52:55], v[192:195]
ds_read_b64_tr_b16 v[224:225], v13 offset:0
v_mfma_f32_16x16x32_bf16 v[196:199], v[32:35], v[36:39], v[196:199]
ds_read_b64_tr_b16 v[226:227], v13 offset:1536
v_mfma_f32_16x16x32_bf16 v[200:203], v[32:35], v[40:43], v[200:203]
v_mfma_f32_16x16x32_bf16 v[204:207], v[32:35], v[44:47], v[204:207]
v_mfma_f32_16x16x32_bf16 v[208:211], v[32:35], v[48:51], v[208:211]
v_mfma_f32_16x16x32_bf16 v[212:215], v[32:35], v[52:55], v[212:215]
s_waitcnt lgkmcnt(0)
s_barrier
v_mfma_f32_16x16x32_bf16 v[156:159], v[216:219], v[228:231], v[156:159]
ds_read_b64_tr_b16 v[24:25], v11 offset:12288
v_mfma_f32_16x16x32_bf16 v[160:163], v[216:219], v[232:235], v[160:163]
ds_read_b64_tr_b16 v[26:27], v11 offset:13824
v_mfma_f32_16x16x32_bf16 v[164:167], v[216:219], v[236:239], v[164:167]
ds_read_b128 v[36:39], v248 offset:0
v_mfma_f32_16x16x32_bf16 v[168:171], v[216:219], v[240:243], v[168:171]
ds_read_b128 v[40:43], v248 offset:2048
v_mfma_f32_16x16x32_bf16 v[172:175], v[216:219], v[244:247], v[172:175]
ds_read_b128 v[44:47], v248 offset:4096
v_mfma_f32_16x16x32_bf16 v[176:179], v[220:223], v[228:231], v[176:179]
ds_read_b128 v[48:51], v248 offset:6144
v_mfma_f32_16x16x32_bf16 v[180:183], v[220:223], v[232:235], v[180:183]
ds_read_b128 v[52:55], v248 offset:8192
v_mfma_f32_16x16x32_bf16 v[184:187], v[220:223], v[236:239], v[184:187]
ds_read_b64_tr_b16 v[28:29], v12 offset:12288
v_mfma_f32_16x16x32_bf16 v[188:191], v[220:223], v[240:243], v[188:191]
ds_read_b64_tr_b16 v[30:31], v12 offset:13824
v_mfma_f32_16x16x32_bf16 v[192:195], v[220:223], v[244:247], v[192:195]
ds_read_b64_tr_b16 v[32:33], v13 offset:12288
v_mfma_f32_16x16x32_bf16 v[196:199], v[224:227], v[228:231], v[196:199]
ds_read_b64_tr_b16 v[34:35], v13 offset:13824
v_mfma_f32_16x16x32_bf16 v[200:203], v[224:227], v[232:235], v[200:203]
v_mfma_f32_16x16x32_bf16 v[204:207], v[224:227], v[236:239], v[204:207]
v_mfma_f32_16x16x32_bf16 v[208:211], v[224:227], v[240:243], v[208:211]
v_mfma_f32_16x16x32_bf16 v[212:215], v[224:227], v[244:247], v[212:215]
s_waitcnt lgkmcnt(0)
s_barrier
v_mfma_f32_16x16x32_bf16 v[156:159], v[24:27], v[36:39], v[156:159]
ds_read_b64_tr_b16 v[216:217], v8 offset:0
v_mfma_f32_16x16x32_bf16 v[160:163], v[24:27], v[40:43], v[160:163]
ds_read_b64_tr_b16 v[218:219], v8 offset:6144
v_mfma_f32_16x16x32_bf16 v[164:167], v[24:27], v[44:47], v[164:167]
ds_read_b128 v[228:231], v4 offset:20480
v_mfma_f32_16x16x32_bf16 v[168:171], v[24:27], v[48:51], v[168:171]
ds_read_b128 v[232:235], v4 offset:21504
v_mfma_f32_16x16x32_bf16 v[172:175], v[24:27], v[52:55], v[172:175]
ds_read_b128 v[236:239], v4 offset:22528
v_mfma_f32_16x16x32_bf16 v[176:179], v[28:31], v[36:39], v[176:179]
ds_read_b128 v[240:243], v4 offset:23552
v_mfma_f32_16x16x32_bf16 v[180:183], v[28:31], v[40:43], v[180:183]
ds_read_b128 v[244:247], v4 offset:24576
v_mfma_f32_16x16x32_bf16 v[184:187], v[28:31], v[44:47], v[184:187]
ds_read_b64_tr_b16 v[220:221], v9 offset:0
v_mfma_f32_16x16x32_bf16 v[188:191], v[28:31], v[48:51], v[188:191]
ds_read_b64_tr_b16 v[222:223], v9 offset:6144
v_mfma_f32_16x16x32_bf16 v[192:195], v[28:31], v[52:55], v[192:195]
ds_read_b64_tr_b16 v[224:225], v10 offset:0
v_mfma_f32_16x16x32_bf16 v[196:199], v[32:35], v[36:39], v[196:199]
ds_read_b64_tr_b16 v[226:227], v10 offset:6144
v_mfma_f32_16x16x32_bf16 v[200:203], v[32:35], v[40:43], v[200:203]
v_mfma_f32_16x16x32_bf16 v[204:207], v[32:35], v[44:47], v[204:207]
v_mfma_f32_16x16x32_bf16 v[208:211], v[32:35], v[48:51], v[208:211]
v_mfma_f32_16x16x32_bf16 v[212:215], v[32:35], v[52:55], v[212:215]
s_waitcnt lgkmcnt(0)
s_barrier
v_mfma_f32_16x16x32_bf16 v[96:99], v[216:219], v[228:231], v[96:99]
ds_read_b64_tr_b16 v[24:25], v8 offset:12288
v_mfma_f32_16x16x32_bf16 v[100:103], v[216:219], v[232:235], v[100:103]
ds_read_b64_tr_b16 v[26:27], v8 offset:18432
v_mfma_f32_16x16x32_bf16 v[104:107], v[216:219], v[236:239], v[104:107]
ds_read_b128 v[36:39], v4 offset:25600
v_mfma_f32_16x16x32_bf16 v[108:111], v[216:219], v[240:243], v[108:111]
ds_read_b128 v[40:43], v4 offset:26624
v_mfma_f32_16x16x32_bf16 v[112:115], v[216:219], v[244:247], v[112:115]
ds_read_b128 v[44:47], v4 offset:27648
v_mfma_f32_16x16x32_bf16 v[116:119], v[220:223], v[228:231], v[116:119]
ds_read_b128 v[48:51], v4 offset:28672
v_mfma_f32_16x16x32_bf16 v[120:123], v[220:223], v[232:235], v[120:123]
ds_read_b128 v[52:55], v4 offset:29696
v_mfma_f32_16x16x32_bf16 v[124:127], v[220:223], v[236:239], v[124:127]
ds_read_b64_tr_b16 v[28:29], v9 offset:12288
v_mfma_f32_16x16x32_bf16 v[128:131], v[220:223], v[240:243], v[128:131]
ds_read_b64_tr_b16 v[30:31], v9 offset:18432
v_mfma_f32_16x16x32_bf16 v[132:135], v[220:223], v[244:247], v[132:135]
ds_read_b64_tr_b16 v[32:33], v10 offset:12288
v_mfma_f32_16x16x32_bf16 v[136:139], v[224:227], v[228:231], v[136:139]
ds_read_b64_tr_b16 v[34:35], v10 offset:18432
v_mfma_f32_16x16x32_bf16 v[140:143], v[224:227], v[232:235], v[140:143]
v_mfma_f32_16x16x32_bf16 v[144:147], v[224:227], v[236:239], v[144:147]
v_mfma_f32_16x16x32_bf16 v[148:151], v[224:227], v[240:243], v[148:151]
v_mfma_f32_16x16x32_bf16 v[152:155], v[224:227], v[244:247], v[152:155]
s_waitcnt lgkmcnt(0)
s_barrier
v_mfma_f32_16x16x32_bf16 v[96:99], v[24:27], v[36:39], v[96:99]
ds_read_b64_tr_b16 v[216:217], v11 offset:24576
v_mfma_f32_16x16x32_bf16 v[100:103], v[24:27], v[40:43], v[100:103]
ds_read_b64_tr_b16 v[218:219], v11 offset:26112
v_mfma_f32_16x16x32_bf16 v[104:107], v[24:27], v[44:47], v[104:107]
ds_read_b128 v[228:231], v5 offset:10240
v_mfma_f32_16x16x32_bf16 v[108:111], v[24:27], v[48:51], v[108:111]
ds_read_b128 v[232:235], v5 offset:12288
v_mfma_f32_16x16x32_bf16 v[112:115], v[24:27], v[52:55], v[112:115]
ds_read_b128 v[236:239], v5 offset:14336
v_mfma_f32_16x16x32_bf16 v[116:119], v[28:31], v[36:39], v[116:119]
ds_read_b128 v[240:243], v5 offset:16384
v_mfma_f32_16x16x32_bf16 v[120:123], v[28:31], v[40:43], v[120:123]
ds_read_b128 v[244:247], v5 offset:18432
v_mfma_f32_16x16x32_bf16 v[124:127], v[28:31], v[44:47], v[124:127]
ds_read_b64_tr_b16 v[220:221], v12 offset:24576
v_mfma_f32_16x16x32_bf16 v[128:131], v[28:31], v[48:51], v[128:131]
ds_read_b64_tr_b16 v[222:223], v12 offset:26112
v_mfma_f32_16x16x32_bf16 v[132:135], v[28:31], v[52:55], v[132:135]
ds_read_b64_tr_b16 v[224:225], v13 offset:24576
v_mfma_f32_16x16x32_bf16 v[136:139], v[32:35], v[36:39], v[136:139]
ds_read_b64_tr_b16 v[226:227], v13 offset:26112
v_mfma_f32_16x16x32_bf16 v[140:143], v[32:35], v[40:43], v[140:143]
v_mfma_f32_16x16x32_bf16 v[144:147], v[32:35], v[44:47], v[144:147]
v_mfma_f32_16x16x32_bf16 v[148:151], v[32:35], v[48:51], v[148:151]
v_mfma_f32_16x16x32_bf16 v[152:155], v[32:35], v[52:55], v[152:155]
s_waitcnt lgkmcnt(0)
s_barrier
v_mfma_f32_16x16x32_bf16 v[156:159], v[216:219], v[228:231], v[156:159]
ds_read_b64_tr_b16 v[24:25], v11 offset:36864
v_mfma_f32_16x16x32_bf16 v[160:163], v[216:219], v[232:235], v[160:163]
ds_read_b64_tr_b16 v[26:27], v11 offset:38400
v_mfma_f32_16x16x32_bf16 v[164:167], v[216:219], v[236:239], v[164:167]
ds_read_b128 v[36:39], v248 offset:10240
v_mfma_f32_16x16x32_bf16 v[168:171], v[216:219], v[240:243], v[168:171]
ds_read_b128 v[40:43], v248 offset:12288
v_mfma_f32_16x16x32_bf16 v[172:175], v[216:219], v[244:247], v[172:175]
ds_read_b128 v[44:47], v248 offset:14336
v_mfma_f32_16x16x32_bf16 v[176:179], v[220:223], v[228:231], v[176:179]
ds_read_b128 v[48:51], v248 offset:16384
v_mfma_f32_16x16x32_bf16 v[180:183], v[220:223], v[232:235], v[180:183]
ds_read_b128 v[52:55], v248 offset:18432
v_mfma_f32_16x16x32_bf16 v[184:187], v[220:223], v[236:239], v[184:187]
ds_read_b64_tr_b16 v[28:29], v12 offset:36864
v_mfma_f32_16x16x32_bf16 v[188:191], v[220:223], v[240:243], v[188:191]
ds_read_b64_tr_b16 v[30:31], v12 offset:38400
v_mfma_f32_16x16x32_bf16 v[192:195], v[220:223], v[244:247], v[192:195]
ds_read_b64_tr_b16 v[32:33], v13 offset:36864
v_mfma_f32_16x16x32_bf16 v[196:199], v[224:227], v[228:231], v[196:199]
ds_read_b64_tr_b16 v[34:35], v13 offset:38400
v_mfma_f32_16x16x32_bf16 v[200:203], v[224:227], v[232:235], v[200:203]
v_mfma_f32_16x16x32_bf16 v[204:207], v[224:227], v[236:239], v[204:207]
v_mfma_f32_16x16x32_bf16 v[208:211], v[224:227], v[240:243], v[208:211]
v_mfma_f32_16x16x32_bf16 v[212:215], v[224:227], v[244:247], v[212:215]
s_waitcnt lgkmcnt(0)
s_barrier
v_mfma_f32_16x16x32_bf16 v[156:159], v[24:27], v[36:39], v[156:159]
ds_read_b64_tr_b16 v[216:217], v11 offset:0
v_mfma_f32_16x16x32_bf16 v[160:163], v[24:27], v[40:43], v[160:163]
ds_read_b64_tr_b16 v[218:219], v11 offset:1536
v_mfma_f32_16x16x32_bf16 v[164:167], v[24:27], v[44:47], v[164:167]
ds_read_b128 v[228:231], v5 offset:0
v_mfma_f32_16x16x32_bf16 v[168:171], v[24:27], v[48:51], v[168:171]
ds_read_b128 v[232:235], v5 offset:2048
v_mfma_f32_16x16x32_bf16 v[172:175], v[24:27], v[52:55], v[172:175]
ds_read_b128 v[236:239], v5 offset:4096
v_mfma_f32_16x16x32_bf16 v[176:179], v[28:31], v[36:39], v[176:179]
ds_read_b128 v[240:243], v5 offset:6144
v_mfma_f32_16x16x32_bf16 v[180:183], v[28:31], v[40:43], v[180:183]
ds_read_b128 v[244:247], v5 offset:8192
v_mfma_f32_16x16x32_bf16 v[184:187], v[28:31], v[44:47], v[184:187]
ds_read_b64_tr_b16 v[220:221], v12 offset:0
v_mfma_f32_16x16x32_bf16 v[188:191], v[28:31], v[48:51], v[188:191]
ds_read_b64_tr_b16 v[222:223], v12 offset:1536
v_mfma_f32_16x16x32_bf16 v[192:195], v[28:31], v[52:55], v[192:195]
ds_read_b64_tr_b16 v[224:225], v13 offset:0
v_mfma_f32_16x16x32_bf16 v[196:199], v[32:35], v[36:39], v[196:199]
ds_read_b64_tr_b16 v[226:227], v13 offset:1536
v_mfma_f32_16x16x32_bf16 v[200:203], v[32:35], v[40:43], v[200:203]
v_mfma_f32_16x16x32_bf16 v[204:207], v[32:35], v[44:47], v[204:207]
v_mfma_f32_16x16x32_bf16 v[208:211], v[32:35], v[48:51], v[208:211]
v_mfma_f32_16x16x32_bf16 v[212:215], v[32:35], v[52:55], v[212:215]
s_waitcnt lgkmcnt(0)
s_barrier
v_mfma_f32_16x16x32_bf16 v[156:159], v[216:219], v[228:231], v[156:159]
ds_read_b64_tr_b16 v[24:25], v8 offset:24576
v_mfma_f32_16x16x32_bf16 v[160:163], v[216:219], v[232:235], v[160:163]
ds_read_b64_tr_b16 v[26:27], v8 offset:30720
v_mfma_f32_16x16x32_bf16 v[164:167], v[216:219], v[236:239], v[164:167]
ds_read_b128 v[36:39], v4 offset:30720
v_mfma_f32_16x16x32_bf16 v[168:171], v[216:219], v[240:243], v[168:171]
ds_read_b128 v[40:43], v4 offset:31744
v_mfma_f32_16x16x32_bf16 v[172:175], v[216:219], v[244:247], v[172:175]
ds_read_b128 v[44:47], v4 offset:32768
v_mfma_f32_16x16x32_bf16 v[176:179], v[220:223], v[228:231], v[176:179]
ds_read_b128 v[48:51], v4 offset:33792
v_mfma_f32_16x16x32_bf16 v[180:183], v[220:223], v[232:235], v[180:183]
ds_read_b128 v[52:55], v4 offset:34816
v_mfma_f32_16x16x32_bf16 v[184:187], v[220:223], v[236:239], v[184:187]
ds_read_b64_tr_b16 v[28:29], v9 offset:24576
v_mfma_f32_16x16x32_bf16 v[188:191], v[220:223], v[240:243], v[188:191]
ds_read_b64_tr_b16 v[30:31], v9 offset:30720
v_mfma_f32_16x16x32_bf16 v[192:195], v[220:223], v[244:247], v[192:195]
ds_read_b64_tr_b16 v[32:33], v10 offset:24576
v_mfma_f32_16x16x32_bf16 v[196:199], v[224:227], v[228:231], v[196:199]
ds_read_b64_tr_b16 v[34:35], v10 offset:30720
v_mfma_f32_16x16x32_bf16 v[200:203], v[224:227], v[232:235], v[200:203]
v_mfma_f32_16x16x32_bf16 v[204:207], v[224:227], v[236:239], v[204:207]
v_mfma_f32_16x16x32_bf16 v[208:211], v[224:227], v[240:243], v[208:211]
v_mfma_f32_16x16x32_bf16 v[212:215], v[224:227], v[244:247], v[212:215]
s_waitcnt lgkmcnt(0)
s_barrier
v_mfma_f32_16x16x32_bf16 v[96:99], v[24:27], v[36:39], v[96:99]
ds_read_b64_tr_b16 v[216:217], v8 offset:36864
v_mfma_f32_16x16x32_bf16 v[100:103], v[24:27], v[40:43], v[100:103]
ds_read_b64_tr_b16 v[218:219], v8 offset:43008
v_mfma_f32_16x16x32_bf16 v[104:107], v[24:27], v[44:47], v[104:107]
ds_read_b128 v[228:231], v4 offset:35840
v_mfma_f32_16x16x32_bf16 v[108:111], v[24:27], v[48:51], v[108:111]
ds_read_b128 v[232:235], v4 offset:36864
v_mfma_f32_16x16x32_bf16 v[112:115], v[24:27], v[52:55], v[112:115]
ds_read_b128 v[236:239], v4 offset:37888
v_mfma_f32_16x16x32_bf16 v[116:119], v[28:31], v[36:39], v[116:119]
ds_read_b128 v[240:243], v4 offset:38912
v_mfma_f32_16x16x32_bf16 v[120:123], v[28:31], v[40:43], v[120:123]
ds_read_b128 v[244:247], v4 offset:39936
v_mfma_f32_16x16x32_bf16 v[124:127], v[28:31], v[44:47], v[124:127]
ds_read_b64_tr_b16 v[220:221], v9 offset:36864
v_mfma_f32_16x16x32_bf16 v[128:131], v[28:31], v[48:51], v[128:131]
ds_read_b64_tr_b16 v[222:223], v9 offset:43008
v_mfma_f32_16x16x32_bf16 v[132:135], v[28:31], v[52:55], v[132:135]
ds_read_b64_tr_b16 v[224:225], v10 offset:36864
v_mfma_f32_16x16x32_bf16 v[136:139], v[32:35], v[36:39], v[136:139]
ds_read_b64_tr_b16 v[226:227], v10 offset:43008
v_mfma_f32_16x16x32_bf16 v[140:143], v[32:35], v[40:43], v[140:143]
v_mfma_f32_16x16x32_bf16 v[144:147], v[32:35], v[44:47], v[144:147]
v_mfma_f32_16x16x32_bf16 v[148:151], v[32:35], v[48:51], v[148:151]
v_mfma_f32_16x16x32_bf16 v[152:155], v[32:35], v[52:55], v[152:155]
s_waitcnt lgkmcnt(0)
s_barrier
v_mfma_f32_16x16x32_bf16 v[96:99], v[216:219], v[228:231], v[96:99]
ds_read_b64_tr_b16 v[24:25], v11 offset:12288
v_mfma_f32_16x16x32_bf16 v[100:103], v[216:219], v[232:235], v[100:103]
ds_read_b64_tr_b16 v[26:27], v11 offset:13824
v_mfma_f32_16x16x32_bf16 v[104:107], v[216:219], v[236:239], v[104:107]
ds_read_b128 v[36:39], v248 offset:0
v_mfma_f32_16x16x32_bf16 v[108:111], v[216:219], v[240:243], v[108:111]
ds_read_b128 v[40:43], v248 offset:2048
v_mfma_f32_16x16x32_bf16 v[112:115], v[216:219], v[244:247], v[112:115]
ds_read_b128 v[44:47], v248 offset:4096
v_mfma_f32_16x16x32_bf16 v[116:119], v[220:223], v[228:231], v[116:119]
ds_read_b128 v[48:51], v248 offset:6144
v_mfma_f32_16x16x32_bf16 v[120:123], v[220:223], v[232:235], v[120:123]
ds_read_b128 v[52:55], v248 offset:8192
v_mfma_f32_16x16x32_bf16 v[124:127], v[220:223], v[236:239], v[124:127]
ds_read_b64_tr_b16 v[28:29], v12 offset:12288
v_mfma_f32_16x16x32_bf16 v[128:131], v[220:223], v[240:243], v[128:131]
ds_read_b64_tr_b16 v[30:31], v12 offset:13824
v_mfma_f32_16x16x32_bf16 v[132:135], v[220:223], v[244:247], v[132:135]
ds_read_b64_tr_b16 v[32:33], v13 offset:12288
v_mfma_f32_16x16x32_bf16 v[136:139], v[224:227], v[228:231], v[136:139]
ds_read_b64_tr_b16 v[34:35], v13 offset:13824
v_mfma_f32_16x16x32_bf16 v[140:143], v[224:227], v[232:235], v[140:143]
ds_write_b128 v0, v[76:79] offset:20480
v_mfma_f32_16x16x32_bf16 v[144:147], v[224:227], v[236:239], v[144:147]
ds_write_b128 v0, v[80:83] offset:21504
v_mfma_f32_16x16x32_bf16 v[148:151], v[224:227], v[240:243], v[148:151]
ds_write_b128 v0, v[84:87] offset:22528
v_mfma_f32_16x16x32_bf16 v[152:155], v[224:227], v[244:247], v[152:155]
ds_write_b128 v0, v[88:91] offset:23552
ds_write_b128 v0, v[92:95] offset:24576
s_waitcnt lgkmcnt(0)
s_barrier
v_mfma_f32_16x16x32_bf16 v[156:159], v[24:27], v[36:39], v[156:159]
ds_read_b64_tr_b16 v[216:217], v11 offset:24576
v_mfma_f32_16x16x32_bf16 v[160:163], v[24:27], v[40:43], v[160:163]
ds_read_b64_tr_b16 v[218:219], v11 offset:26112
v_mfma_f32_16x16x32_bf16 v[164:167], v[24:27], v[44:47], v[164:167]
ds_read_b128 v[228:231], v5 offset:10240
v_mfma_f32_16x16x32_bf16 v[168:171], v[24:27], v[48:51], v[168:171]
ds_read_b128 v[232:235], v5 offset:12288
v_mfma_f32_16x16x32_bf16 v[172:175], v[24:27], v[52:55], v[172:175]
ds_read_b128 v[236:239], v5 offset:14336
v_mfma_f32_16x16x32_bf16 v[176:179], v[28:31], v[36:39], v[176:179]
ds_read_b128 v[240:243], v5 offset:16384
v_mfma_f32_16x16x32_bf16 v[180:183], v[28:31], v[40:43], v[180:183]
ds_read_b128 v[244:247], v5 offset:18432
v_mfma_f32_16x16x32_bf16 v[184:187], v[28:31], v[44:47], v[184:187]
ds_read_b64_tr_b16 v[220:221], v12 offset:24576
v_mfma_f32_16x16x32_bf16 v[188:191], v[28:31], v[48:51], v[188:191]
ds_read_b64_tr_b16 v[222:223], v12 offset:26112
v_mfma_f32_16x16x32_bf16 v[192:195], v[28:31], v[52:55], v[192:195]
ds_read_b64_tr_b16 v[224:225], v13 offset:24576
v_mfma_f32_16x16x32_bf16 v[196:199], v[32:35], v[36:39], v[196:199]
ds_read_b64_tr_b16 v[226:227], v13 offset:26112
v_mfma_f32_16x16x32_bf16 v[200:203], v[32:35], v[40:43], v[200:203]
v_mfma_f32_16x16x32_bf16 v[204:207], v[32:35], v[44:47], v[204:207]
v_mfma_f32_16x16x32_bf16 v[208:211], v[32:35], v[48:51], v[208:211]
v_mfma_f32_16x16x32_bf16 v[212:215], v[32:35], v[52:55], v[212:215]
s_waitcnt lgkmcnt(0)
s_barrier
v_mfma_f32_16x16x32_bf16 v[156:159], v[216:219], v[228:231], v[156:159]
ds_read_b64_tr_b16 v[24:25], v11 offset:36864
v_mfma_f32_16x16x32_bf16 v[160:163], v[216:219], v[232:235], v[160:163]
ds_read_b64_tr_b16 v[26:27], v11 offset:38400
v_mfma_f32_16x16x32_bf16 v[164:167], v[216:219], v[236:239], v[164:167]
ds_read_b128 v[36:39], v248 offset:10240
v_mfma_f32_16x16x32_bf16 v[168:171], v[216:219], v[240:243], v[168:171]
ds_read_b128 v[40:43], v248 offset:12288
v_mfma_f32_16x16x32_bf16 v[172:175], v[216:219], v[244:247], v[172:175]
ds_read_b128 v[44:47], v248 offset:14336
v_mfma_f32_16x16x32_bf16 v[176:179], v[220:223], v[228:231], v[176:179]
ds_read_b128 v[48:51], v248 offset:16384
v_mfma_f32_16x16x32_bf16 v[180:183], v[220:223], v[232:235], v[180:183]
ds_read_b128 v[52:55], v248 offset:18432
v_mfma_f32_16x16x32_bf16 v[184:187], v[220:223], v[236:239], v[184:187]
ds_read_b64_tr_b16 v[28:29], v12 offset:36864
v_mfma_f32_16x16x32_bf16 v[188:191], v[220:223], v[240:243], v[188:191]
ds_read_b64_tr_b16 v[30:31], v12 offset:38400
v_mfma_f32_16x16x32_bf16 v[192:195], v[220:223], v[244:247], v[192:195]
ds_read_b64_tr_b16 v[32:33], v13 offset:36864
v_mfma_f32_16x16x32_bf16 v[196:199], v[224:227], v[228:231], v[196:199]
ds_read_b64_tr_b16 v[34:35], v13 offset:38400
v_mfma_f32_16x16x32_bf16 v[200:203], v[224:227], v[232:235], v[200:203]
v_mfma_f32_16x16x32_bf16 v[204:207], v[224:227], v[236:239], v[204:207]
v_mfma_f32_16x16x32_bf16 v[208:211], v[224:227], v[240:243], v[208:211]
v_mfma_f32_16x16x32_bf16 v[212:215], v[224:227], v[244:247], v[212:215]
s_waitcnt lgkmcnt(0)
s_barrier
v_mfma_f32_16x16x32_bf16 v[156:159], v[24:27], v[36:39], v[156:159]
ds_read_b64_tr_b16 v[216:217], v8 offset:0
v_mfma_f32_16x16x32_bf16 v[160:163], v[24:27], v[40:43], v[160:163]
ds_read_b64_tr_b16 v[218:219], v8 offset:6144
v_mfma_f32_16x16x32_bf16 v[164:167], v[24:27], v[44:47], v[164:167]
ds_read_b128 v[228:231], v4 offset:0
v_mfma_f32_16x16x32_bf16 v[168:171], v[24:27], v[48:51], v[168:171]
ds_read_b128 v[232:235], v4 offset:1024
v_mfma_f32_16x16x32_bf16 v[172:175], v[24:27], v[52:55], v[172:175]
ds_read_b128 v[236:239], v4 offset:2048
v_mfma_f32_16x16x32_bf16 v[176:179], v[28:31], v[36:39], v[176:179]
ds_read_b128 v[240:243], v4 offset:3072
v_mfma_f32_16x16x32_bf16 v[180:183], v[28:31], v[40:43], v[180:183]
ds_read_b128 v[244:247], v4 offset:4096
v_mfma_f32_16x16x32_bf16 v[184:187], v[28:31], v[44:47], v[184:187]
ds_read_b64_tr_b16 v[220:221], v9 offset:0
v_mfma_f32_16x16x32_bf16 v[188:191], v[28:31], v[48:51], v[188:191]
ds_read_b64_tr_b16 v[222:223], v9 offset:6144
v_mfma_f32_16x16x32_bf16 v[192:195], v[28:31], v[52:55], v[192:195]
ds_read_b64_tr_b16 v[224:225], v10 offset:0
v_mfma_f32_16x16x32_bf16 v[196:199], v[32:35], v[36:39], v[196:199]
ds_read_b64_tr_b16 v[226:227], v10 offset:6144
v_mfma_f32_16x16x32_bf16 v[200:203], v[32:35], v[40:43], v[200:203]
v_mfma_f32_16x16x32_bf16 v[204:207], v[32:35], v[44:47], v[204:207]
v_mfma_f32_16x16x32_bf16 v[208:211], v[32:35], v[48:51], v[208:211]
v_mfma_f32_16x16x32_bf16 v[212:215], v[32:35], v[52:55], v[212:215]
s_waitcnt lgkmcnt(0)
s_barrier
v_mfma_f32_16x16x32_bf16 v[96:99], v[216:219], v[228:231], v[96:99]
ds_read_b64_tr_b16 v[24:25], v8 offset:12288
v_mfma_f32_16x16x32_bf16 v[100:103], v[216:219], v[232:235], v[100:103]
ds_read_b64_tr_b16 v[26:27], v8 offset:18432
v_mfma_f32_16x16x32_bf16 v[104:107], v[216:219], v[236:239], v[104:107]
ds_read_b128 v[36:39], v4 offset:5120
v_mfma_f32_16x16x32_bf16 v[108:111], v[216:219], v[240:243], v[108:111]
ds_read_b128 v[40:43], v4 offset:6144
v_mfma_f32_16x16x32_bf16 v[112:115], v[216:219], v[244:247], v[112:115]
ds_read_b128 v[44:47], v4 offset:7168
v_mfma_f32_16x16x32_bf16 v[116:119], v[220:223], v[228:231], v[116:119]
ds_read_b128 v[48:51], v4 offset:8192
v_mfma_f32_16x16x32_bf16 v[120:123], v[220:223], v[232:235], v[120:123]
ds_read_b128 v[52:55], v4 offset:9216
v_mfma_f32_16x16x32_bf16 v[124:127], v[220:223], v[236:239], v[124:127]
ds_read_b64_tr_b16 v[28:29], v9 offset:12288
v_mfma_f32_16x16x32_bf16 v[128:131], v[220:223], v[240:243], v[128:131]
ds_read_b64_tr_b16 v[30:31], v9 offset:18432
v_mfma_f32_16x16x32_bf16 v[132:135], v[220:223], v[244:247], v[132:135]
ds_read_b64_tr_b16 v[32:33], v10 offset:12288
v_mfma_f32_16x16x32_bf16 v[136:139], v[224:227], v[228:231], v[136:139]
ds_read_b64_tr_b16 v[34:35], v10 offset:18432
v_mfma_f32_16x16x32_bf16 v[140:143], v[224:227], v[232:235], v[140:143]
v_mfma_f32_16x16x32_bf16 v[144:147], v[224:227], v[236:239], v[144:147]
v_mfma_f32_16x16x32_bf16 v[148:151], v[224:227], v[240:243], v[148:151]
v_mfma_f32_16x16x32_bf16 v[152:155], v[224:227], v[244:247], v[152:155]
s_waitcnt lgkmcnt(0)
s_barrier
v_mfma_f32_16x16x32_bf16 v[96:99], v[24:27], v[36:39], v[96:99]
ds_read_b64_tr_b16 v[216:217], v11 offset:0
v_mfma_f32_16x16x32_bf16 v[100:103], v[24:27], v[40:43], v[100:103]
ds_read_b64_tr_b16 v[218:219], v11 offset:1536
v_mfma_f32_16x16x32_bf16 v[104:107], v[24:27], v[44:47], v[104:107]
ds_read_b128 v[228:231], v5 offset:0
v_mfma_f32_16x16x32_bf16 v[108:111], v[24:27], v[48:51], v[108:111]
ds_read_b128 v[232:235], v5 offset:2048
v_mfma_f32_16x16x32_bf16 v[112:115], v[24:27], v[52:55], v[112:115]
ds_read_b128 v[236:239], v5 offset:4096
v_mfma_f32_16x16x32_bf16 v[116:119], v[28:31], v[36:39], v[116:119]
ds_read_b128 v[240:243], v5 offset:6144
v_mfma_f32_16x16x32_bf16 v[120:123], v[28:31], v[40:43], v[120:123]
ds_read_b128 v[244:247], v5 offset:8192
v_mfma_f32_16x16x32_bf16 v[124:127], v[28:31], v[44:47], v[124:127]
ds_read_b64_tr_b16 v[220:221], v12 offset:0
v_mfma_f32_16x16x32_bf16 v[128:131], v[28:31], v[48:51], v[128:131]
ds_read_b64_tr_b16 v[222:223], v12 offset:1536
v_mfma_f32_16x16x32_bf16 v[132:135], v[28:31], v[52:55], v[132:135]
ds_read_b64_tr_b16 v[224:225], v13 offset:0
v_mfma_f32_16x16x32_bf16 v[136:139], v[32:35], v[36:39], v[136:139]
ds_read_b64_tr_b16 v[226:227], v13 offset:1536
v_mfma_f32_16x16x32_bf16 v[140:143], v[32:35], v[40:43], v[140:143]
v_mfma_f32_16x16x32_bf16 v[144:147], v[32:35], v[44:47], v[144:147]
v_mfma_f32_16x16x32_bf16 v[148:151], v[32:35], v[48:51], v[148:151]
v_mfma_f32_16x16x32_bf16 v[152:155], v[32:35], v[52:55], v[152:155]
s_waitcnt lgkmcnt(0)
s_barrier
v_mfma_f32_16x16x32_bf16 v[156:159], v[216:219], v[228:231], v[156:159]
ds_read_b64_tr_b16 v[24:25], v11 offset:12288
v_mfma_f32_16x16x32_bf16 v[160:163], v[216:219], v[232:235], v[160:163]
ds_read_b64_tr_b16 v[26:27], v11 offset:13824
v_mfma_f32_16x16x32_bf16 v[164:167], v[216:219], v[236:239], v[164:167]
ds_read_b128 v[36:39], v248 offset:0
v_mfma_f32_16x16x32_bf16 v[168:171], v[216:219], v[240:243], v[168:171]
ds_read_b128 v[40:43], v248 offset:2048
v_mfma_f32_16x16x32_bf16 v[172:175], v[216:219], v[244:247], v[172:175]
ds_read_b128 v[44:47], v248 offset:4096
v_mfma_f32_16x16x32_bf16 v[176:179], v[220:223], v[228:231], v[176:179]
ds_read_b128 v[48:51], v248 offset:6144
v_mfma_f32_16x16x32_bf16 v[180:183], v[220:223], v[232:235], v[180:183]
ds_read_b128 v[52:55], v248 offset:8192
v_mfma_f32_16x16x32_bf16 v[184:187], v[220:223], v[236:239], v[184:187]
ds_read_b64_tr_b16 v[28:29], v12 offset:12288
v_mfma_f32_16x16x32_bf16 v[188:191], v[220:223], v[240:243], v[188:191]
ds_read_b64_tr_b16 v[30:31], v12 offset:13824
v_mfma_f32_16x16x32_bf16 v[192:195], v[220:223], v[244:247], v[192:195]
ds_read_b64_tr_b16 v[32:33], v13 offset:12288
v_mfma_f32_16x16x32_bf16 v[196:199], v[224:227], v[228:231], v[196:199]
ds_read_b64_tr_b16 v[34:35], v13 offset:13824
v_mfma_f32_16x16x32_bf16 v[200:203], v[224:227], v[232:235], v[200:203]
v_mfma_f32_16x16x32_bf16 v[204:207], v[224:227], v[236:239], v[204:207]
v_mfma_f32_16x16x32_bf16 v[208:211], v[224:227], v[240:243], v[208:211]
v_mfma_f32_16x16x32_bf16 v[212:215], v[224:227], v[244:247], v[212:215]
s_waitcnt lgkmcnt(0)
s_barrier
v_mfma_f32_16x16x32_bf16 v[156:159], v[24:27], v[36:39], v[156:159]
ds_read_b64_tr_b16 v[216:217], v11 offset:24576
v_mfma_f32_16x16x32_bf16 v[160:163], v[24:27], v[40:43], v[160:163]
ds_read_b64_tr_b16 v[218:219], v11 offset:26112
v_mfma_f32_16x16x32_bf16 v[164:167], v[24:27], v[44:47], v[164:167]
ds_read_b128 v[228:231], v5 offset:10240
v_mfma_f32_16x16x32_bf16 v[168:171], v[24:27], v[48:51], v[168:171]
ds_read_b128 v[232:235], v5 offset:12288
v_mfma_f32_16x16x32_bf16 v[172:175], v[24:27], v[52:55], v[172:175]
ds_read_b128 v[236:239], v5 offset:14336
v_mfma_f32_16x16x32_bf16 v[176:179], v[28:31], v[36:39], v[176:179]
ds_read_b128 v[240:243], v5 offset:16384
v_mfma_f32_16x16x32_bf16 v[180:183], v[28:31], v[40:43], v[180:183]
ds_read_b128 v[244:247], v5 offset:18432
v_mfma_f32_16x16x32_bf16 v[184:187], v[28:31], v[44:47], v[184:187]
ds_read_b64_tr_b16 v[220:221], v12 offset:24576
v_mfma_f32_16x16x32_bf16 v[188:191], v[28:31], v[48:51], v[188:191]
ds_read_b64_tr_b16 v[222:223], v12 offset:26112
v_mfma_f32_16x16x32_bf16 v[192:195], v[28:31], v[52:55], v[192:195]
ds_read_b64_tr_b16 v[224:225], v13 offset:24576
v_mfma_f32_16x16x32_bf16 v[196:199], v[32:35], v[36:39], v[196:199]
ds_read_b64_tr_b16 v[226:227], v13 offset:26112
v_mfma_f32_16x16x32_bf16 v[200:203], v[32:35], v[40:43], v[200:203]
v_mfma_f32_16x16x32_bf16 v[204:207], v[32:35], v[44:47], v[204:207]
v_mfma_f32_16x16x32_bf16 v[208:211], v[32:35], v[48:51], v[208:211]
v_mfma_f32_16x16x32_bf16 v[212:215], v[32:35], v[52:55], v[212:215]
s_waitcnt lgkmcnt(0)
s_barrier
v_mfma_f32_16x16x32_bf16 v[156:159], v[216:219], v[228:231], v[156:159]
ds_read_b64_tr_b16 v[24:25], v8 offset:24576
v_mfma_f32_16x16x32_bf16 v[160:163], v[216:219], v[232:235], v[160:163]
ds_read_b64_tr_b16 v[26:27], v8 offset:30720
v_mfma_f32_16x16x32_bf16 v[164:167], v[216:219], v[236:239], v[164:167]
ds_read_b128 v[36:39], v4 offset:10240
v_mfma_f32_16x16x32_bf16 v[168:171], v[216:219], v[240:243], v[168:171]
ds_read_b128 v[40:43], v4 offset:11264
v_mfma_f32_16x16x32_bf16 v[172:175], v[216:219], v[244:247], v[172:175]
ds_read_b128 v[44:47], v4 offset:12288
v_mfma_f32_16x16x32_bf16 v[176:179], v[220:223], v[228:231], v[176:179]
ds_read_b128 v[48:51], v4 offset:13312
v_mfma_f32_16x16x32_bf16 v[180:183], v[220:223], v[232:235], v[180:183]
ds_read_b128 v[52:55], v4 offset:14336
v_mfma_f32_16x16x32_bf16 v[184:187], v[220:223], v[236:239], v[184:187]
ds_read_b64_tr_b16 v[28:29], v9 offset:24576
v_mfma_f32_16x16x32_bf16 v[188:191], v[220:223], v[240:243], v[188:191]
ds_read_b64_tr_b16 v[30:31], v9 offset:30720
v_mfma_f32_16x16x32_bf16 v[192:195], v[220:223], v[244:247], v[192:195]
ds_read_b64_tr_b16 v[32:33], v10 offset:24576
v_mfma_f32_16x16x32_bf16 v[196:199], v[224:227], v[228:231], v[196:199]
ds_read_b64_tr_b16 v[34:35], v10 offset:30720
v_mfma_f32_16x16x32_bf16 v[200:203], v[224:227], v[232:235], v[200:203]
v_mfma_f32_16x16x32_bf16 v[204:207], v[224:227], v[236:239], v[204:207]
v_mfma_f32_16x16x32_bf16 v[208:211], v[224:227], v[240:243], v[208:211]
v_mfma_f32_16x16x32_bf16 v[212:215], v[224:227], v[244:247], v[212:215]
s_waitcnt lgkmcnt(0)
s_barrier
v_mfma_f32_16x16x32_bf16 v[96:99], v[24:27], v[36:39], v[96:99]
ds_read_b64_tr_b16 v[216:217], v8 offset:36864
v_mfma_f32_16x16x32_bf16 v[100:103], v[24:27], v[40:43], v[100:103]
ds_read_b64_tr_b16 v[218:219], v8 offset:43008
v_mfma_f32_16x16x32_bf16 v[104:107], v[24:27], v[44:47], v[104:107]
ds_read_b128 v[228:231], v4 offset:15360
v_mfma_f32_16x16x32_bf16 v[108:111], v[24:27], v[48:51], v[108:111]
ds_read_b128 v[232:235], v4 offset:16384
v_mfma_f32_16x16x32_bf16 v[112:115], v[24:27], v[52:55], v[112:115]
ds_read_b128 v[236:239], v4 offset:17408
v_mfma_f32_16x16x32_bf16 v[116:119], v[28:31], v[36:39], v[116:119]
ds_read_b128 v[240:243], v4 offset:18432
v_mfma_f32_16x16x32_bf16 v[120:123], v[28:31], v[40:43], v[120:123]
ds_read_b128 v[244:247], v4 offset:19456
v_mfma_f32_16x16x32_bf16 v[124:127], v[28:31], v[44:47], v[124:127]
ds_read_b64_tr_b16 v[220:221], v9 offset:36864
v_mfma_f32_16x16x32_bf16 v[128:131], v[28:31], v[48:51], v[128:131]
ds_read_b64_tr_b16 v[222:223], v9 offset:43008
v_mfma_f32_16x16x32_bf16 v[132:135], v[28:31], v[52:55], v[132:135]
ds_read_b64_tr_b16 v[224:225], v10 offset:36864
v_mfma_f32_16x16x32_bf16 v[136:139], v[32:35], v[36:39], v[136:139]
ds_read_b64_tr_b16 v[226:227], v10 offset:43008
v_mfma_f32_16x16x32_bf16 v[140:143], v[32:35], v[40:43], v[140:143]
v_mfma_f32_16x16x32_bf16 v[144:147], v[32:35], v[44:47], v[144:147]
v_mfma_f32_16x16x32_bf16 v[148:151], v[32:35], v[48:51], v[148:151]
v_mfma_f32_16x16x32_bf16 v[152:155], v[32:35], v[52:55], v[152:155]
s_waitcnt lgkmcnt(0)
s_barrier
v_mfma_f32_16x16x32_bf16 v[96:99], v[216:219], v[228:231], v[96:99]
ds_read_b64_tr_b16 v[24:25], v11 offset:36864
v_mfma_f32_16x16x32_bf16 v[100:103], v[216:219], v[232:235], v[100:103]
ds_read_b64_tr_b16 v[26:27], v11 offset:38400
v_mfma_f32_16x16x32_bf16 v[104:107], v[216:219], v[236:239], v[104:107]
ds_read_b128 v[36:39], v248 offset:10240
v_mfma_f32_16x16x32_bf16 v[108:111], v[216:219], v[240:243], v[108:111]
ds_read_b128 v[40:43], v248 offset:12288
v_mfma_f32_16x16x32_bf16 v[112:115], v[216:219], v[244:247], v[112:115]
ds_read_b128 v[44:47], v248 offset:14336
v_mfma_f32_16x16x32_bf16 v[116:119], v[220:223], v[228:231], v[116:119]
ds_read_b128 v[48:51], v248 offset:16384
v_mfma_f32_16x16x32_bf16 v[120:123], v[220:223], v[232:235], v[120:123]
ds_read_b128 v[52:55], v248 offset:18432
v_mfma_f32_16x16x32_bf16 v[124:127], v[220:223], v[236:239], v[124:127]
ds_read_b64_tr_b16 v[28:29], v12 offset:36864
v_mfma_f32_16x16x32_bf16 v[128:131], v[220:223], v[240:243], v[128:131]
ds_read_b64_tr_b16 v[30:31], v12 offset:38400
v_mfma_f32_16x16x32_bf16 v[132:135], v[220:223], v[244:247], v[132:135]
ds_read_b64_tr_b16 v[32:33], v13 offset:36864
v_mfma_f32_16x16x32_bf16 v[136:139], v[224:227], v[228:231], v[136:139]
ds_read_b64_tr_b16 v[34:35], v13 offset:38400
v_mfma_f32_16x16x32_bf16 v[140:143], v[224:227], v[232:235], v[140:143]
v_mfma_f32_16x16x32_bf16 v[144:147], v[224:227], v[236:239], v[144:147]
v_mfma_f32_16x16x32_bf16 v[148:151], v[224:227], v[240:243], v[148:151]
v_mfma_f32_16x16x32_bf16 v[152:155], v[224:227], v[244:247], v[152:155]
s_waitcnt lgkmcnt(0)
s_barrier
v_mfma_f32_16x16x32_bf16 v[156:159], v[24:27], v[36:39], v[156:159]
ds_read_b64_tr_b16 v[216:217], v11 offset:0
v_mfma_f32_16x16x32_bf16 v[160:163], v[24:27], v[40:43], v[160:163]
ds_read_b64_tr_b16 v[218:219], v11 offset:1536
v_mfma_f32_16x16x32_bf16 v[164:167], v[24:27], v[44:47], v[164:167]
ds_read_b128 v[228:231], v5 offset:0
v_mfma_f32_16x16x32_bf16 v[168:171], v[24:27], v[48:51], v[168:171]
ds_read_b128 v[232:235], v5 offset:2048
v_mfma_f32_16x16x32_bf16 v[172:175], v[24:27], v[52:55], v[172:175]
ds_read_b128 v[236:239], v5 offset:4096
v_mfma_f32_16x16x32_bf16 v[176:179], v[28:31], v[36:39], v[176:179]
ds_read_b128 v[240:243], v5 offset:6144
v_mfma_f32_16x16x32_bf16 v[180:183], v[28:31], v[40:43], v[180:183]
ds_read_b128 v[244:247], v5 offset:8192
v_mfma_f32_16x16x32_bf16 v[184:187], v[28:31], v[44:47], v[184:187]
ds_read_b64_tr_b16 v[220:221], v12 offset:0
v_mfma_f32_16x16x32_bf16 v[188:191], v[28:31], v[48:51], v[188:191]
ds_read_b64_tr_b16 v[222:223], v12 offset:1536
v_mfma_f32_16x16x32_bf16 v[192:195], v[28:31], v[52:55], v[192:195]
ds_read_b64_tr_b16 v[224:225], v13 offset:0
v_mfma_f32_16x16x32_bf16 v[196:199], v[32:35], v[36:39], v[196:199]
ds_read_b64_tr_b16 v[226:227], v13 offset:1536
v_mfma_f32_16x16x32_bf16 v[200:203], v[32:35], v[40:43], v[200:203]
v_mfma_f32_16x16x32_bf16 v[204:207], v[32:35], v[44:47], v[204:207]
v_mfma_f32_16x16x32_bf16 v[208:211], v[32:35], v[48:51], v[208:211]
v_mfma_f32_16x16x32_bf16 v[212:215], v[32:35], v[52:55], v[212:215]
s_waitcnt lgkmcnt(0)
s_barrier
v_mfma_f32_16x16x32_bf16 v[156:159], v[216:219], v[228:231], v[156:159]
ds_read_b64_tr_b16 v[24:25], v11 offset:12288
v_mfma_f32_16x16x32_bf16 v[160:163], v[216:219], v[232:235], v[160:163]
ds_read_b64_tr_b16 v[26:27], v11 offset:13824
v_mfma_f32_16x16x32_bf16 v[164:167], v[216:219], v[236:239], v[164:167]
ds_read_b128 v[36:39], v248 offset:0
v_mfma_f32_16x16x32_bf16 v[168:171], v[216:219], v[240:243], v[168:171]
ds_read_b128 v[40:43], v248 offset:2048
v_mfma_f32_16x16x32_bf16 v[172:175], v[216:219], v[244:247], v[172:175]
ds_read_b128 v[44:47], v248 offset:4096
v_mfma_f32_16x16x32_bf16 v[176:179], v[220:223], v[228:231], v[176:179]
ds_read_b128 v[48:51], v248 offset:6144
v_mfma_f32_16x16x32_bf16 v[180:183], v[220:223], v[232:235], v[180:183]
ds_read_b128 v[52:55], v248 offset:8192
v_mfma_f32_16x16x32_bf16 v[184:187], v[220:223], v[236:239], v[184:187]
ds_read_b64_tr_b16 v[28:29], v12 offset:12288
v_mfma_f32_16x16x32_bf16 v[188:191], v[220:223], v[240:243], v[188:191]
ds_read_b64_tr_b16 v[30:31], v12 offset:13824
v_mfma_f32_16x16x32_bf16 v[192:195], v[220:223], v[244:247], v[192:195]
ds_read_b64_tr_b16 v[32:33], v13 offset:12288
v_mfma_f32_16x16x32_bf16 v[196:199], v[224:227], v[228:231], v[196:199]
ds_read_b64_tr_b16 v[34:35], v13 offset:13824
v_mfma_f32_16x16x32_bf16 v[200:203], v[224:227], v[232:235], v[200:203]
v_mfma_f32_16x16x32_bf16 v[204:207], v[224:227], v[236:239], v[204:207]
v_mfma_f32_16x16x32_bf16 v[208:211], v[224:227], v[240:243], v[208:211]
v_mfma_f32_16x16x32_bf16 v[212:215], v[224:227], v[244:247], v[212:215]
s_waitcnt lgkmcnt(0)
s_barrier
v_mfma_f32_16x16x32_bf16 v[156:159], v[24:27], v[36:39], v[156:159]
ds_read_b64_tr_b16 v[216:217], v8 offset:0
v_mfma_f32_16x16x32_bf16 v[160:163], v[24:27], v[40:43], v[160:163]
ds_read_b64_tr_b16 v[218:219], v8 offset:6144
v_mfma_f32_16x16x32_bf16 v[164:167], v[24:27], v[44:47], v[164:167]
ds_read_b128 v[228:231], v4 offset:20480
v_mfma_f32_16x16x32_bf16 v[168:171], v[24:27], v[48:51], v[168:171]
ds_read_b128 v[232:235], v4 offset:21504
v_mfma_f32_16x16x32_bf16 v[172:175], v[24:27], v[52:55], v[172:175]
ds_read_b128 v[236:239], v4 offset:22528
v_mfma_f32_16x16x32_bf16 v[176:179], v[28:31], v[36:39], v[176:179]
ds_read_b128 v[240:243], v4 offset:23552
v_mfma_f32_16x16x32_bf16 v[180:183], v[28:31], v[40:43], v[180:183]
ds_read_b128 v[244:247], v4 offset:24576
v_mfma_f32_16x16x32_bf16 v[184:187], v[28:31], v[44:47], v[184:187]
ds_read_b64_tr_b16 v[220:221], v9 offset:0
v_mfma_f32_16x16x32_bf16 v[188:191], v[28:31], v[48:51], v[188:191]
ds_read_b64_tr_b16 v[222:223], v9 offset:6144
v_mfma_f32_16x16x32_bf16 v[192:195], v[28:31], v[52:55], v[192:195]
ds_read_b64_tr_b16 v[224:225], v10 offset:0
v_mfma_f32_16x16x32_bf16 v[196:199], v[32:35], v[36:39], v[196:199]
ds_read_b64_tr_b16 v[226:227], v10 offset:6144
v_mfma_f32_16x16x32_bf16 v[200:203], v[32:35], v[40:43], v[200:203]
v_mfma_f32_16x16x32_bf16 v[204:207], v[32:35], v[44:47], v[204:207]
v_mfma_f32_16x16x32_bf16 v[208:211], v[32:35], v[48:51], v[208:211]
v_mfma_f32_16x16x32_bf16 v[212:215], v[32:35], v[52:55], v[212:215]
s_waitcnt lgkmcnt(0)
s_barrier
v_mfma_f32_16x16x32_bf16 v[96:99], v[216:219], v[228:231], v[96:99]
ds_read_b64_tr_b16 v[24:25], v8 offset:12288
v_mfma_f32_16x16x32_bf16 v[100:103], v[216:219], v[232:235], v[100:103]
ds_read_b64_tr_b16 v[26:27], v8 offset:18432
v_mfma_f32_16x16x32_bf16 v[104:107], v[216:219], v[236:239], v[104:107]
ds_read_b128 v[36:39], v4 offset:25600
v_mfma_f32_16x16x32_bf16 v[108:111], v[216:219], v[240:243], v[108:111]
ds_read_b128 v[40:43], v4 offset:26624
v_mfma_f32_16x16x32_bf16 v[112:115], v[216:219], v[244:247], v[112:115]
ds_read_b128 v[44:47], v4 offset:27648
v_mfma_f32_16x16x32_bf16 v[116:119], v[220:223], v[228:231], v[116:119]
ds_read_b128 v[48:51], v4 offset:28672
v_mfma_f32_16x16x32_bf16 v[120:123], v[220:223], v[232:235], v[120:123]
ds_read_b128 v[52:55], v4 offset:29696
v_mfma_f32_16x16x32_bf16 v[124:127], v[220:223], v[236:239], v[124:127]
ds_read_b64_tr_b16 v[28:29], v9 offset:12288
v_mfma_f32_16x16x32_bf16 v[128:131], v[220:223], v[240:243], v[128:131]
ds_read_b64_tr_b16 v[30:31], v9 offset:18432
v_mfma_f32_16x16x32_bf16 v[132:135], v[220:223], v[244:247], v[132:135]
ds_read_b64_tr_b16 v[32:33], v10 offset:12288
v_mfma_f32_16x16x32_bf16 v[136:139], v[224:227], v[228:231], v[136:139]
ds_read_b64_tr_b16 v[34:35], v10 offset:18432
v_mfma_f32_16x16x32_bf16 v[140:143], v[224:227], v[232:235], v[140:143]
v_mfma_f32_16x16x32_bf16 v[144:147], v[224:227], v[236:239], v[144:147]
v_mfma_f32_16x16x32_bf16 v[148:151], v[224:227], v[240:243], v[148:151]
v_mfma_f32_16x16x32_bf16 v[152:155], v[224:227], v[244:247], v[152:155]
s_waitcnt lgkmcnt(0)
s_barrier
v_mfma_f32_16x16x32_bf16 v[96:99], v[24:27], v[36:39], v[96:99]
ds_read_b64_tr_b16 v[216:217], v11 offset:24576
v_mfma_f32_16x16x32_bf16 v[100:103], v[24:27], v[40:43], v[100:103]
ds_read_b64_tr_b16 v[218:219], v11 offset:26112
v_mfma_f32_16x16x32_bf16 v[104:107], v[24:27], v[44:47], v[104:107]
ds_read_b128 v[228:231], v5 offset:10240
v_mfma_f32_16x16x32_bf16 v[108:111], v[24:27], v[48:51], v[108:111]
ds_read_b128 v[232:235], v5 offset:12288
v_mfma_f32_16x16x32_bf16 v[112:115], v[24:27], v[52:55], v[112:115]
ds_read_b128 v[236:239], v5 offset:14336
v_mfma_f32_16x16x32_bf16 v[116:119], v[28:31], v[36:39], v[116:119]
ds_read_b128 v[240:243], v5 offset:16384
v_mfma_f32_16x16x32_bf16 v[120:123], v[28:31], v[40:43], v[120:123]
ds_read_b128 v[244:247], v5 offset:18432
v_mfma_f32_16x16x32_bf16 v[124:127], v[28:31], v[44:47], v[124:127]
ds_read_b64_tr_b16 v[220:221], v12 offset:24576
v_mfma_f32_16x16x32_bf16 v[128:131], v[28:31], v[48:51], v[128:131]
ds_read_b64_tr_b16 v[222:223], v12 offset:26112
v_mfma_f32_16x16x32_bf16 v[132:135], v[28:31], v[52:55], v[132:135]
ds_read_b64_tr_b16 v[224:225], v13 offset:24576
v_mfma_f32_16x16x32_bf16 v[136:139], v[32:35], v[36:39], v[136:139]
ds_read_b64_tr_b16 v[226:227], v13 offset:26112
v_mfma_f32_16x16x32_bf16 v[140:143], v[32:35], v[40:43], v[140:143]
v_mfma_f32_16x16x32_bf16 v[144:147], v[32:35], v[44:47], v[144:147]
v_mfma_f32_16x16x32_bf16 v[148:151], v[32:35], v[48:51], v[148:151]
v_mfma_f32_16x16x32_bf16 v[152:155], v[32:35], v[52:55], v[152:155]
s_waitcnt lgkmcnt(0)
s_barrier
v_mfma_f32_16x16x32_bf16 v[156:159], v[216:219], v[228:231], v[156:159]
ds_read_b64_tr_b16 v[24:25], v11 offset:36864
v_mfma_f32_16x16x32_bf16 v[160:163], v[216:219], v[232:235], v[160:163]
ds_read_b64_tr_b16 v[26:27], v11 offset:38400
v_mfma_f32_16x16x32_bf16 v[164:167], v[216:219], v[236:239], v[164:167]
ds_read_b128 v[36:39], v248 offset:10240
v_mfma_f32_16x16x32_bf16 v[168:171], v[216:219], v[240:243], v[168:171]
ds_read_b128 v[40:43], v248 offset:12288
v_mfma_f32_16x16x32_bf16 v[172:175], v[216:219], v[244:247], v[172:175]
ds_read_b128 v[44:47], v248 offset:14336
v_mfma_f32_16x16x32_bf16 v[176:179], v[220:223], v[228:231], v[176:179]
ds_read_b128 v[48:51], v248 offset:16384
v_mfma_f32_16x16x32_bf16 v[180:183], v[220:223], v[232:235], v[180:183]
ds_read_b128 v[52:55], v248 offset:18432
v_mfma_f32_16x16x32_bf16 v[184:187], v[220:223], v[236:239], v[184:187]
ds_read_b64_tr_b16 v[28:29], v12 offset:36864
v_mfma_f32_16x16x32_bf16 v[188:191], v[220:223], v[240:243], v[188:191]
ds_read_b64_tr_b16 v[30:31], v12 offset:38400
v_mfma_f32_16x16x32_bf16 v[192:195], v[220:223], v[244:247], v[192:195]
ds_read_b64_tr_b16 v[32:33], v13 offset:36864
v_mfma_f32_16x16x32_bf16 v[196:199], v[224:227], v[228:231], v[196:199]
ds_read_b64_tr_b16 v[34:35], v13 offset:38400
v_mfma_f32_16x16x32_bf16 v[200:203], v[224:227], v[232:235], v[200:203]
v_mfma_f32_16x16x32_bf16 v[204:207], v[224:227], v[236:239], v[204:207]
v_mfma_f32_16x16x32_bf16 v[208:211], v[224:227], v[240:243], v[208:211]
v_mfma_f32_16x16x32_bf16 v[212:215], v[224:227], v[244:247], v[212:215]
s_waitcnt lgkmcnt(0)
s_barrier
v_mfma_f32_16x16x32_bf16 v[156:159], v[24:27], v[36:39], v[156:159]
ds_read_b64_tr_b16 v[216:217], v8 offset:24576
v_mfma_f32_16x16x32_bf16 v[160:163], v[24:27], v[40:43], v[160:163]
ds_read_b64_tr_b16 v[218:219], v8 offset:30720
v_mfma_f32_16x16x32_bf16 v[164:167], v[24:27], v[44:47], v[164:167]
ds_read_b128 v[228:231], v4 offset:30720
v_mfma_f32_16x16x32_bf16 v[168:171], v[24:27], v[48:51], v[168:171]
ds_read_b128 v[232:235], v4 offset:31744
v_mfma_f32_16x16x32_bf16 v[172:175], v[24:27], v[52:55], v[172:175]
ds_read_b128 v[236:239], v4 offset:32768
v_mfma_f32_16x16x32_bf16 v[176:179], v[28:31], v[36:39], v[176:179]
ds_read_b128 v[240:243], v4 offset:33792
v_mfma_f32_16x16x32_bf16 v[180:183], v[28:31], v[40:43], v[180:183]
ds_read_b128 v[244:247], v4 offset:34816
v_mfma_f32_16x16x32_bf16 v[184:187], v[28:31], v[44:47], v[184:187]
ds_read_b64_tr_b16 v[220:221], v9 offset:24576
v_mfma_f32_16x16x32_bf16 v[188:191], v[28:31], v[48:51], v[188:191]
ds_read_b64_tr_b16 v[222:223], v9 offset:30720
v_mfma_f32_16x16x32_bf16 v[192:195], v[28:31], v[52:55], v[192:195]
ds_read_b64_tr_b16 v[224:225], v10 offset:24576
v_mfma_f32_16x16x32_bf16 v[196:199], v[32:35], v[36:39], v[196:199]
ds_read_b64_tr_b16 v[226:227], v10 offset:30720
v_mfma_f32_16x16x32_bf16 v[200:203], v[32:35], v[40:43], v[200:203]
v_mfma_f32_16x16x32_bf16 v[204:207], v[32:35], v[44:47], v[204:207]
v_mfma_f32_16x16x32_bf16 v[208:211], v[32:35], v[48:51], v[208:211]
v_mfma_f32_16x16x32_bf16 v[212:215], v[32:35], v[52:55], v[212:215]
s_waitcnt lgkmcnt(0)
s_barrier
v_mfma_f32_16x16x32_bf16 v[96:99], v[216:219], v[228:231], v[96:99]
ds_read_b64_tr_b16 v[24:25], v8 offset:36864
v_mfma_f32_16x16x32_bf16 v[100:103], v[216:219], v[232:235], v[100:103]
ds_read_b64_tr_b16 v[26:27], v8 offset:43008
v_mfma_f32_16x16x32_bf16 v[104:107], v[216:219], v[236:239], v[104:107]
ds_read_b128 v[36:39], v4 offset:35840
v_mfma_f32_16x16x32_bf16 v[108:111], v[216:219], v[240:243], v[108:111]
ds_read_b128 v[40:43], v4 offset:36864
v_mfma_f32_16x16x32_bf16 v[112:115], v[216:219], v[244:247], v[112:115]
ds_read_b128 v[44:47], v4 offset:37888
v_mfma_f32_16x16x32_bf16 v[116:119], v[220:223], v[228:231], v[116:119]
ds_read_b128 v[48:51], v4 offset:38912
v_mfma_f32_16x16x32_bf16 v[120:123], v[220:223], v[232:235], v[120:123]
ds_read_b128 v[52:55], v4 offset:39936
v_mfma_f32_16x16x32_bf16 v[124:127], v[220:223], v[236:239], v[124:127]
ds_read_b64_tr_b16 v[28:29], v9 offset:36864
v_mfma_f32_16x16x32_bf16 v[128:131], v[220:223], v[240:243], v[128:131]
ds_read_b64_tr_b16 v[30:31], v9 offset:43008
v_mfma_f32_16x16x32_bf16 v[132:135], v[220:223], v[244:247], v[132:135]
ds_read_b64_tr_b16 v[32:33], v10 offset:36864
v_mfma_f32_16x16x32_bf16 v[136:139], v[224:227], v[228:231], v[136:139]
ds_read_b64_tr_b16 v[34:35], v10 offset:43008
v_mfma_f32_16x16x32_bf16 v[140:143], v[224:227], v[232:235], v[140:143]
v_mfma_f32_16x16x32_bf16 v[144:147], v[224:227], v[236:239], v[144:147]
v_mfma_f32_16x16x32_bf16 v[148:151], v[224:227], v[240:243], v[148:151]
v_mfma_f32_16x16x32_bf16 v[152:155], v[224:227], v[244:247], v[152:155]
s_waitcnt lgkmcnt(0)
s_barrier
v_mfma_f32_16x16x32_bf16 v[96:99], v[24:27], v[36:39], v[96:99]
v_mfma_f32_16x16x32_bf16 v[100:103], v[24:27], v[40:43], v[100:103]
v_mfma_f32_16x16x32_bf16 v[104:107], v[24:27], v[44:47], v[104:107]
v_mfma_f32_16x16x32_bf16 v[108:111], v[24:27], v[48:51], v[108:111]
v_mfma_f32_16x16x32_bf16 v[112:115], v[24:27], v[52:55], v[112:115]
v_mfma_f32_16x16x32_bf16 v[116:119], v[28:31], v[36:39], v[116:119]
v_mfma_f32_16x16x32_bf16 v[120:123], v[28:31], v[40:43], v[120:123]
v_mfma_f32_16x16x32_bf16 v[124:127], v[28:31], v[44:47], v[124:127]
v_mfma_f32_16x16x32_bf16 v[128:131], v[28:31], v[48:51], v[128:131]
v_mfma_f32_16x16x32_bf16 v[132:135], v[28:31], v[52:55], v[132:135]
v_mfma_f32_16x16x32_bf16 v[136:139], v[32:35], v[36:39], v[136:139]
v_mfma_f32_16x16x32_bf16 v[140:143], v[32:35], v[40:43], v[140:143]
v_mfma_f32_16x16x32_bf16 v[144:147], v[32:35], v[44:47], v[144:147]
v_mfma_f32_16x16x32_bf16 v[148:151], v[32:35], v[48:51], v[148:151]
v_mfma_f32_16x16x32_bf16 v[152:155], v[32:35], v[52:55], v[152:155]
ds_read_b128 v[216:219], v18 offset:1280
ds_read_b128 v[220:223], v18 offset:1536
ds_read_b128 v[224:227], v18 offset:1792
ds_read_b128 v[228:231], v18 offset:2048
ds_read_b128 v[232:235], v18 offset:2304
s_waitcnt lgkmcnt(0)
v_add_f32 v216, v216, v217
v_add_f32 v218, v218, v219
v_add_f32 v216, v216, v218
v_rcp_f32 v19, v216
v_add_f32 v220, v220, v221
v_add_f32 v222, v222, v223
v_add_f32 v220, v220, v222
v_rcp_f32 v20, v220
v_add_f32 v224, v224, v225
v_add_f32 v226, v226, v227
v_add_f32 v224, v224, v226
v_rcp_f32 v21, v224
v_add_f32 v228, v228, v229
v_add_f32 v230, v230, v231
v_add_f32 v228, v228, v230
v_rcp_f32 v22, v228
v_add_f32 v232, v232, v233
v_add_f32 v234, v234, v235
v_add_f32 v232, v232, v234
v_rcp_f32 v23, v232
s_nop 7
v_mul_f32 v96, v96, v19
v_mul_f32 v97, v97, v19
v_mul_f32 v98, v98, v19
v_mul_f32 v99, v99, v19
v_cvt_pk_bf16_f32 v96, v96, v97
v_cvt_pk_bf16_f32 v97, v98, v99
ds_write_b64 v14, v[96:97] offset:30720
v_mul_f32 v100, v100, v20
v_mul_f32 v101, v101, v20
v_mul_f32 v102, v102, v20
v_mul_f32 v103, v103, v20
v_cvt_pk_bf16_f32 v100, v100, v101
v_cvt_pk_bf16_f32 v101, v102, v103
ds_write_b64 v14, v[100:101] offset:31744
v_mul_f32 v104, v104, v21
v_mul_f32 v105, v105, v21
v_mul_f32 v106, v106, v21
v_mul_f32 v107, v107, v21
v_cvt_pk_bf16_f32 v104, v104, v105
v_cvt_pk_bf16_f32 v105, v106, v107
ds_write_b64 v14, v[104:105] offset:32768
v_mul_f32 v108, v108, v22
v_mul_f32 v109, v109, v22
v_mul_f32 v110, v110, v22
v_mul_f32 v111, v111, v22
v_cvt_pk_bf16_f32 v108, v108, v109
v_cvt_pk_bf16_f32 v109, v110, v111
ds_write_b64 v14, v[108:109] offset:33792
v_mul_f32 v112, v112, v23
v_mul_f32 v113, v113, v23
v_mul_f32 v114, v114, v23
v_mul_f32 v115, v115, v23
v_cvt_pk_bf16_f32 v112, v112, v113
v_cvt_pk_bf16_f32 v113, v114, v115
ds_write_b64 v14, v[112:113] offset:34816
v_mul_f32 v116, v116, v19
v_mul_f32 v117, v117, v19
v_mul_f32 v118, v118, v19
v_mul_f32 v119, v119, v19
v_cvt_pk_bf16_f32 v116, v116, v117
v_cvt_pk_bf16_f32 v117, v118, v119
ds_write_b64 v15, v[116:117] offset:30720
v_mul_f32 v120, v120, v20
v_mul_f32 v121, v121, v20
v_mul_f32 v122, v122, v20
v_mul_f32 v123, v123, v20
v_cvt_pk_bf16_f32 v120, v120, v121
v_cvt_pk_bf16_f32 v121, v122, v123
ds_write_b64 v15, v[120:121] offset:31744
v_mul_f32 v124, v124, v21
v_mul_f32 v125, v125, v21
v_mul_f32 v126, v126, v21
v_mul_f32 v127, v127, v21
v_cvt_pk_bf16_f32 v124, v124, v125
v_cvt_pk_bf16_f32 v125, v126, v127
ds_write_b64 v15, v[124:125] offset:32768
v_mul_f32 v128, v128, v22
v_mul_f32 v129, v129, v22
v_mul_f32 v130, v130, v22
v_mul_f32 v131, v131, v22
v_cvt_pk_bf16_f32 v128, v128, v129
v_cvt_pk_bf16_f32 v129, v130, v131
ds_write_b64 v15, v[128:129] offset:33792
v_mul_f32 v132, v132, v23
v_mul_f32 v133, v133, v23
v_mul_f32 v134, v134, v23
v_mul_f32 v135, v135, v23
v_cvt_pk_bf16_f32 v132, v132, v133
v_cvt_pk_bf16_f32 v133, v134, v135
ds_write_b64 v15, v[132:133] offset:34816
v_mul_f32 v136, v136, v19
v_mul_f32 v137, v137, v19
v_mul_f32 v138, v138, v19
v_mul_f32 v139, v139, v19
v_cvt_pk_bf16_f32 v136, v136, v137
v_cvt_pk_bf16_f32 v137, v138, v139
ds_write_b64 v16, v[136:137] offset:30720
v_mul_f32 v140, v140, v20
v_mul_f32 v141, v141, v20
v_mul_f32 v142, v142, v20
v_mul_f32 v143, v143, v20
v_cvt_pk_bf16_f32 v140, v140, v141
v_cvt_pk_bf16_f32 v141, v142, v143
ds_write_b64 v16, v[140:141] offset:31744
v_mul_f32 v144, v144, v21
v_mul_f32 v145, v145, v21
v_mul_f32 v146, v146, v21
v_mul_f32 v147, v147, v21
v_cvt_pk_bf16_f32 v144, v144, v145
v_cvt_pk_bf16_f32 v145, v146, v147
ds_write_b64 v16, v[144:145] offset:32768
v_mul_f32 v148, v148, v22
v_mul_f32 v149, v149, v22
v_mul_f32 v150, v150, v22
v_mul_f32 v151, v151, v22
v_cvt_pk_bf16_f32 v148, v148, v149
v_cvt_pk_bf16_f32 v149, v150, v151
ds_write_b64 v16, v[148:149] offset:33792
v_mul_f32 v152, v152, v23
v_mul_f32 v153, v153, v23
v_mul_f32 v154, v154, v23
v_mul_f32 v155, v155, v23
v_cvt_pk_bf16_f32 v152, v152, v153
v_cvt_pk_bf16_f32 v153, v154, v155
ds_write_b64 v16, v[152:153] offset:34816
v_cvt_pk_bf16_f32 v156, v156, v157
v_cvt_pk_bf16_f32 v157, v158, v159
ds_write_b64 v14, v[156:157] offset:0
v_cvt_pk_bf16_f32 v160, v160, v161
v_cvt_pk_bf16_f32 v161, v162, v163
ds_write_b64 v14, v[160:161] offset:1024
v_cvt_pk_bf16_f32 v164, v164, v165
v_cvt_pk_bf16_f32 v165, v166, v167
ds_write_b64 v14, v[164:165] offset:2048
v_cvt_pk_bf16_f32 v168, v168, v169
v_cvt_pk_bf16_f32 v169, v170, v171
ds_write_b64 v14, v[168:169] offset:3072
v_cvt_pk_bf16_f32 v172, v172, v173
v_cvt_pk_bf16_f32 v173, v174, v175
ds_write_b64 v14, v[172:173] offset:4096
v_cvt_pk_bf16_f32 v176, v176, v177
v_cvt_pk_bf16_f32 v177, v178, v179
ds_write_b64 v15, v[176:177] offset:0
v_cvt_pk_bf16_f32 v180, v180, v181
v_cvt_pk_bf16_f32 v181, v182, v183
ds_write_b64 v15, v[180:181] offset:1024
v_cvt_pk_bf16_f32 v184, v184, v185
v_cvt_pk_bf16_f32 v185, v186, v187
ds_write_b64 v15, v[184:185] offset:2048
v_cvt_pk_bf16_f32 v188, v188, v189
v_cvt_pk_bf16_f32 v189, v190, v191
ds_write_b64 v15, v[188:189] offset:3072
v_cvt_pk_bf16_f32 v192, v192, v193
v_cvt_pk_bf16_f32 v193, v194, v195
ds_write_b64 v15, v[192:193] offset:4096
v_cvt_pk_bf16_f32 v196, v196, v197
v_cvt_pk_bf16_f32 v197, v198, v199
ds_write_b64 v16, v[196:197] offset:0
v_cvt_pk_bf16_f32 v200, v200, v201
v_cvt_pk_bf16_f32 v201, v202, v203
ds_write_b64 v16, v[200:201] offset:1024
v_cvt_pk_bf16_f32 v204, v204, v205
v_cvt_pk_bf16_f32 v205, v206, v207
ds_write_b64 v16, v[204:205] offset:2048
v_cvt_pk_bf16_f32 v208, v208, v209
v_cvt_pk_bf16_f32 v209, v210, v211
ds_write_b64 v16, v[208:209] offset:3072
v_cvt_pk_bf16_f32 v212, v212, v213
v_cvt_pk_bf16_f32 v213, v214, v215
ds_write_b64 v16, v[212:213] offset:4096
s_waitcnt lgkmcnt(0)
s_barrier
s_add_u32 s38, s38, 1
s_branch .LA_loop
.LA_last:
v_xor_b32 v248, 64, v5
s_waitcnt lgkmcnt(0)
s_barrier
ds_read_b64_tr_b16 v[216:217], v8 offset:0
ds_read_b64_tr_b16 v[218:219], v8 offset:6144
ds_read_b128 v[228:231], v4 offset:0
ds_read_b128 v[232:235], v4 offset:1024
ds_read_b128 v[236:239], v4 offset:2048
ds_read_b128 v[240:243], v4 offset:3072
ds_read_b128 v[244:247], v4 offset:4096
ds_read_b64_tr_b16 v[220:221], v9 offset:0
ds_read_b64_tr_b16 v[222:223], v9 offset:6144
ds_read_b64_tr_b16 v[224:225], v10 offset:0
ds_read_b64_tr_b16 v[226:227], v10 offset:6144
s_waitcnt lgkmcnt(0)
s_barrier
v_mfma_f32_16x16x32_bf16 v[96:99], v[216:219], v[228:231], 0
ds_read_b64_tr_b16 v[24:25], v8 offset:12288
v_mfma_f32_16x16x32_bf16 v[100:103], v[216:219], v[232:235], 0
ds_read_b64_tr_b16 v[26:27], v8 offset:18432
v_mfma_f32_16x16x32_bf16 v[104:107], v[216:219], v[236:239], 0
ds_read_b128 v[36:39], v4 offset:5120
v_mfma_f32_16x16x32_bf16 v[108:111], v[216:219], v[240:243], 0
ds_read_b128 v[40:43], v4 offset:6144
v_mfma_f32_16x16x32_bf16 v[112:115], v[216:219], v[244:247], 0
ds_read_b128 v[44:47], v4 offset:7168
v_mfma_f32_16x16x32_bf16 v[116:119], v[220:223], v[228:231], 0
ds_read_b128 v[48:51], v4 offset:8192
v_mfma_f32_16x16x32_bf16 v[120:123], v[220:223], v[232:235], 0
ds_read_b128 v[52:55], v4 offset:9216
v_mfma_f32_16x16x32_bf16 v[124:127], v[220:223], v[236:239], 0
ds_read_b64_tr_b16 v[28:29], v9 offset:12288
v_mfma_f32_16x16x32_bf16 v[128:131], v[220:223], v[240:243], 0
ds_read_b64_tr_b16 v[30:31], v9 offset:18432
v_mfma_f32_16x16x32_bf16 v[132:135], v[220:223], v[244:247], 0
ds_read_b64_tr_b16 v[32:33], v10 offset:12288
v_mfma_f32_16x16x32_bf16 v[136:139], v[224:227], v[228:231], 0
ds_read_b64_tr_b16 v[34:35], v10 offset:18432
v_mfma_f32_16x16x32_bf16 v[140:143], v[224:227], v[232:235], 0
v_mfma_f32_16x16x32_bf16 v[144:147], v[224:227], v[236:239], 0
v_mfma_f32_16x16x32_bf16 v[148:151], v[224:227], v[240:243], 0
v_mfma_f32_16x16x32_bf16 v[152:155], v[224:227], v[244:247], 0
s_waitcnt lgkmcnt(0)
s_barrier
v_mfma_f32_16x16x32_bf16 v[96:99], v[24:27], v[36:39], v[96:99]
ds_read_b64_tr_b16 v[216:217], v8 offset:24576
v_mfma_f32_16x16x32_bf16 v[100:103], v[24:27], v[40:43], v[100:103]
ds_read_b64_tr_b16 v[218:219], v8 offset:30720
v_mfma_f32_16x16x32_bf16 v[104:107], v[24:27], v[44:47], v[104:107]
ds_read_b128 v[228:231], v4 offset:10240
v_mfma_f32_16x16x32_bf16 v[108:111], v[24:27], v[48:51], v[108:111]
ds_read_b128 v[232:235], v4 offset:11264
v_mfma_f32_16x16x32_bf16 v[112:115], v[24:27], v[52:55], v[112:115]
ds_read_b128 v[236:239], v4 offset:12288
v_mfma_f32_16x16x32_bf16 v[116:119], v[28:31], v[36:39], v[116:119]
ds_read_b128 v[240:243], v4 offset:13312
v_mfma_f32_16x16x32_bf16 v[120:123], v[28:31], v[40:43], v[120:123]
ds_read_b128 v[244:247], v4 offset:14336
v_mfma_f32_16x16x32_bf16 v[124:127], v[28:31], v[44:47], v[124:127]
ds_read_b64_tr_b16 v[220:221], v9 offset:24576
v_mfma_f32_16x16x32_bf16 v[128:131], v[28:31], v[48:51], v[128:131]
ds_read_b64_tr_b16 v[222:223], v9 offset:30720
v_mfma_f32_16x16x32_bf16 v[132:135], v[28:31], v[52:55], v[132:135]
ds_read_b64_tr_b16 v[224:225], v10 offset:24576
v_mfma_f32_16x16x32_bf16 v[136:139], v[32:35], v[36:39], v[136:139]
ds_read_b64_tr_b16 v[226:227], v10 offset:30720
v_mfma_f32_16x16x32_bf16 v[140:143], v[32:35], v[40:43], v[140:143]
v_mfma_f32_16x16x32_bf16 v[144:147], v[32:35], v[44:47], v[144:147]
v_mfma_f32_16x16x32_bf16 v[148:151], v[32:35], v[48:51], v[148:151]
v_mfma_f32_16x16x32_bf16 v[152:155], v[32:35], v[52:55], v[152:155]
s_waitcnt lgkmcnt(0)
s_barrier
v_mfma_f32_16x16x32_bf16 v[96:99], v[216:219], v[228:231], v[96:99]
ds_read_b64_tr_b16 v[24:25], v8 offset:36864
v_mfma_f32_16x16x32_bf16 v[100:103], v[216:219], v[232:235], v[100:103]
ds_read_b64_tr_b16 v[26:27], v8 offset:43008
v_mfma_f32_16x16x32_bf16 v[104:107], v[216:219], v[236:239], v[104:107]
ds_read_b128 v[36:39], v4 offset:15360
v_mfma_f32_16x16x32_bf16 v[108:111], v[216:219], v[240:243], v[108:111]
ds_read_b128 v[40:43], v4 offset:16384
v_mfma_f32_16x16x32_bf16 v[112:115], v[216:219], v[244:247], v[112:115]
ds_read_b128 v[44:47], v4 offset:17408
v_mfma_f32_16x16x32_bf16 v[116:119], v[220:223], v[228:231], v[116:119]
ds_read_b128 v[48:51], v4 offset:18432
v_mfma_f32_16x16x32_bf16 v[120:123], v[220:223], v[232:235], v[120:123]
ds_read_b128 v[52:55], v4 offset:19456
v_mfma_f32_16x16x32_bf16 v[124:127], v[220:223], v[236:239], v[124:127]
ds_read_b64_tr_b16 v[28:29], v9 offset:36864
v_mfma_f32_16x16x32_bf16 v[128:131], v[220:223], v[240:243], v[128:131]
ds_read_b64_tr_b16 v[30:31], v9 offset:43008
v_mfma_f32_16x16x32_bf16 v[132:135], v[220:223], v[244:247], v[132:135]
ds_read_b64_tr_b16 v[32:33], v10 offset:36864
v_mfma_f32_16x16x32_bf16 v[136:139], v[224:227], v[228:231], v[136:139]
ds_read_b64_tr_b16 v[34:35], v10 offset:43008
v_mfma_f32_16x16x32_bf16 v[140:143], v[224:227], v[232:235], v[140:143]
v_mfma_f32_16x16x32_bf16 v[144:147], v[224:227], v[236:239], v[144:147]
v_mfma_f32_16x16x32_bf16 v[148:151], v[224:227], v[240:243], v[148:151]
v_mfma_f32_16x16x32_bf16 v[152:155], v[224:227], v[244:247], v[152:155]
s_waitcnt lgkmcnt(0)
s_barrier
v_mfma_f32_16x16x32_bf16 v[96:99], v[24:27], v[36:39], v[96:99]
ds_read_b64_tr_b16 v[216:217], v8 offset:0
v_mfma_f32_16x16x32_bf16 v[100:103], v[24:27], v[40:43], v[100:103]
ds_read_b64_tr_b16 v[218:219], v8 offset:6144
v_mfma_f32_16x16x32_bf16 v[104:107], v[24:27], v[44:47], v[104:107]
ds_read_b128 v[228:231], v4 offset:20480
v_mfma_f32_16x16x32_bf16 v[108:111], v[24:27], v[48:51], v[108:111]
ds_read_b128 v[232:235], v4 offset:21504
v_mfma_f32_16x16x32_bf16 v[112:115], v[24:27], v[52:55], v[112:115]
ds_read_b128 v[236:239], v4 offset:22528
v_mfma_f32_16x16x32_bf16 v[116:119], v[28:31], v[36:39], v[116:119]
ds_read_b128 v[240:243], v4 offset:23552
v_mfma_f32_16x16x32_bf16 v[120:123], v[28:31], v[40:43], v[120:123]
ds_read_b128 v[244:247], v4 offset:24576
v_mfma_f32_16x16x32_bf16 v[124:127], v[28:31], v[44:47], v[124:127]
ds_read_b64_tr_b16 v[220:221], v9 offset:0
v_mfma_f32_16x16x32_bf16 v[128:131], v[28:31], v[48:51], v[128:131]
ds_read_b64_tr_b16 v[222:223], v9 offset:6144
v_mfma_f32_16x16x32_bf16 v[132:135], v[28:31], v[52:55], v[132:135]
ds_read_b64_tr_b16 v[224:225], v10 offset:0
v_mfma_f32_16x16x32_bf16 v[136:139], v[32:35], v[36:39], v[136:139]
ds_read_b64_tr_b16 v[226:227], v10 offset:6144
v_mfma_f32_16x16x32_bf16 v[140:143], v[32:35], v[40:43], v[140:143]
ds_write_b128 v0, v[56:59] offset:0
v_mfma_f32_16x16x32_bf16 v[144:147], v[32:35], v[44:47], v[144:147]
ds_write_b128 v0, v[60:63] offset:1024
v_mfma_f32_16x16x32_bf16 v[148:151], v[32:35], v[48:51], v[148:151]
ds_write_b128 v0, v[64:67] offset:2048
v_mfma_f32_16x16x32_bf16 v[152:155], v[32:35], v[52:55], v[152:155]
ds_write_b128 v0, v[68:71] offset:3072
ds_write_b128 v0, v[72:75] offset:4096
s_waitcnt lgkmcnt(0)
s_barrier
v_mfma_f32_16x16x32_bf16 v[96:99], v[216:219], v[228:231], v[96:99]
ds_read_b64_tr_b16 v[24:25], v8 offset:12288
v_mfma_f32_16x16x32_bf16 v[100:103], v[216:219], v[232:235], v[100:103]
ds_read_b64_tr_b16 v[26:27], v8 offset:18432
v_mfma_f32_16x16x32_bf16 v[104:107], v[216:219], v[236:239], v[104:107]
ds_read_b128 v[36:39], v4 offset:25600
v_mfma_f32_16x16x32_bf16 v[108:111], v[216:219], v[240:243], v[108:111]
ds_read_b128 v[40:43], v4 offset:26624
v_mfma_f32_16x16x32_bf16 v[112:115], v[216:219], v[244:247], v[112:115]
ds_read_b128 v[44:47], v4 offset:27648
v_mfma_f32_16x16x32_bf16 v[116:119], v[220:223], v[228:231], v[116:119]
ds_read_b128 v[48:51], v4 offset:28672
v_mfma_f32_16x16x32_bf16 v[120:123], v[220:223], v[232:235], v[120:123]
ds_read_b128 v[52:55], v4 offset:29696
v_mfma_f32_16x16x32_bf16 v[124:127], v[220:223], v[236:239], v[124:127]
ds_read_b64_tr_b16 v[28:29], v9 offset:12288
v_mfma_f32_16x16x32_bf16 v[128:131], v[220:223], v[240:243], v[128:131]
ds_read_b64_tr_b16 v[30:31], v9 offset:18432
v_mfma_f32_16x16x32_bf16 v[132:135], v[220:223], v[244:247], v[132:135]
ds_read_b64_tr_b16 v[32:33], v10 offset:12288
v_mfma_f32_16x16x32_bf16 v[136:139], v[224:227], v[228:231], v[136:139]
ds_read_b64_tr_b16 v[34:35], v10 offset:18432
v_mfma_f32_16x16x32_bf16 v[140:143], v[224:227], v[232:235], v[140:143]
v_mfma_f32_16x16x32_bf16 v[144:147], v[224:227], v[236:239], v[144:147]
v_mfma_f32_16x16x32_bf16 v[148:151], v[224:227], v[240:243], v[148:151]
v_mfma_f32_16x16x32_bf16 v[152:155], v[224:227], v[244:247], v[152:155]
s_waitcnt lgkmcnt(0)
s_barrier
v_mfma_f32_16x16x32_bf16 v[96:99], v[24:27], v[36:39], v[96:99]
ds_read_b64_tr_b16 v[216:217], v8 offset:24576
v_mfma_f32_16x16x32_bf16 v[100:103], v[24:27], v[40:43], v[100:103]
ds_read_b64_tr_b16 v[218:219], v8 offset:30720
v_mfma_f32_16x16x32_bf16 v[104:107], v[24:27], v[44:47], v[104:107]
ds_read_b128 v[228:231], v4 offset:30720
v_mfma_f32_16x16x32_bf16 v[108:111], v[24:27], v[48:51], v[108:111]
ds_read_b128 v[232:235], v4 offset:31744
v_mfma_f32_16x16x32_bf16 v[112:115], v[24:27], v[52:55], v[112:115]
ds_read_b128 v[236:239], v4 offset:32768
v_mfma_f32_16x16x32_bf16 v[116:119], v[28:31], v[36:39], v[116:119]
ds_read_b128 v[240:243], v4 offset:33792
v_mfma_f32_16x16x32_bf16 v[120:123], v[28:31], v[40:43], v[120:123]
ds_read_b128 v[244:247], v4 offset:34816
v_mfma_f32_16x16x32_bf16 v[124:127], v[28:31], v[44:47], v[124:127]
ds_read_b64_tr_b16 v[220:221], v9 offset:24576
v_mfma_f32_16x16x32_bf16 v[128:131], v[28:31], v[48:51], v[128:131]
ds_read_b64_tr_b16 v[222:223], v9 offset:30720
v_mfma_f32_16x16x32_bf16 v[132:135], v[28:31], v[52:55], v[132:135]
ds_read_b64_tr_b16 v[224:225], v10 offset:24576
v_mfma_f32_16x16x32_bf16 v[136:139], v[32:35], v[36:39], v[136:139]
ds_read_b64_tr_b16 v[226:227], v10 offset:30720
v_mfma_f32_16x16x32_bf16 v[140:143], v[32:35], v[40:43], v[140:143]
v_mfma_f32_16x16x32_bf16 v[144:147], v[32:35], v[44:47], v[144:147]
v_mfma_f32_16x16x32_bf16 v[148:151], v[32:35], v[48:51], v[148:151]
v_mfma_f32_16x16x32_bf16 v[152:155], v[32:35], v[52:55], v[152:155]
s_waitcnt lgkmcnt(0)
s_barrier
v_mfma_f32_16x16x32_bf16 v[96:99], v[216:219], v[228:231], v[96:99]
ds_read_b64_tr_b16 v[24:25], v8 offset:36864
v_mfma_f32_16x16x32_bf16 v[100:103], v[216:219], v[232:235], v[100:103]
ds_read_b64_tr_b16 v[26:27], v8 offset:43008
v_mfma_f32_16x16x32_bf16 v[104:107], v[216:219], v[236:239], v[104:107]
ds_read_b128 v[36:39], v4 offset:35840
v_mfma_f32_16x16x32_bf16 v[108:111], v[216:219], v[240:243], v[108:111]
ds_read_b128 v[40:43], v4 offset:36864
v_mfma_f32_16x16x32_bf16 v[112:115], v[216:219], v[244:247], v[112:115]
ds_read_b128 v[44:47], v4 offset:37888
v_mfma_f32_16x16x32_bf16 v[116:119], v[220:223], v[228:231], v[116:119]
ds_read_b128 v[48:51], v4 offset:38912
v_mfma_f32_16x16x32_bf16 v[120:123], v[220:223], v[232:235], v[120:123]
ds_read_b128 v[52:55], v4 offset:39936
v_mfma_f32_16x16x32_bf16 v[124:127], v[220:223], v[236:239], v[124:127]
ds_read_b64_tr_b16 v[28:29], v9 offset:36864
v_mfma_f32_16x16x32_bf16 v[128:131], v[220:223], v[240:243], v[128:131]
ds_read_b64_tr_b16 v[30:31], v9 offset:43008
v_mfma_f32_16x16x32_bf16 v[132:135], v[220:223], v[244:247], v[132:135]
ds_read_b64_tr_b16 v[32:33], v10 offset:36864
v_mfma_f32_16x16x32_bf16 v[136:139], v[224:227], v[228:231], v[136:139]
ds_read_b64_tr_b16 v[34:35], v10 offset:43008
v_mfma_f32_16x16x32_bf16 v[140:143], v[224:227], v[232:235], v[140:143]
v_mfma_f32_16x16x32_bf16 v[144:147], v[224:227], v[236:239], v[144:147]
v_mfma_f32_16x16x32_bf16 v[148:151], v[224:227], v[240:243], v[148:151]
v_mfma_f32_16x16x32_bf16 v[152:155], v[224:227], v[244:247], v[152:155]
s_waitcnt lgkmcnt(0)
s_barrier
v_mfma_f32_16x16x32_bf16 v[96:99], v[24:27], v[36:39], v[96:99]
ds_read_b64_tr_b16 v[216:217], v8 offset:0
v_mfma_f32_16x16x32_bf16 v[100:103], v[24:27], v[40:43], v[100:103]
ds_read_b64_tr_b16 v[218:219], v8 offset:6144
v_mfma_f32_16x16x32_bf16 v[104:107], v[24:27], v[44:47], v[104:107]
ds_read_b128 v[228:231], v4 offset:0
v_mfma_f32_16x16x32_bf16 v[108:111], v[24:27], v[48:51], v[108:111]
ds_read_b128 v[232:235], v4 offset:1024
v_mfma_f32_16x16x32_bf16 v[112:115], v[24:27], v[52:55], v[112:115]
ds_read_b128 v[236:239], v4 offset:2048
v_mfma_f32_16x16x32_bf16 v[116:119], v[28:31], v[36:39], v[116:119]
ds_read_b128 v[240:243], v4 offset:3072
v_mfma_f32_16x16x32_bf16 v[120:123], v[28:31], v[40:43], v[120:123]
ds_read_b128 v[244:247], v4 offset:4096
v_mfma_f32_16x16x32_bf16 v[124:127], v[28:31], v[44:47], v[124:127]
ds_read_b64_tr_b16 v[220:221], v9 offset:0
v_mfma_f32_16x16x32_bf16 v[128:131], v[28:31], v[48:51], v[128:131]
ds_read_b64_tr_b16 v[222:223], v9 offset:6144
v_mfma_f32_16x16x32_bf16 v[132:135], v[28:31], v[52:55], v[132:135]
ds_read_b64_tr_b16 v[224:225], v10 offset:0
v_mfma_f32_16x16x32_bf16 v[136:139], v[32:35], v[36:39], v[136:139]
ds_read_b64_tr_b16 v[226:227], v10 offset:6144
v_mfma_f32_16x16x32_bf16 v[140:143], v[32:35], v[40:43], v[140:143]
ds_write_b128 v0, v[76:79] offset:20480
v_mfma_f32_16x16x32_bf16 v[144:147], v[32:35], v[44:47], v[144:147]
ds_write_b128 v0, v[80:83] offset:21504
v_mfma_f32_16x16x32_bf16 v[148:151], v[32:35], v[48:51], v[148:151]
ds_write_b128 v0, v[84:87] offset:22528
v_mfma_f32_16x16x32_bf16 v[152:155], v[32:35], v[52:55], v[152:155]
ds_write_b128 v0, v[88:91] offset:23552
ds_write_b128 v0, v[92:95] offset:24576
s_waitcnt lgkmcnt(0)
s_barrier
v_mfma_f32_16x16x32_bf16 v[96:99], v[216:219], v[228:231], v[96:99]
ds_read_b64_tr_b16 v[24:25], v8 offset:12288
v_mfma_f32_16x16x32_bf16 v[100:103], v[216:219], v[232:235], v[100:103]
ds_read_b64_tr_b16 v[26:27], v8 offset:18432
v_mfma_f32_16x16x32_bf16 v[104:107], v[216:219], v[236:239], v[104:107]
ds_read_b128 v[36:39], v4 offset:5120
v_mfma_f32_16x16x32_bf16 v[108:111], v[216:219], v[240:243], v[108:111]
ds_read_b128 v[40:43], v4 offset:6144
v_mfma_f32_16x16x32_bf16 v[112:115], v[216:219], v[244:247], v[112:115]
ds_read_b128 v[44:47], v4 offset:7168
v_mfma_f32_16x16x32_bf16 v[116:119], v[220:223], v[228:231], v[116:119]
ds_read_b128 v[48:51], v4 offset:8192
v_mfma_f32_16x16x32_bf16 v[120:123], v[220:223], v[232:235], v[120:123]
ds_read_b128 v[52:55], v4 offset:9216
v_mfma_f32_16x16x32_bf16 v[124:127], v[220:223], v[236:239], v[124:127]
ds_read_b64_tr_b16 v[28:29], v9 offset:12288
v_mfma_f32_16x16x32_bf16 v[128:131], v[220:223], v[240:243], v[128:131]
ds_read_b64_tr_b16 v[30:31], v9 offset:18432
v_mfma_f32_16x16x32_bf16 v[132:135], v[220:223], v[244:247], v[132:135]
ds_read_b64_tr_b16 v[32:33], v10 offset:12288
v_mfma_f32_16x16x32_bf16 v[136:139], v[224:227], v[228:231], v[136:139]
ds_read_b64_tr_b16 v[34:35], v10 offset:18432
v_mfma_f32_16x16x32_bf16 v[140:143], v[224:227], v[232:235], v[140:143]
v_mfma_f32_16x16x32_bf16 v[144:147], v[224:227], v[236:239], v[144:147]
v_mfma_f32_16x16x32_bf16 v[148:151], v[224:227], v[240:243], v[148:151]
v_mfma_f32_16x16x32_bf16 v[152:155], v[224:227], v[244:247], v[152:155]
s_waitcnt lgkmcnt(0)
s_barrier
v_mfma_f32_16x16x32_bf16 v[96:99], v[24:27], v[36:39], v[96:99]
ds_read_b64_tr_b16 v[216:217], v8 offset:24576
v_mfma_f32_16x16x32_bf16 v[100:103], v[24:27], v[40:43], v[100:103]
ds_read_b64_tr_b16 v[218:219], v8 offset:30720
v_mfma_f32_16x16x32_bf16 v[104:107], v[24:27], v[44:47], v[104:107]
ds_read_b128 v[228:231], v4 offset:10240
v_mfma_f32_16x16x32_bf16 v[108:111], v[24:27], v[48:51], v[108:111]
ds_read_b128 v[232:235], v4 offset:11264
v_mfma_f32_16x16x32_bf16 v[112:115], v[24:27], v[52:55], v[112:115]
ds_read_b128 v[236:239], v4 offset:12288
v_mfma_f32_16x16x32_bf16 v[116:119], v[28:31], v[36:39], v[116:119]
ds_read_b128 v[240:243], v4 offset:13312
v_mfma_f32_16x16x32_bf16 v[120:123], v[28:31], v[40:43], v[120:123]
ds_read_b128 v[244:247], v4 offset:14336
v_mfma_f32_16x16x32_bf16 v[124:127], v[28:31], v[44:47], v[124:127]
ds_read_b64_tr_b16 v[220:221], v9 offset:24576
v_mfma_f32_16x16x32_bf16 v[128:131], v[28:31], v[48:51], v[128:131]
ds_read_b64_tr_b16 v[222:223], v9 offset:30720
v_mfma_f32_16x16x32_bf16 v[132:135], v[28:31], v[52:55], v[132:135]
ds_read_b64_tr_b16 v[224:225], v10 offset:24576
v_mfma_f32_16x16x32_bf16 v[136:139], v[32:35], v[36:39], v[136:139]
ds_read_b64_tr_b16 v[226:227], v10 offset:30720
v_mfma_f32_16x16x32_bf16 v[140:143], v[32:35], v[40:43], v[140:143]
v_mfma_f32_16x16x32_bf16 v[144:147], v[32:35], v[44:47], v[144:147]
v_mfma_f32_16x16x32_bf16 v[148:151], v[32:35], v[48:51], v[148:151]
v_mfma_f32_16x16x32_bf16 v[152:155], v[32:35], v[52:55], v[152:155]
s_waitcnt lgkmcnt(0)
s_barrier
v_mfma_f32_16x16x32_bf16 v[96:99], v[216:219], v[228:231], v[96:99]
ds_read_b64_tr_b16 v[24:25], v8 offset:36864
v_mfma_f32_16x16x32_bf16 v[100:103], v[216:219], v[232:235], v[100:103]
ds_read_b64_tr_b16 v[26:27], v8 offset:43008
v_mfma_f32_16x16x32_bf16 v[104:107], v[216:219], v[236:239], v[104:107]
ds_read_b128 v[36:39], v4 offset:15360
v_mfma_f32_16x16x32_bf16 v[108:111], v[216:219], v[240:243], v[108:111]
ds_read_b128 v[40:43], v4 offset:16384
v_mfma_f32_16x16x32_bf16 v[112:115], v[216:219], v[244:247], v[112:115]
ds_read_b128 v[44:47], v4 offset:17408
v_mfma_f32_16x16x32_bf16 v[116:119], v[220:223], v[228:231], v[116:119]
ds_read_b128 v[48:51], v4 offset:18432
v_mfma_f32_16x16x32_bf16 v[120:123], v[220:223], v[232:235], v[120:123]
ds_read_b128 v[52:55], v4 offset:19456
v_mfma_f32_16x16x32_bf16 v[124:127], v[220:223], v[236:239], v[124:127]
ds_read_b64_tr_b16 v[28:29], v9 offset:36864
v_mfma_f32_16x16x32_bf16 v[128:131], v[220:223], v[240:243], v[128:131]
ds_read_b64_tr_b16 v[30:31], v9 offset:43008
v_mfma_f32_16x16x32_bf16 v[132:135], v[220:223], v[244:247], v[132:135]
ds_read_b64_tr_b16 v[32:33], v10 offset:36864
v_mfma_f32_16x16x32_bf16 v[136:139], v[224:227], v[228:231], v[136:139]
ds_read_b64_tr_b16 v[34:35], v10 offset:43008
v_mfma_f32_16x16x32_bf16 v[140:143], v[224:227], v[232:235], v[140:143]
v_mfma_f32_16x16x32_bf16 v[144:147], v[224:227], v[236:239], v[144:147]
v_mfma_f32_16x16x32_bf16 v[148:151], v[224:227], v[240:243], v[148:151]
v_mfma_f32_16x16x32_bf16 v[152:155], v[224:227], v[244:247], v[152:155]
s_waitcnt lgkmcnt(0)
s_barrier
v_mfma_f32_16x16x32_bf16 v[96:99], v[24:27], v[36:39], v[96:99]
ds_read_b64_tr_b16 v[216:217], v8 offset:0
v_mfma_f32_16x16x32_bf16 v[100:103], v[24:27], v[40:43], v[100:103]
ds_read_b64_tr_b16 v[218:219], v8 offset:6144
v_mfma_f32_16x16x32_bf16 v[104:107], v[24:27], v[44:47], v[104:107]
ds_read_b128 v[228:231], v4 offset:20480
v_mfma_f32_16x16x32_bf16 v[108:111], v[24:27], v[48:51], v[108:111]
ds_read_b128 v[232:235], v4 offset:21504
v_mfma_f32_16x16x32_bf16 v[112:115], v[24:27], v[52:55], v[112:115]
ds_read_b128 v[236:239], v4 offset:22528
v_mfma_f32_16x16x32_bf16 v[116:119], v[28:31], v[36:39], v[116:119]
ds_read_b128 v[240:243], v4 offset:23552
v_mfma_f32_16x16x32_bf16 v[120:123], v[28:31], v[40:43], v[120:123]
ds_read_b128 v[244:247], v4 offset:24576
v_mfma_f32_16x16x32_bf16 v[124:127], v[28:31], v[44:47], v[124:127]
ds_read_b64_tr_b16 v[220:221], v9 offset:0
v_mfma_f32_16x16x32_bf16 v[128:131], v[28:31], v[48:51], v[128:131]
ds_read_b64_tr_b16 v[222:223], v9 offset:6144
v_mfma_f32_16x16x32_bf16 v[132:135], v[28:31], v[52:55], v[132:135]
ds_read_b64_tr_b16 v[224:225], v10 offset:0
v_mfma_f32_16x16x32_bf16 v[136:139], v[32:35], v[36:39], v[136:139]
ds_read_b64_tr_b16 v[226:227], v10 offset:6144
v_mfma_f32_16x16x32_bf16 v[140:143], v[32:35], v[40:43], v[140:143]
v_mfma_f32_16x16x32_bf16 v[144:147], v[32:35], v[44:47], v[144:147]
v_mfma_f32_16x16x32_bf16 v[148:151], v[32:35], v[48:51], v[148:151]
v_mfma_f32_16x16x32_bf16 v[152:155], v[32:35], v[52:55], v[152:155]
s_waitcnt lgkmcnt(0)
s_barrier
v_mfma_f32_16x16x32_bf16 v[96:99], v[216:219], v[228:231], v[96:99]
ds_read_b64_tr_b16 v[24:25], v8 offset:12288
v_mfma_f32_16x16x32_bf16 v[100:103], v[216:219], v[232:235], v[100:103]
ds_read_b64_tr_b16 v[26:27], v8 offset:18432
v_mfma_f32_16x16x32_bf16 v[104:107], v[216:219], v[236:239], v[104:107]
ds_read_b128 v[36:39], v4 offset:25600
v_mfma_f32_16x16x32_bf16 v[108:111], v[216:219], v[240:243], v[108:111]
ds_read_b128 v[40:43], v4 offset:26624
v_mfma_f32_16x16x32_bf16 v[112:115], v[216:219], v[244:247], v[112:115]
ds_read_b128 v[44:47], v4 offset:27648
v_mfma_f32_16x16x32_bf16 v[116:119], v[220:223], v[228:231], v[116:119]
ds_read_b128 v[48:51], v4 offset:28672
v_mfma_f32_16x16x32_bf16 v[120:123], v[220:223], v[232:235], v[120:123]
ds_read_b128 v[52:55], v4 offset:29696
v_mfma_f32_16x16x32_bf16 v[124:127], v[220:223], v[236:239], v[124:127]
ds_read_b64_tr_b16 v[28:29], v9 offset:12288
v_mfma_f32_16x16x32_bf16 v[128:131], v[220:223], v[240:243], v[128:131]
ds_read_b64_tr_b16 v[30:31], v9 offset:18432
v_mfma_f32_16x16x32_bf16 v[132:135], v[220:223], v[244:247], v[132:135]
ds_read_b64_tr_b16 v[32:33], v10 offset:12288
v_mfma_f32_16x16x32_bf16 v[136:139], v[224:227], v[228:231], v[136:139]
ds_read_b64_tr_b16 v[34:35], v10 offset:18432
v_mfma_f32_16x16x32_bf16 v[140:143], v[224:227], v[232:235], v[140:143]
v_mfma_f32_16x16x32_bf16 v[144:147], v[224:227], v[236:239], v[144:147]
v_mfma_f32_16x16x32_bf16 v[148:151], v[224:227], v[240:243], v[148:151]
v_mfma_f32_16x16x32_bf16 v[152:155], v[224:227], v[244:247], v[152:155]
s_waitcnt lgkmcnt(0)
s_barrier
v_mfma_f32_16x16x32_bf16 v[96:99], v[24:27], v[36:39], v[96:99]
ds_read_b64_tr_b16 v[216:217], v8 offset:24576
v_mfma_f32_16x16x32_bf16 v[100:103], v[24:27], v[40:43], v[100:103]
ds_read_b64_tr_b16 v[218:219], v8 offset:30720
v_mfma_f32_16x16x32_bf16 v[104:107], v[24:27], v[44:47], v[104:107]
ds_read_b128 v[228:231], v4 offset:30720
v_mfma_f32_16x16x32_bf16 v[108:111], v[24:27], v[48:51], v[108:111]
ds_read_b128 v[232:235], v4 offset:31744
v_mfma_f32_16x16x32_bf16 v[112:115], v[24:27], v[52:55], v[112:115]
ds_read_b128 v[236:239], v4 offset:32768
v_mfma_f32_16x16x32_bf16 v[116:119], v[28:31], v[36:39], v[116:119]
ds_read_b128 v[240:243], v4 offset:33792
v_mfma_f32_16x16x32_bf16 v[120:123], v[28:31], v[40:43], v[120:123]
ds_read_b128 v[244:247], v4 offset:34816
v_mfma_f32_16x16x32_bf16 v[124:127], v[28:31], v[44:47], v[124:127]
ds_read_b64_tr_b16 v[220:221], v9 offset:24576
v_mfma_f32_16x16x32_bf16 v[128:131], v[28:31], v[48:51], v[128:131]
ds_read_b64_tr_b16 v[222:223], v9 offset:30720
v_mfma_f32_16x16x32_bf16 v[132:135], v[28:31], v[52:55], v[132:135]
ds_read_b64_tr_b16 v[224:225], v10 offset:24576
v_mfma_f32_16x16x32_bf16 v[136:139], v[32:35], v[36:39], v[136:139]
ds_read_b64_tr_b16 v[226:227], v10 offset:30720
v_mfma_f32_16x16x32_bf16 v[140:143], v[32:35], v[40:43], v[140:143]
v_mfma_f32_16x16x32_bf16 v[144:147], v[32:35], v[44:47], v[144:147]
v_mfma_f32_16x16x32_bf16 v[148:151], v[32:35], v[48:51], v[148:151]
v_mfma_f32_16x16x32_bf16 v[152:155], v[32:35], v[52:55], v[152:155]
s_waitcnt lgkmcnt(0)
s_barrier
v_mfma_f32_16x16x32_bf16 v[96:99], v[216:219], v[228:231], v[96:99]
ds_read_b64_tr_b16 v[24:25], v8 offset:36864
v_mfma_f32_16x16x32_bf16 v[100:103], v[216:219], v[232:235], v[100:103]
ds_read_b64_tr_b16 v[26:27], v8 offset:43008
v_mfma_f32_16x16x32_bf16 v[104:107], v[216:219], v[236:239], v[104:107]
ds_read_b128 v[36:39], v4 offset:35840
v_mfma_f32_16x16x32_bf16 v[108:111], v[216:219], v[240:243], v[108:111]
ds_read_b128 v[40:43], v4 offset:36864
v_mfma_f32_16x16x32_bf16 v[112:115], v[216:219], v[244:247], v[112:115]
ds_read_b128 v[44:47], v4 offset:37888
v_mfma_f32_16x16x32_bf16 v[116:119], v[220:223], v[228:231], v[116:119]
ds_read_b128 v[48:51], v4 offset:38912
v_mfma_f32_16x16x32_bf16 v[120:123], v[220:223], v[232:235], v[120:123]
ds_read_b128 v[52:55], v4 offset:39936
v_mfma_f32_16x16x32_bf16 v[124:127], v[220:223], v[236:239], v[124:127]
ds_read_b64_tr_b16 v[28:29], v9 offset:36864
v_mfma_f32_16x16x32_bf16 v[128:131], v[220:223], v[240:243], v[128:131]
ds_read_b64_tr_b16 v[30:31], v9 offset:43008
v_mfma_f32_16x16x32_bf16 v[132:135], v[220:223], v[244:247], v[132:135]
ds_read_b64_tr_b16 v[32:33], v10 offset:36864
v_mfma_f32_16x16x32_bf16 v[136:139], v[224:227], v[228:231], v[136:139]
ds_read_b64_tr_b16 v[34:35], v10 offset:43008
v_mfma_f32_16x16x32_bf16 v[140:143], v[224:227], v[232:235], v[140:143]
v_mfma_f32_16x16x32_bf16 v[144:147], v[224:227], v[236:239], v[144:147]
v_mfma_f32_16x16x32_bf16 v[148:151], v[224:227], v[240:243], v[148:151]
v_mfma_f32_16x16x32_bf16 v[152:155], v[224:227], v[244:247], v[152:155]
s_waitcnt lgkmcnt(0)
s_barrier
v_mfma_f32_16x16x32_bf16 v[96:99], v[24:27], v[36:39], v[96:99]
v_mfma_f32_16x16x32_bf16 v[100:103], v[24:27], v[40:43], v[100:103]
v_mfma_f32_16x16x32_bf16 v[104:107], v[24:27], v[44:47], v[104:107]
v_mfma_f32_16x16x32_bf16 v[108:111], v[24:27], v[48:51], v[108:111]
v_mfma_f32_16x16x32_bf16 v[112:115], v[24:27], v[52:55], v[112:115]
v_mfma_f32_16x16x32_bf16 v[116:119], v[28:31], v[36:39], v[116:119]
v_mfma_f32_16x16x32_bf16 v[120:123], v[28:31], v[40:43], v[120:123]
v_mfma_f32_16x16x32_bf16 v[124:127], v[28:31], v[44:47], v[124:127]
v_mfma_f32_16x16x32_bf16 v[128:131], v[28:31], v[48:51], v[128:131]
v_mfma_f32_16x16x32_bf16 v[132:135], v[28:31], v[52:55], v[132:135]
v_mfma_f32_16x16x32_bf16 v[136:139], v[32:35], v[36:39], v[136:139]
v_mfma_f32_16x16x32_bf16 v[140:143], v[32:35], v[40:43], v[140:143]
v_mfma_f32_16x16x32_bf16 v[144:147], v[32:35], v[44:47], v[144:147]
v_mfma_f32_16x16x32_bf16 v[148:151], v[32:35], v[48:51], v[148:151]
v_mfma_f32_16x16x32_bf16 v[152:155], v[32:35], v[52:55], v[152:155]
ds_read_b128 v[216:219], v18 offset:1280
ds_read_b128 v[220:223], v18 offset:1536
ds_read_b128 v[224:227], v18 offset:1792
ds_read_b128 v[228:231], v18 offset:2048
ds_read_b128 v[232:235], v18 offset:2304
s_waitcnt lgkmcnt(0)
v_add_f32 v216, v216, v217
v_add_f32 v218, v218, v219
v_add_f32 v216, v216, v218
v_rcp_f32 v19, v216
v_add_f32 v220, v220, v221
v_add_f32 v222, v222, v223
v_add_f32 v220, v220, v222
v_rcp_f32 v20, v220
v_add_f32 v224, v224, v225
v_add_f32 v226, v226, v227
v_add_f32 v224, v224, v226
v_rcp_f32 v21, v224
v_add_f32 v228, v228, v229
v_add_f32 v230, v230, v231
v_add_f32 v228, v228, v230
v_rcp_f32 v22, v228
v_add_f32 v232, v232, v233
v_add_f32 v234, v234, v235
v_add_f32 v232, v232, v234
v_rcp_f32 v23, v232
s_nop 7
v_mul_f32 v96, v96, v19
v_mul_f32 v97, v97, v19
v_mul_f32 v98, v98, v19
v_mul_f32 v99, v99, v19
v_cvt_pk_bf16_f32 v96, v96, v97
v_cvt_pk_bf16_f32 v97, v98, v99
ds_write_b64 v14, v[96:97] offset:30720
v_mul_f32 v100, v100, v20
v_mul_f32 v101, v101, v20
v_mul_f32 v102, v102, v20
v_mul_f32 v103, v103, v20
v_cvt_pk_bf16_f32 v100, v100, v101
v_cvt_pk_bf16_f32 v101, v102, v103
ds_write_b64 v14, v[100:101] offset:31744
v_mul_f32 v104, v104, v21
v_mul_f32 v105, v105, v21
v_mul_f32 v106, v106, v21
v_mul_f32 v107, v107, v21
v_cvt_pk_bf16_f32 v104, v104, v105
v_cvt_pk_bf16_f32 v105, v106, v107
ds_write_b64 v14, v[104:105] offset:32768
v_mul_f32 v108, v108, v22
v_mul_f32 v109, v109, v22
v_mul_f32 v110, v110, v22
v_mul_f32 v111, v111, v22
v_cvt_pk_bf16_f32 v108, v108, v109
v_cvt_pk_bf16_f32 v109, v110, v111
ds_write_b64 v14, v[108:109] offset:33792
v_mul_f32 v112, v112, v23
v_mul_f32 v113, v113, v23
v_mul_f32 v114, v114, v23
v_mul_f32 v115, v115, v23
v_cvt_pk_bf16_f32 v112, v112, v113
v_cvt_pk_bf16_f32 v113, v114, v115
ds_write_b64 v14, v[112:113] offset:34816
v_mul_f32 v116, v116, v19
v_mul_f32 v117, v117, v19
v_mul_f32 v118, v118, v19
v_mul_f32 v119, v119, v19
v_cvt_pk_bf16_f32 v116, v116, v117
v_cvt_pk_bf16_f32 v117, v118, v119
ds_write_b64 v15, v[116:117] offset:30720
v_mul_f32 v120, v120, v20
v_mul_f32 v121, v121, v20
v_mul_f32 v122, v122, v20
v_mul_f32 v123, v123, v20
v_cvt_pk_bf16_f32 v120, v120, v121
v_cvt_pk_bf16_f32 v121, v122, v123
ds_write_b64 v15, v[120:121] offset:31744
v_mul_f32 v124, v124, v21
v_mul_f32 v125, v125, v21
v_mul_f32 v126, v126, v21
v_mul_f32 v127, v127, v21
v_cvt_pk_bf16_f32 v124, v124, v125
v_cvt_pk_bf16_f32 v125, v126, v127
ds_write_b64 v15, v[124:125] offset:32768
v_mul_f32 v128, v128, v22
v_mul_f32 v129, v129, v22
v_mul_f32 v130, v130, v22
v_mul_f32 v131, v131, v22
v_cvt_pk_bf16_f32 v128, v128, v129
v_cvt_pk_bf16_f32 v129, v130, v131
ds_write_b64 v15, v[128:129] offset:33792
v_mul_f32 v132, v132, v23
v_mul_f32 v133, v133, v23
v_mul_f32 v134, v134, v23
v_mul_f32 v135, v135, v23
v_cvt_pk_bf16_f32 v132, v132, v133
v_cvt_pk_bf16_f32 v133, v134, v135
ds_write_b64 v15, v[132:133] offset:34816
v_mul_f32 v136, v136, v19
v_mul_f32 v137, v137, v19
v_mul_f32 v138, v138, v19
v_mul_f32 v139, v139, v19
v_cvt_pk_bf16_f32 v136, v136, v137
v_cvt_pk_bf16_f32 v137, v138, v139
ds_write_b64 v16, v[136:137] offset:30720
v_mul_f32 v140, v140, v20
v_mul_f32 v141, v141, v20
v_mul_f32 v142, v142, v20
v_mul_f32 v143, v143, v20
v_cvt_pk_bf16_f32 v140, v140, v141
v_cvt_pk_bf16_f32 v141, v142, v143
ds_write_b64 v16, v[140:141] offset:31744
v_mul_f32 v144, v144, v21
v_mul_f32 v145, v145, v21
v_mul_f32 v146, v146, v21
v_mul_f32 v147, v147, v21
v_cvt_pk_bf16_f32 v144, v144, v145
v_cvt_pk_bf16_f32 v145, v146, v147
ds_write_b64 v16, v[144:145] offset:32768
v_mul_f32 v148, v148, v22
v_mul_f32 v149, v149, v22
v_mul_f32 v150, v150, v22
v_mul_f32 v151, v151, v22
v_cvt_pk_bf16_f32 v148, v148, v149
v_cvt_pk_bf16_f32 v149, v150, v151
ds_write_b64 v16, v[148:149] offset:33792
v_mul_f32 v152, v152, v23
v_mul_f32 v153, v153, v23
v_mul_f32 v154, v154, v23
v_mul_f32 v155, v155, v23
v_cvt_pk_bf16_f32 v152, v152, v153
v_cvt_pk_bf16_f32 v153, v154, v155
ds_write_b64 v16, v[152:153] offset:34816
s_waitcnt lgkmcnt(0)
s_barrier
s_branch .Lfin
.Lf_end:
s_endpgm
.LP_start:
s_mul_i32 s33, s51, 3072
s_mul_i32 s44, s67, 196608
s_add_u32 s44, s44, s33
s_mul_i32 s35, s67, 384
s_mul_i32 s39, s51, 10240
s_add_u32 s39, s39, 110592
s_and_b32 s4, s51, 1
s_mul_i32 s5, s51, 320
s_lshl_b32 s6, s4, 6
s_add_u32 s45, s5, s6
s_xor_b32 s4, s4, 1
s_lshl_b32 s6, s4, 8
s_add_u32 s46, s5, s6
s_mul_i32 s40, s51, 2560
s_mul_i32 s41, s51, 25600
v_lshlrev_b32 v4, 4, v0
v_add_u32 v4, 49152, v4
v_lshrrev_b32 v8, 3, v0
v_mul_u32_u24 v8, 1280, v8
s_lshl_b32 s4, s51, 1
v_add_u32 v24, s4, v16
v_and_b32 v24, 3, v24
v_lshlrev_b32 v24, 1, v24
v_and_b32 v25, 7, v0
v_xor_b32 v24, v24, v25
v_lshl_add_u32 v8, v24, 4, v8
s_add_u32 m0, s40, 139264
s_add_u32 s62, s41, 0
buffer_load_dwordx4 v8, s[20:23], s62 offen offset:0  lds
s_add_u32 s62, s41, 9216
buffer_load_dwordx4 v8, s[20:23], s62 offen offset:1024  lds
s_mov_b32 exec_hi, 0
s_add_u32 s62, s41, 18432
buffer_load_dwordx4 v8, s[20:23], s62 offen offset:2048  lds
s_mov_b32 exec_hi, -1
s_add_u32 m0, s33, 90112
s_add_u32 s60, s35, 0
buffer_load_dwordx4 v5, s[16:19], s60 offen offset:0  lds
buffer_load_dwordx4 v6, s[16:19], s60 offen offset:1024  lds
buffer_load_dwordx4 v7, s[16:19], s60 offen offset:2048  lds
s_add_u32 m0, s33, 102400
s_add_u32 s60, s35, 393216
buffer_load_dwordx4 v5, s[16:19], s60 offen offset:0  lds
buffer_load_dwordx4 v6, s[16:19], s60 offen offset:1024  lds
buffer_load_dwordx4 v7, s[16:19], s60 offen offset:2048  lds
s_add_u32 m0, s40, 149504
s_add_u32 s62, s41, 128
buffer_load_dwordx4 v8, s[20:23], s62 offen offset:0  lds
s_add_u32 s62, s41, 9344
buffer_load_dwordx4 v8, s[20:23], s62 offen offset:1024  lds
s_mov_b32 exec_hi, 0
s_add_u32 s62, s41, 18560
buffer_load_dwordx4 v8, s[20:23], s62 offen offset:2048  lds
s_mov_b32 exec_hi, -1
s_add_u32 m0, s33, 114688
s_add_u32 s60, s35, 786432
buffer_load_dwordx4 v5, s[16:19], s60 offen offset:0  lds
buffer_load_dwordx4 v6, s[16:19], s60 offen offset:1024  lds
buffer_load_dwordx4 v7, s[16:19], s60 offen offset:2048  lds
s_add_u32 m0, s33, 126976
s_add_u32 s60, s35, 1179648
buffer_load_dwordx4 v5, s[16:19], s60 offen offset:0  lds
buffer_load_dwordx4 v6, s[16:19], s60 offen offset:1024  lds
buffer_load_dwordx4 v7, s[16:19], s60 offen offset:2048  lds
v_lshrrev_b32 v24, 3, v0
v_and_b32 v25, 7, v0
v_and_b32 v26, 2, v24
v_xor_b32 v25, v25, v26
v_mul_u32_u24 v24, 1280, v24
v_lshl_add_u32 v9, v25, 4, v24
v_xor_b32 v25, 4, v25
v_lshl_add_u32 v10, v25, 4, v24
v_add_u32 v10, 9216, v10
v_lshrrev_b32 v24, 2, v0
v_lshrrev_b32 v25, 5, v0
v_lshlrev_b32 v25, 1, v25
v_xor_b32 v25, v25, v19
v_mul_u32_u24 v24, 1280, v24
v_lshl_add_u32 v11, v25, 4, v24
v_lshlrev_b32 v24, 3, v19
v_add_u32 v24, s39, v24
v_lshl_add_u32 v12, v22, 7, v24
v_lshl_add_u32 v12, v20, 5, v12
v_lshl_add_u32 v13, v22, 6, v24
v_lshl_add_u32 v13, v21, 5, v13
v_add_u32 v13, 8192, v13
v_mov_b32 v56, 0
v_mov_b32 v57, 0
v_mov_b32 v58, 0
v_mov_b32 v59, 0
v_mov_b32 v60, 0
v_mov_b32 v61, 0
v_mov_b32 v62, 0
v_mov_b32 v63, 0
v_mov_b32 v64, 0
v_mov_b32 v65, 0
v_mov_b32 v66, 0
v_mov_b32 v67, 0
v_mov_b32 v68, 0
v_mov_b32 v69, 0
v_mov_b32 v70, 0
v_mov_b32 v71, 0
v_mov_b32 v72, 0
v_mov_b32 v73, 0
v_mov_b32 v74, 0
v_mov_b32 v75, 0
v_mov_b32 v76, 0
v_mov_b32 v77, 0
v_mov_b32 v78, 0
v_mov_b32 v79, 0
v_mov_b32 v80, 0
v_mov_b32 v81, 0
v_mov_b32 v82, 0
v_mov_b32 v83, 0
v_mov_b32 v84, 0
v_mov_b32 v85, 0
v_mov_b32 v86, 0
v_mov_b32 v87, 0
v_mov_b32 v88, 0
v_mov_b32 v89, 0
v_mov_b32 v90, 0
v_mov_b32 v91, 0
v_mov_b32 v92, 0
v_mov_b32 v93, 0
v_mov_b32 v94, 0
v_mov_b32 v95, 0
v_mov_b32 v96, 0
v_mov_b32 v97, 0
v_mov_b32 v98, 0
v_mov_b32 v99, 0
v_mov_b32 v100, 0
v_mov_b32 v101, 0
v_mov_b32 v102, 0
v_mov_b32 v103, 0
v_mov_b32 v104, 0
v_mov_b32 v105, 0
v_mov_b32 v106, 0
v_mov_b32 v107, 0
v_mov_b32 v108, 0
v_mov_b32 v109, 0
v_mov_b32 v110, 0
v_mov_b32 v111, 0
v_mov_b32 v112, 0
v_mov_b32 v113, 0
v_mov_b32 v114, 0
v_mov_b32 v115, 0
v_mov_b32 v116, 0
v_mov_b32 v117, 0
v_mov_b32 v118, 0
v_mov_b32 v119, 0
v_mov_b32 v120, 0
v_mov_b32 v121, 0
v_mov_b32 v122, 0
v_mov_b32 v123, 0
v_mov_b32 v124, 0
v_mov_b32 v125, 0
v_mov_b32 v126, 0
v_mov_b32 v127, 0
v_mov_b32 v128, 0
v_mov_b32 v129, 0
v_mov_b32 v130, 0
v_mov_b32 v131, 0
v_mov_b32 v132, 0
v_mov_b32 v133, 0
v_mov_b32 v134, 0
v_mov_b32 v135, 0
v_mov_b32 v136, 0
v_mov_b32 v137, 0
v_mov_b32 v138, 0
v_mov_b32 v139, 0
v_mov_b32 v140, 0
v_mov_b32 v141, 0
v_mov_b32 v142, 0
v_mov_b32 v143, 0
v_mov_b32 v144, 0
v_mov_b32 v145, 0
v_mov_b32 v146, 0
v_mov_b32 v147, 0
v_mov_b32 v148, 0
v_mov_b32 v149, 0
v_mov_b32 v150, 0
v_mov_b32 v151, 0
v_mov_b32 v152, 0
v_mov_b32 v153, 0
v_mov_b32 v154, 0
v_mov_b32 v155, 0
v_mov_b32 v156, 0
v_mov_b32 v157, 0
v_mov_b32 v158, 0
v_mov_b32 v159, 0
v_mov_b32 v160, 0
v_mov_b32 v161, 0
v_mov_b32 v162, 0
v_mov_b32 v163, 0
v_mov_b32 v164, 0
v_mov_b32 v165, 0
v_mov_b32 v166, 0
v_mov_b32 v167, 0
v_mov_b32 v168, 0
v_mov_b32 v169, 0
v_mov_b32 v170, 0
v_mov_b32 v171, 0
v_mov_b32 v172, 0
v_mov_b32 v173, 0
v_mov_b32 v174, 0
v_mov_b32 v175, 0
v_mov_b32 v176, 0
v_mov_b32 v177, 0
v_mov_b32 v178, 0
v_mov_b32 v179, 0
v_mov_b32 v180, 0
v_mov_b32 v181, 0
v_mov_b32 v182, 0
v_mov_b32 v183, 0
v_mov_b32 v184, 0
v_mov_b32 v185, 0
v_mov_b32 v186, 0
v_mov_b32 v187, 0
v_mov_b32 v188, 0
v_mov_b32 v189, 0
v_mov_b32 v190, 0
v_mov_b32 v191, 0
v_mov_b32 v192, 0
v_mov_b32 v193, 0
v_mov_b32 v194, 0
v_mov_b32 v195, 0
v_mov_b32 v196, 0
v_mov_b32 v197, 0
v_mov_b32 v198, 0
v_mov_b32 v199, 0
v_mov_b32 v200, 0
v_mov_b32 v201, 0
v_mov_b32 v202, 0
v_mov_b32 v203, 0
v_mov_b32 v204, 0
v_mov_b32 v205, 0
v_mov_b32 v206, 0
v_mov_b32 v207, 0
v_mov_b32 v208, 0
v_mov_b32 v209, 0
v_mov_b32 v210, 0
v_mov_b32 v211, 0
v_mov_b32 v212, 0
v_mov_b32 v213, 0
v_mov_b32 v214, 0
v_mov_b32 v215, 0
v_mov_b32 v216, 0
v_mov_b32 v217, 0
v_mov_b32 v218, 0
v_mov_b32 v219, 0
v_mov_b32 v220, 0
v_mov_b32 v221, 0
v_mov_b32 v222, 0
v_mov_b32 v223, 0
v_mov_b32 v224, 0
v_mov_b32 v225, 0
v_mov_b32 v226, 0
v_mov_b32 v227, 0
v_mov_b32 v228, 0
v_mov_b32 v229, 0
v_mov_b32 v230, 0
v_mov_b32 v231, 0
v_mov_b32 v232, 0
v_mov_b32 v233, 0
v_mov_b32 v234, 0
v_mov_b32 v235, 0
v_mov_b32 v236, 0
v_mov_b32 v237, 0
v_mov_b32 v238, 0
v_mov_b32 v239, 0
v_mov_b32 v240, 0
v_mov_b32 v241, 0
v_mov_b32 v242, 0
v_mov_b32 v243, 0
v_mov_b32 v244, 0
v_mov_b32 v245, 0
v_mov_b32 v246, 0
v_mov_b32 v247, 0
v_mov_b32 v248, 0
v_mov_b32 v249, 0
v_mov_b32 v250, 0
v_mov_b32 v251, 0
v_mov_b32 v252, 0
v_mov_b32 v253, 0
v_mov_b32 v254, 0
v_mov_b32 v255, 0
s_waitcnt vmcnt(12)
s_barrier
s_waitcnt vmcnt(9)
s_barrier
s_add_u32 m0, s33, 90112
s_add_u32 s60, s35, 1572864
buffer_load_dwordx4 v5, s[16:19], s60 offen offset:0  lds
buffer_load_dwordx4 v6, s[16:19], s60 offen offset:1024  lds
buffer_load_dwordx4 v7, s[16:19], s60 offen offset:2048  lds
s_waitcnt vmcnt(6)
s_barrier
s_add_u32 m0, s40, 139264
s_add_u32 s62, s41, 256
buffer_load_dwordx4 v8, s[20:23], s62 offen offset:0  lds
s_add_u32 s62, s41, 9472
buffer_load_dwordx4 v8, s[20:23], s62 offen offset:1024  lds
s_mov_b32 exec_hi, 0
s_add_u32 s62, s41, 18688
buffer_load_dwordx4 v8, s[20:23], s62 offen offset:2048  lds
s_mov_b32 exec_hi, -1
s_add_u32 m0, s33, 102400
s_add_u32 s60, s35, 1966080
buffer_load_dwordx4 v5, s[16:19], s60 offen offset:0  lds
buffer_load_dwordx4 v6, s[16:19], s60 offen offset:1024  lds
buffer_load_dwordx4 v7, s[16:19], s60 offen offset:2048  lds
s_waitcnt vmcnt(9)
s_barrier
s_add_u32 m0, s33, 114688
s_add_u32 s60, s35, 2359296
buffer_load_dwordx4 v5, s[16:19], s60 offen offset:0  lds
buffer_load_dwordx4 v6, s[16:19], s60 offen offset:1024  lds
buffer_load_dwordx4 v7, s[16:19], s60 offen offset:2048  lds
s_waitcnt vmcnt(6)
s_barrier
s_add_u32 m0, s40, 149504
s_add_u32 s62, s41, 384
buffer_load_dwordx4 v8, s[20:23], s62 offen offset:0  lds
s_add_u32 s62, s41, 9600
buffer_load_dwordx4 v8, s[20:23], s62 offen offset:1024  lds
s_mov_b32 exec_hi, 0
s_add_u32 s62, s41, 18816
buffer_load_dwordx4 v8, s[20:23], s62 offen offset:2048  lds
s_mov_b32 exec_hi, -1
s_add_u32 m0, s33, 126976
s_add_u32 s60, s35, 2752512
buffer_load_dwordx4 v5, s[16:19], s60 offen offset:0  lds
buffer_load_dwordx4 v6, s[16:19], s60 offen offset:1024  lds
buffer_load_dwordx4 v7, s[16:19], s60 offen offset:2048  lds
s_waitcnt vmcnt(9)
s_barrier
s_add_u32 m0, s33, 90112
s_add_u32 s60, s35, 3145728
buffer_load_dwordx4 v5, s[16:19], s60 offen offset:0  lds
buffer_load_dwordx4 v6, s[16:19], s60 offen offset:1024  lds
buffer_load_dwordx4 v7, s[16:19], s60 offen offset:2048  lds
s_waitcnt vmcnt(6)
s_barrier
s_add_u32 m0, s40, 139264
s_add_u32 s62, s41, 512
buffer_load_dwordx4 v8, s[20:23], s62 offen offset:0  lds
s_add_u32 s62, s41, 9728
buffer_load_dwordx4 v8, s[20:23], s62 offen offset:1024  lds
s_mov_b32 exec_hi, 0
s_add_u32 s62, s41, 18944
buffer_load_dwordx4 v8, s[20:23], s62 offen offset:2048  lds
s_mov_b32 exec_hi, -1
s_add_u32 m0, s33, 102400
s_add_u32 s60, s35, 3538944
buffer_load_dwordx4 v5, s[16:19], s60 offen offset:0  lds
buffer_load_dwordx4 v6, s[16:19], s60 offen offset:1024  lds
buffer_load_dwordx4 v7, s[16:19], s60 offen offset:2048  lds
s_waitcnt vmcnt(9)
s_barrier
s_add_u32 m0, s33, 114688
s_add_u32 s60, s35, 3932160
buffer_load_dwordx4 v5, s[16:19], s60 offen offset:0  lds
buffer_load_dwordx4 v6, s[16:19], s60 offen offset:1024  lds
buffer_load_dwordx4 v7, s[16:19], s60 offen offset:2048  lds
s_waitcnt vmcnt(6)
s_barrier
s_add_u32 m0, s40, 149504
s_add_u32 s62, s41, 640
buffer_load_dwordx4 v8, s[20:23], s62 offen offset:0  lds
s_add_u32 s62, s41, 9856
buffer_load_dwordx4 v8, s[20:23], s62 offen offset:1024  lds
s_mov_b32 exec_hi, 0
s_add_u32 s62, s41, 19072
buffer_load_dwordx4 v8, s[20:23], s62 offen offset:2048  lds
s_mov_b32 exec_hi, -1
s_add_u32 m0, s33, 126976
s_add_u32 s60, s35, 4325376
buffer_load_dwordx4 v5, s[16:19], s60 offen offset:0  lds
buffer_load_dwordx4 v6, s[16:19], s60 offen offset:1024  lds
buffer_load_dwordx4 v7, s[16:19], s60 offen offset:2048  lds
s_waitcnt vmcnt(9)
s_barrier
s_add_u32 m0, s33, 90112
s_add_u32 s60, s35, 4718592
buffer_load_dwordx4 v5, s[16:19], s60 offen offset:0  lds
buffer_load_dwordx4 v6, s[16:19], s60 offen offset:1024  lds
buffer_load_dwordx4 v7, s[16:19], s60 offen offset:2048  lds
s_waitcnt vmcnt(6)
s_barrier
s_add_u32 m0, s40, 139264
s_add_u32 s62, s41, 768
buffer_load_dwordx4 v8, s[20:23], s62 offen offset:0  lds
s_add_u32 s62, s41, 9984
buffer_load_dwordx4 v8, s[20:23], s62 offen offset:1024  lds
s_mov_b32 exec_hi, 0
s_add_u32 s62, s41, 19200
buffer_load_dwordx4 v8, s[20:23], s62 offen offset:2048  lds
s_mov_b32 exec_hi, -1
s_add_u32 m0, s33, 102400
s_add_u32 s60, s35, 5111808
buffer_load_dwordx4 v5, s[16:19], s60 offen offset:0  lds
buffer_load_dwordx4 v6, s[16:19], s60 offen offset:1024  lds
buffer_load_dwordx4 v7, s[16:19], s60 offen offset:2048  lds
s_waitcnt vmcnt(9)
s_barrier
s_add_u32 m0, s33, 114688
s_add_u32 s60, s35, 5505024
buffer_load_dwordx4 v5, s[16:19], s60 offen offset:0  lds
buffer_load_dwordx4 v6, s[16:19], s60 offen offset:1024  lds
buffer_load_dwordx4 v7, s[16:19], s60 offen offset:2048  lds
s_waitcnt vmcnt(6)
s_barrier
s_add_u32 m0, s40, 149504
s_add_u32 s62, s41, 896
buffer_load_dwordx4 v8, s[20:23], s62 offen offset:0  lds
s_add_u32 s62, s41, 10112
buffer_load_dwordx4 v8, s[20:23], s62 offen offset:1024  lds
s_mov_b32 exec_hi, 0
s_add_u32 s62, s41, 19328
buffer_load_dwordx4 v8, s[20:23], s62 offen offset:2048  lds
s_mov_b32 exec_hi, -1
s_add_u32 m0, s33, 126976
s_add_u32 s60, s35, 5898240
buffer_load_dwordx4 v5, s[16:19], s60 offen offset:0  lds
buffer_load_dwordx4 v6, s[16:19], s60 offen offset:1024  lds
buffer_load_dwordx4 v7, s[16:19], s60 offen offset:2048  lds
s_waitcnt vmcnt(9)
s_barrier
s_add_u32 m0, s33, 90112
s_add_u32 s60, s35, 6291456
buffer_load_dwordx4 v5, s[16:19], s60 offen offset:0  lds
buffer_load_dwordx4 v6, s[16:19], s60 offen offset:1024  lds
buffer_load_dwordx4 v7, s[16:19], s60 offen offset:2048  lds
s_waitcnt vmcnt(6)
s_barrier
s_add_u32 m0, s40, 139264
s_add_u32 s62, s41, 1024
buffer_load_dwordx4 v8, s[20:23], s62 offen offset:0  lds
s_add_u32 s62, s41, 10240
buffer_load_dwordx4 v8, s[20:23], s62 offen offset:1024  lds
s_mov_b32 exec_hi, 0
s_add_u32 s62, s41, 19456
buffer_load_dwordx4 v8, s[20:23], s62 offen offset:2048  lds
s_mov_b32 exec_hi, -1
s_add_u32 m0, s33, 102400
s_add_u32 s60, s35, 6684672
buffer_load_dwordx4 v5, s[16:19], s60 offen offset:0  lds
buffer_load_dwordx4 v6, s[16:19], s60 offen offset:1024  lds
buffer_load_dwordx4 v7, s[16:19], s60 offen offset:2048  lds
s_waitcnt vmcnt(9)
s_barrier
s_add_u32 m0, s33, 114688
s_add_u32 s60, s35, 7077888
buffer_load_dwordx4 v5, s[16:19], s60 offen offset:0  lds
buffer_load_dwordx4 v6, s[16:19], s60 offen offset:1024  lds
buffer_load_dwordx4 v7, s[16:19], s60 offen offset:2048  lds
s_waitcnt vmcnt(6)
s_barrier
s_add_u32 m0, s40, 149504
s_add_u32 s62, s41, 1152
buffer_load_dwordx4 v8, s[20:23], s62 offen offset:0  lds
s_add_u32 s62, s41, 10368
buffer_load_dwordx4 v8, s[20:23], s62 offen offset:1024  lds
s_mov_b32 exec_hi, 0
s_add_u32 s62, s41, 19584
buffer_load_dwordx4 v8, s[20:23], s62 offen offset:2048  lds
s_mov_b32 exec_hi, -1
s_add_u32 m0, s33, 126976
s_add_u32 s60, s35, 7471104
buffer_load_dwordx4 v5, s[16:19], s60 offen offset:0  lds
buffer_load_dwordx4 v6, s[16:19], s60 offen offset:1024  lds
buffer_load_dwordx4 v7, s[16:19], s60 offen offset:2048  lds
s_add_u32 m0, s33, 0
s_add_u32 s61, s44, 0
buffer_load_dwordx4 v1, s[8:11], s61 offen offset:0 nt lds
buffer_load_dwordx4 v2, s[8:11], s61 offen offset:1024 nt lds
buffer_load_dwordx4 v3, s[8:11], s61 offen offset:2048 nt lds
s_waitcnt vmcnt(12)
s_barrier
s_add_u32 m0, s33, 12288
s_add_u32 s61, s44, 12288
buffer_load_dwordx4 v1, s[8:11], s61 offen offset:0 nt lds
buffer_load_dwordx4 v2, s[8:11], s61 offen offset:1024 nt lds
buffer_load_dwordx4 v3, s[8:11], s61 offen offset:2048 nt lds
s_waitcnt vmcnt(9)
s_barrier
s_add_u32 m0, s33, 24576
s_add_u32 s61, s44, 24576
buffer_load_dwordx4 v1, s[8:11], s61 offen offset:0 nt lds
buffer_load_dwordx4 v2, s[8:11], s61 offen offset:1024 nt lds
buffer_load_dwordx4 v3, s[8:11], s61 offen offset:2048 nt lds
s_waitcnt vmcnt(9)
s_barrier
s_add_u32 m0, s33, 36864
s_add_u32 s61, s44, 36864
buffer_load_dwordx4 v1, s[8:11], s61 offen offset:0 nt lds
buffer_load_dwordx4 v2, s[8:11], s61 offen offset:1024 nt lds
buffer_load_dwordx4 v3, s[8:11], s61 offen offset:2048 nt lds
s_barrier
s_waitcnt vmcnt(0)
s_waitcnt lgkmcnt(0)
s_barrier
s_add_u32 s3, s38, 0
s_and_b32 s3, s3, 3
s_xor_b32 s3, s3, s67
s_mul_i32 s34, s3, 196608
s_add_u32 s34, s34, s33
s_barrier
s_branch .LP_noop
.LP_loop:
s_add_u32 s3, s38, 0
s_and_b32 s3, s3, 3
s_xor_b32 s3, s3, s67
s_mul_i32 s34, s3, 196608
s_add_u32 s34, s34, s33
ds_read_b128 v[36:39], v4 offset:30720
ds_read_b128 v[40:43], v4 offset:31744
ds_read_b128 v[44:47], v4 offset:32768
ds_read_b128 v[48:51], v4 offset:33792
ds_read_b128 v[52:55], v4 offset:34816
s_waitcnt vmcnt(6)
ds_read_b64_tr_b16 v[16:17], v12 offset:0
ds_read_b64_tr_b16 v[18:19], v12 offset:512
v_xor_b32 v15, 32, v12
ds_read_b64_tr_b16 v[20:21], v15 offset:0
ds_read_b64_tr_b16 v[22:23], v15 offset:512
v_xor_b32 v14, 64, v12
ds_read_b64_tr_b16 v[24:25], v14 offset:0
ds_read_b64_tr_b16 v[26:27], v14 offset:512
v_xor_b32 v15, 96, v12
ds_read_b64_tr_b16 v[28:29], v15 offset:0
ds_read_b64_tr_b16 v[30:31], v15 offset:512
s_waitcnt lgkmcnt(6)
v_mfma_f32_16x16x32_bf16 v[56:59], v[16:19], v[36:39], v[56:59]
v_mfma_f32_16x16x32_bf16 v[60:63], v[16:19], v[40:43], v[60:63]
v_mfma_f32_16x16x32_bf16 v[64:67], v[16:19], v[44:47], v[64:67]
v_mfma_f32_16x16x32_bf16 v[68:71], v[16:19], v[48:51], v[68:71]
v_mfma_f32_16x16x32_bf16 v[72:75], v[16:19], v[52:55], v[72:75]
s_waitcnt vmcnt(2)
ds_read_b64_tr_b16 v[32:33], v12 offset:4096
ds_read_b64_tr_b16 v[34:35], v12 offset:4608
s_waitcnt lgkmcnt(6)
v_mfma_f32_16x16x32_bf16 v[76:79], v[20:23], v[36:39], v[76:79]
v_mfma_f32_16x16x32_bf16 v[80:83], v[20:23], v[40:43], v[80:83]
v_mfma_f32_16x16x32_bf16 v[84:87], v[20:23], v[44:47], v[84:87]
v_mfma_f32_16x16x32_bf16 v[88:91], v[20:23], v[48:51], v[88:91]
v_mfma_f32_16x16x32_bf16 v[92:95], v[20:23], v[52:55], v[92:95]
v_xor_b32 v15, 32, v12
ds_read_b64_tr_b16 v[16:17], v15 offset:4096
ds_read_b64_tr_b16 v[18:19], v15 offset:4608
s_waitcnt lgkmcnt(6)
v_mfma_f32_16x16x32_bf16 v[96:99], v[24:27], v[36:39], v[96:99]
v_mfma_f32_16x16x32_bf16 v[100:103], v[24:27], v[40:43], v[100:103]
v_mfma_f32_16x16x32_bf16 v[104:107], v[24:27], v[44:47], v[104:107]
v_mfma_f32_16x16x32_bf16 v[108:111], v[24:27], v[48:51], v[108:111]
v_mfma_f32_16x16x32_bf16 v[112:115], v[24:27], v[52:55], v[112:115]
v_xor_b32 v14, 64, v12
ds_read_b64_tr_b16 v[20:21], v14 offset:4096
ds_read_b64_tr_b16 v[22:23], v14 offset:4608
s_waitcnt lgkmcnt(6)
v_mfma_f32_16x16x32_bf16 v[116:119], v[28:31], v[36:39], v[116:119]
v_mfma_f32_16x16x32_bf16 v[120:123], v[28:31], v[40:43], v[120:123]
v_mfma_f32_16x16x32_bf16 v[124:127], v[28:31], v[44:47], v[124:127]
v_mfma_f32_16x16x32_bf16 v[128:131], v[28:31], v[48:51], v[128:131]
v_mfma_f32_16x16x32_bf16 v[132:135], v[28:31], v[52:55], v[132:135]
v_xor_b32 v15, 96, v12
ds_read_b64_tr_b16 v[24:25], v15 offset:4096
ds_read_b64_tr_b16 v[26:27], v15 offset:4608
s_waitcnt lgkmcnt(6)
v_mfma_f32_16x16x32_bf16 v[136:139], v[32:35], v[36:39], v[136:139]
v_mfma_f32_16x16x32_bf16 v[140:143], v[32:35], v[40:43], v[140:143]
v_mfma_f32_16x16x32_bf16 v[144:147], v[32:35], v[44:47], v[144:147]
v_mfma_f32_16x16x32_bf16 v[148:151], v[32:35], v[48:51], v[148:151]
v_mfma_f32_16x16x32_bf16 v[152:155], v[32:35], v[52:55], v[152:155]
s_waitcnt vmcnt(0)
ds_read_b64_tr_b16 v[28:29], v13 offset:0
ds_read_b64_tr_b16 v[30:31], v13 offset:256
s_waitcnt lgkmcnt(6)
v_mfma_f32_16x16x32_bf16 v[156:159], v[16:19], v[36:39], v[156:159]
v_mfma_f32_16x16x32_bf16 v[160:163], v[16:19], v[40:43], v[160:163]
v_mfma_f32_16x16x32_bf16 v[164:167], v[16:19], v[44:47], v[164:167]
v_mfma_f32_16x16x32_bf16 v[168:171], v[16:19], v[48:51], v[168:171]
v_mfma_f32_16x16x32_bf16 v[172:175], v[16:19], v[52:55], v[172:175]
v_xor_b32 v15, 32, v13
ds_read_b64_tr_b16 v[32:33], v15 offset:0
ds_read_b64_tr_b16 v[34:35], v15 offset:256
s_waitcnt lgkmcnt(6)
v_mfma_f32_16x16x32_bf16 v[176:179], v[20:23], v[36:39], v[176:179]
v_mfma_f32_16x16x32_bf16 v[180:183], v[20:23], v[40:43], v[180:183]
v_mfma_f32_16x16x32_bf16 v[184:187], v[20:23], v[44:47], v[184:187]
v_mfma_f32_16x16x32_bf16 v[188:191], v[20:23], v[48:51], v[188:191]
v_mfma_f32_16x16x32_bf16 v[192:195], v[20:23], v[52:55], v[192:195]
s_waitcnt lgkmcnt(4)
v_mfma_f32_16x16x32_bf16 v[196:199], v[24:27], v[36:39], v[196:199]
v_mfma_f32_16x16x32_bf16 v[200:203], v[24:27], v[40:43], v[200:203]
v_mfma_f32_16x16x32_bf16 v[204:207], v[24:27], v[44:47], v[204:207]
v_mfma_f32_16x16x32_bf16 v[208:211], v[24:27], v[48:51], v[208:211]
v_mfma_f32_16x16x32_bf16 v[212:215], v[24:27], v[52:55], v[212:215]
s_waitcnt lgkmcnt(2)
v_mfma_f32_16x16x32_bf16 v[216:219], v[28:31], v[36:39], v[216:219]
v_mfma_f32_16x16x32_bf16 v[220:223], v[28:31], v[40:43], v[220:223]
v_mfma_f32_16x16x32_bf16 v[224:227], v[28:31], v[44:47], v[224:227]
v_mfma_f32_16x16x32_bf16 v[228:231], v[28:31], v[48:51], v[228:231]
v_mfma_f32_16x16x32_bf16 v[232:235], v[28:31], v[52:55], v[232:235]
s_waitcnt lgkmcnt(0)
v_mfma_f32_16x16x32_bf16 v[236:239], v[32:35], v[36:39], v[236:239]
s_add_u32 m0, s39, 0
s_add_u32 s60, s36, 40960
s_add_u32 s62, s60, 18432
buffer_load_dwordx4 v9, s[24:27], s60 offen offset:0  lds
v_mfma_f32_16x16x32_bf16 v[240:243], v[32:35], v[40:43], v[240:243]
buffer_load_dwordx4 v10, s[24:27], s60 offen offset:1024  lds
v_mfma_f32_16x16x32_bf16 v[244:247], v[32:35], v[44:47], v[244:247]
buffer_load_dwordx4 v9, s[24:27], s62 offen offset:2048  lds
v_mfma_f32_16x16x32_bf16 v[248:251], v[32:35], v[48:51], v[248:251]
buffer_load_dwordx4 v10, s[24:27], s62 offen offset:3072  lds
v_mfma_f32_16x16x32_bf16 v[252:255], v[32:35], v[52:55], v[252:255]
s_add_u32 m0, s39, 4096
s_add_u32 s60, s36, 41088
s_add_u32 s62, s60, 18432
buffer_load_dwordx4 v9, s[24:27], s60 offen offset:0  lds
buffer_load_dwordx4 v10, s[24:27], s60 offen offset:1024  lds
buffer_load_dwordx4 v9, s[24:27], s62 offen offset:2048  lds
buffer_load_dwordx4 v10, s[24:27], s62 offen offset:3072  lds
s_add_u32 m0, s39, 8192
s_add_u32 s60, s37, 40960
s_add_u32 s62, s60, 19456
buffer_load_dwordx4 v11, s[24:27], s60 offen offset:0  lds
buffer_load_dwordx4 v11, s[24:27], s62 offen offset:1024  lds
ds_read_b128 v[36:39], v4 offset:35840
ds_read_b128 v[40:43], v4 offset:36864
ds_read_b128 v[44:47], v4 offset:37888
ds_read_b128 v[48:51], v4 offset:38912
ds_read_b128 v[52:55], v4 offset:39936
s_waitcnt vmcnt(6)
ds_read_b64_tr_b16 v[16:17], v12 offset:0
ds_read_b64_tr_b16 v[18:19], v12 offset:512
v_xor_b32 v15, 32, v12
ds_read_b64_tr_b16 v[20:21], v15 offset:0
ds_read_b64_tr_b16 v[22:23], v15 offset:512
v_xor_b32 v14, 64, v12
ds_read_b64_tr_b16 v[24:25], v14 offset:0
ds_read_b64_tr_b16 v[26:27], v14 offset:512
v_xor_b32 v15, 96, v12
ds_read_b64_tr_b16 v[28:29], v15 offset:0
ds_read_b64_tr_b16 v[30:31], v15 offset:512
s_waitcnt lgkmcnt(6)
v_mfma_f32_16x16x32_bf16 v[56:59], v[16:19], v[36:39], v[56:59]
v_mfma_f32_16x16x32_bf16 v[60:63], v[16:19], v[40:43], v[60:63]
v_mfma_f32_16x16x32_bf16 v[64:67], v[16:19], v[44:47], v[64:67]
v_mfma_f32_16x16x32_bf16 v[68:71], v[16:19], v[48:51], v[68:71]
v_mfma_f32_16x16x32_bf16 v[72:75], v[16:19], v[52:55], v[72:75]
s_waitcnt vmcnt(2)
ds_read_b64_tr_b16 v[32:33], v12 offset:4096
ds_read_b64_tr_b16 v[34:35], v12 offset:4608
s_waitcnt lgkmcnt(6)
v_mfma_f32_16x16x32_bf16 v[76:79], v[20:23], v[36:39], v[76:79]
v_mfma_f32_16x16x32_bf16 v[80:83], v[20:23], v[40:43], v[80:83]
v_mfma_f32_16x16x32_bf16 v[84:87], v[20:23], v[44:47], v[84:87]
v_mfma_f32_16x16x32_bf16 v[88:91], v[20:23], v[48:51], v[88:91]
v_mfma_f32_16x16x32_bf16 v[92:95], v[20:23], v[52:55], v[92:95]
v_xor_b32 v15, 32, v12
ds_read_b64_tr_b16 v[16:17], v15 offset:4096
ds_read_b64_tr_b16 v[18:19], v15 offset:4608
s_waitcnt lgkmcnt(6)
v_mfma_f32_16x16x32_bf16 v[96:99], v[24:27], v[36:39], v[96:99]
v_mfma_f32_16x16x32_bf16 v[100:103], v[24:27], v[40:43], v[100:103]
v_mfma_f32_16x16x32_bf16 v[104:107], v[24:27], v[44:47], v[104:107]
v_mfma_f32_16x16x32_bf16 v[108:111], v[24:27], v[48:51], v[108:111]
v_mfma_f32_16x16x32_bf16 v[112:115], v[24:27], v[52:55], v[112:115]
v_xor_b32 v14, 64, v12
ds_read_b64_tr_b16 v[20:21], v14 offset:4096
ds_read_b64_tr_b16 v[22:23], v14 offset:4608
s_waitcnt lgkmcnt(6)
v_mfma_f32_16x16x32_bf16 v[116:119], v[28:31], v[36:39], v[116:119]
v_mfma_f32_16x16x32_bf16 v[120:123], v[28:31], v[40:43], v[120:123]
v_mfma_f32_16x16x32_bf16 v[124:127], v[28:31], v[44:47], v[124:127]
v_mfma_f32_16x16x32_bf16 v[128:131], v[28:31], v[48:51], v[128:131]
v_mfma_f32_16x16x32_bf16 v[132:135], v[28:31], v[52:55], v[132:135]
v_xor_b32 v15, 96, v12
ds_read_b64_tr_b16 v[24:25], v15 offset:4096
ds_read_b64_tr_b16 v[26:27], v15 offset:4608
s_waitcnt lgkmcnt(6)
v_mfma_f32_16x16x32_bf16 v[136:139], v[32:35], v[36:39], v[136:139]
v_mfma_f32_16x16x32_bf16 v[140:143], v[32:35], v[40:43], v[140:143]
v_mfma_f32_16x16x32_bf16 v[144:147], v[32:35], v[44:47], v[144:147]
v_mfma_f32_16x16x32_bf16 v[148:151], v[32:35], v[48:51], v[148:151]
v_mfma_f32_16x16x32_bf16 v[152:155], v[32:35], v[52:55], v[152:155]
s_waitcnt vmcnt(0)
ds_read_b64_tr_b16 v[28:29], v13 offset:0
ds_read_b64_tr_b16 v[30:31], v13 offset:256
s_waitcnt lgkmcnt(6)
v_mfma_f32_16x16x32_bf16 v[156:159], v[16:19], v[36:39], v[156:159]
v_mfma_f32_16x16x32_bf16 v[160:163], v[16:19], v[40:43], v[160:163]
v_mfma_f32_16x16x32_bf16 v[164:167], v[16:19], v[44:47], v[164:167]
v_mfma_f32_16x16x32_bf16 v[168:171], v[16:19], v[48:51], v[168:171]
v_mfma_f32_16x16x32_bf16 v[172:175], v[16:19], v[52:55], v[172:175]
v_xor_b32 v15, 32, v13
ds_read_b64_tr_b16 v[32:33], v15 offset:0
ds_read_b64_tr_b16 v[34:35], v15 offset:256
s_waitcnt lgkmcnt(6)
v_mfma_f32_16x16x32_bf16 v[176:179], v[20:23], v[36:39], v[176:179]
v_mfma_f32_16x16x32_bf16 v[180:183], v[20:23], v[40:43], v[180:183]
v_mfma_f32_16x16x32_bf16 v[184:187], v[20:23], v[44:47], v[184:187]
v_mfma_f32_16x16x32_bf16 v[188:191], v[20:23], v[48:51], v[188:191]
v_mfma_f32_16x16x32_bf16 v[192:195], v[20:23], v[52:55], v[192:195]
s_waitcnt lgkmcnt(4)
v_mfma_f32_16x16x32_bf16 v[196:199], v[24:27], v[36:39], v[196:199]
v_mfma_f32_16x16x32_bf16 v[200:203], v[24:27], v[40:43], v[200:203]
v_mfma_f32_16x16x32_bf16 v[204:207], v[24:27], v[44:47], v[204:207]
v_mfma_f32_16x16x32_bf16 v[208:211], v[24:27], v[48:51], v[208:211]
v_mfma_f32_16x16x32_bf16 v[212:215], v[24:27], v[52:55], v[212:215]
s_waitcnt lgkmcnt(2)
v_mfma_f32_16x16x32_bf16 v[216:219], v[28:31], v[36:39], v[216:219]
v_mfma_f32_16x16x32_bf16 v[220:223], v[28:31], v[40:43], v[220:223]
v_mfma_f32_16x16x32_bf16 v[224:227], v[28:31], v[44:47], v[224:227]
v_mfma_f32_16x16x32_bf16 v[228:231], v[28:31], v[48:51], v[228:231]
v_mfma_f32_16x16x32_bf16 v[232:235], v[28:31], v[52:55], v[232:235]
s_waitcnt lgkmcnt(0)
v_mfma_f32_16x16x32_bf16 v[236:239], v[32:35], v[36:39], v[236:239]
s_add_u32 m0, s39, 0
s_add_u32 s60, s36, 81920
s_add_u32 s62, s60, 18432
buffer_load_dwordx4 v9, s[24:27], s60 offen offset:0  lds
v_mfma_f32_16x16x32_bf16 v[240:243], v[32:35], v[40:43], v[240:243]
buffer_load_dwordx4 v10, s[24:27], s60 offen offset:1024  lds
v_mfma_f32_16x16x32_bf16 v[244:247], v[32:35], v[44:47], v[244:247]
buffer_load_dwordx4 v9, s[24:27], s62 offen offset:2048  lds
v_mfma_f32_16x16x32_bf16 v[248:251], v[32:35], v[48:51], v[248:251]
buffer_load_dwordx4 v10, s[24:27], s62 offen offset:3072  lds
v_mfma_f32_16x16x32_bf16 v[252:255], v[32:35], v[52:55], v[252:255]
s_add_u32 m0, s39, 4096
s_add_u32 s60, s36, 82048
s_add_u32 s62, s60, 18432
buffer_load_dwordx4 v9, s[24:27], s60 offen offset:0  lds
buffer_load_dwordx4 v10, s[24:27], s60 offen offset:1024  lds
buffer_load_dwordx4 v9, s[24:27], s62 offen offset:2048  lds
buffer_load_dwordx4 v10, s[24:27], s62 offen offset:3072  lds
s_add_u32 m0, s39, 8192
s_add_u32 s60, s37, 81920
s_add_u32 s62, s60, 19456
buffer_load_dwordx4 v11, s[24:27], s60 offen offset:0  lds
buffer_load_dwordx4 v11, s[24:27], s62 offen offset:1024  lds
ds_read_b128 v[36:39], v4 offset:40960
ds_read_b128 v[40:43], v4 offset:41984
ds_read_b128 v[44:47], v4 offset:43008
ds_read_b128 v[48:51], v4 offset:44032
ds_read_b128 v[52:55], v4 offset:45056
s_waitcnt vmcnt(6)
ds_read_b64_tr_b16 v[16:17], v12 offset:0
ds_read_b64_tr_b16 v[18:19], v12 offset:512
v_xor_b32 v15, 32, v12
ds_read_b64_tr_b16 v[20:21], v15 offset:0
ds_read_b64_tr_b16 v[22:23], v15 offset:512
v_xor_b32 v14, 64, v12
ds_read_b64_tr_b16 v[24:25], v14 offset:0
ds_read_b64_tr_b16 v[26:27], v14 offset:512
v_xor_b32 v15, 96, v12
ds_read_b64_tr_b16 v[28:29], v15 offset:0
ds_read_b64_tr_b16 v[30:31], v15 offset:512
s_waitcnt lgkmcnt(6)
v_mfma_f32_16x16x32_bf16 v[56:59], v[16:19], v[36:39], v[56:59]
v_mfma_f32_16x16x32_bf16 v[60:63], v[16:19], v[40:43], v[60:63]
v_mfma_f32_16x16x32_bf16 v[64:67], v[16:19], v[44:47], v[64:67]
v_mfma_f32_16x16x32_bf16 v[68:71], v[16:19], v[48:51], v[68:71]
v_mfma_f32_16x16x32_bf16 v[72:75], v[16:19], v[52:55], v[72:75]
s_waitcnt vmcnt(2)
ds_read_b64_tr_b16 v[32:33], v12 offset:4096
ds_read_b64_tr_b16 v[34:35], v12 offset:4608
s_waitcnt lgkmcnt(6)
v_mfma_f32_16x16x32_bf16 v[76:79], v[20:23], v[36:39], v[76:79]
v_mfma_f32_16x16x32_bf16 v[80:83], v[20:23], v[40:43], v[80:83]
v_mfma_f32_16x16x32_bf16 v[84:87], v[20:23], v[44:47], v[84:87]
v_mfma_f32_16x16x32_bf16 v[88:91], v[20:23], v[48:51], v[88:91]
v_mfma_f32_16x16x32_bf16 v[92:95], v[20:23], v[52:55], v[92:95]
v_xor_b32 v15, 32, v12
ds_read_b64_tr_b16 v[16:17], v15 offset:4096
ds_read_b64_tr_b16 v[18:19], v15 offset:4608
s_waitcnt lgkmcnt(6)
v_mfma_f32_16x16x32_bf16 v[96:99], v[24:27], v[36:39], v[96:99]
v_mfma_f32_16x16x32_bf16 v[100:103], v[24:27], v[40:43], v[100:103]
v_mfma_f32_16x16x32_bf16 v[104:107], v[24:27], v[44:47], v[104:107]
v_mfma_f32_16x16x32_bf16 v[108:111], v[24:27], v[48:51], v[108:111]
v_mfma_f32_16x16x32_bf16 v[112:115], v[24:27], v[52:55], v[112:115]
v_xor_b32 v14, 64, v12
ds_read_b64_tr_b16 v[20:21], v14 offset:4096
ds_read_b64_tr_b16 v[22:23], v14 offset:4608
s_waitcnt lgkmcnt(6)
v_mfma_f32_16x16x32_bf16 v[116:119], v[28:31], v[36:39], v[116:119]
v_mfma_f32_16x16x32_bf16 v[120:123], v[28:31], v[40:43], v[120:123]
v_mfma_f32_16x16x32_bf16 v[124:127], v[28:31], v[44:47], v[124:127]
v_mfma_f32_16x16x32_bf16 v[128:131], v[28:31], v[48:51], v[128:131]
v_mfma_f32_16x16x32_bf16 v[132:135], v[28:31], v[52:55], v[132:135]
v_xor_b32 v15, 96, v12
ds_read_b64_tr_b16 v[24:25], v15 offset:4096
ds_read_b64_tr_b16 v[26:27], v15 offset:4608
s_waitcnt lgkmcnt(6)
v_mfma_f32_16x16x32_bf16 v[136:139], v[32:35], v[36:39], v[136:139]
v_mfma_f32_16x16x32_bf16 v[140:143], v[32:35], v[40:43], v[140:143]
v_mfma_f32_16x16x32_bf16 v[144:147], v[32:35], v[44:47], v[144:147]
v_mfma_f32_16x16x32_bf16 v[148:151], v[32:35], v[48:51], v[148:151]
v_mfma_f32_16x16x32_bf16 v[152:155], v[32:35], v[52:55], v[152:155]
s_waitcnt vmcnt(0)
ds_read_b64_tr_b16 v[28:29], v13 offset:0
ds_read_b64_tr_b16 v[30:31], v13 offset:256
s_waitcnt lgkmcnt(6)
v_mfma_f32_16x16x32_bf16 v[156:159], v[16:19], v[36:39], v[156:159]
v_mfma_f32_16x16x32_bf16 v[160:163], v[16:19], v[40:43], v[160:163]
v_mfma_f32_16x16x32_bf16 v[164:167], v[16:19], v[44:47], v[164:167]
v_mfma_f32_16x16x32_bf16 v[168:171], v[16:19], v[48:51], v[168:171]
v_mfma_f32_16x16x32_bf16 v[172:175], v[16:19], v[52:55], v[172:175]
v_xor_b32 v15, 32, v13
ds_read_b64_tr_b16 v[32:33], v15 offset:0
ds_read_b64_tr_b16 v[34:35], v15 offset:256
s_waitcnt lgkmcnt(6)
v_mfma_f32_16x16x32_bf16 v[176:179], v[20:23], v[36:39], v[176:179]
v_mfma_f32_16x16x32_bf16 v[180:183], v[20:23], v[40:43], v[180:183]
v_mfma_f32_16x16x32_bf16 v[184:187], v[20:23], v[44:47], v[184:187]
v_mfma_f32_16x16x32_bf16 v[188:191], v[20:23], v[48:51], v[188:191]
v_mfma_f32_16x16x32_bf16 v[192:195], v[20:23], v[52:55], v[192:195]
s_waitcnt lgkmcnt(4)
v_mfma_f32_16x16x32_bf16 v[196:199], v[24:27], v[36:39], v[196:199]
v_mfma_f32_16x16x32_bf16 v[200:203], v[24:27], v[40:43], v[200:203]
v_mfma_f32_16x16x32_bf16 v[204:207], v[24:27], v[44:47], v[204:207]
v_mfma_f32_16x16x32_bf16 v[208:211], v[24:27], v[48:51], v[208:211]
v_mfma_f32_16x16x32_bf16 v[212:215], v[24:27], v[52:55], v[212:215]
s_waitcnt lgkmcnt(2)
v_mfma_f32_16x16x32_bf16 v[216:219], v[28:31], v[36:39], v[216:219]
v_mfma_f32_16x16x32_bf16 v[220:223], v[28:31], v[40:43], v[220:223]
v_mfma_f32_16x16x32_bf16 v[224:227], v[28:31], v[44:47], v[224:227]
v_mfma_f32_16x16x32_bf16 v[228:231], v[28:31], v[48:51], v[228:231]
v_mfma_f32_16x16x32_bf16 v[232:235], v[28:31], v[52:55], v[232:235]
s_waitcnt lgkmcnt(0)
v_mfma_f32_16x16x32_bf16 v[236:239], v[32:35], v[36:39], v[236:239]
s_add_u32 m0, s39, 0
s_add_u32 s60, s36, 122880
s_add_u32 s62, s60, 18432
buffer_load_dwordx4 v9, s[24:27], s60 offen offset:0  lds
v_mfma_f32_16x16x32_bf16 v[240:243], v[32:35], v[40:43], v[240:243]
buffer_load_dwordx4 v10, s[24:27], s60 offen offset:1024  lds
v_mfma_f32_16x16x32_bf16 v[244:247], v[32:35], v[44:47], v[244:247]
buffer_load_dwordx4 v9, s[24:27], s62 offen offset:2048  lds
v_mfma_f32_16x16x32_bf16 v[248:251], v[32:35], v[48:51], v[248:251]
buffer_load_dwordx4 v10, s[24:27], s62 offen offset:3072  lds
v_mfma_f32_16x16x32_bf16 v[252:255], v[32:35], v[52:55], v[252:255]
s_add_u32 m0, s39, 4096
s_add_u32 s60, s36, 123008
s_add_u32 s62, s60, 18432
buffer_load_dwordx4 v9, s[24:27], s60 offen offset:0  lds
buffer_load_dwordx4 v10, s[24:27], s60 offen offset:1024  lds
buffer_load_dwordx4 v9, s[24:27], s62 offen offset:2048  lds
buffer_load_dwordx4 v10, s[24:27], s62 offen offset:3072  lds
s_add_u32 m0, s39, 8192
s_add_u32 s60, s37, 122880
s_add_u32 s62, s60, 19456
buffer_load_dwordx4 v11, s[24:27], s60 offen offset:0  lds
buffer_load_dwordx4 v11, s[24:27], s62 offen offset:1024  lds
s_barrier
ds_read_b128 v[36:39], v4 offset:46080
ds_read_b128 v[40:43], v4 offset:47104
ds_read_b128 v[44:47], v4 offset:48128
ds_read_b128 v[48:51], v4 offset:49152
ds_read_b128 v[52:55], v4 offset:50176
s_waitcnt vmcnt(6)
ds_read_b64_tr_b16 v[16:17], v12 offset:0
ds_read_b64_tr_b16 v[18:19], v12 offset:512
v_xor_b32 v15, 32, v12
ds_read_b64_tr_b16 v[20:21], v15 offset:0
ds_read_b64_tr_b16 v[22:23], v15 offset:512
v_xor_b32 v14, 64, v12
ds_read_b64_tr_b16 v[24:25], v14 offset:0
ds_read_b64_tr_b16 v[26:27], v14 offset:512
v_xor_b32 v15, 96, v12
ds_read_b64_tr_b16 v[28:29], v15 offset:0
ds_read_b64_tr_b16 v[30:31], v15 offset:512
s_waitcnt lgkmcnt(6)
v_mfma_f32_16x16x32_bf16 v[56:59], v[16:19], v[36:39], v[56:59]
v_mfma_f32_16x16x32_bf16 v[60:63], v[16:19], v[40:43], v[60:63]
v_mfma_f32_16x16x32_bf16 v[64:67], v[16:19], v[44:47], v[64:67]
v_mfma_f32_16x16x32_bf16 v[68:71], v[16:19], v[48:51], v[68:71]
v_mfma_f32_16x16x32_bf16 v[72:75], v[16:19], v[52:55], v[72:75]
s_waitcnt vmcnt(2)
ds_read_b64_tr_b16 v[32:33], v12 offset:4096
ds_read_b64_tr_b16 v[34:35], v12 offset:4608
s_waitcnt lgkmcnt(6)
v_mfma_f32_16x16x32_bf16 v[76:79], v[20:23], v[36:39], v[76:79]
v_mfma_f32_16x16x32_bf16 v[80:83], v[20:23], v[40:43], v[80:83]
v_mfma_f32_16x16x32_bf16 v[84:87], v[20:23], v[44:47], v[84:87]
v_mfma_f32_16x16x32_bf16 v[88:91], v[20:23], v[48:51], v[88:91]
v_mfma_f32_16x16x32_bf16 v[92:95], v[20:23], v[52:55], v[92:95]
v_xor_b32 v15, 32, v12
ds_read_b64_tr_b16 v[16:17], v15 offset:4096
ds_read_b64_tr_b16 v[18:19], v15 offset:4608
s_waitcnt lgkmcnt(6)
v_mfma_f32_16x16x32_bf16 v[96:99], v[24:27], v[36:39], v[96:99]
v_mfma_f32_16x16x32_bf16 v[100:103], v[24:27], v[40:43], v[100:103]
v_mfma_f32_16x16x32_bf16 v[104:107], v[24:27], v[44:47], v[104:107]
v_mfma_f32_16x16x32_bf16 v[108:111], v[24:27], v[48:51], v[108:111]
v_mfma_f32_16x16x32_bf16 v[112:115], v[24:27], v[52:55], v[112:115]
v_xor_b32 v14, 64, v12
ds_read_b64_tr_b16 v[20:21], v14 offset:4096
ds_read_b64_tr_b16 v[22:23], v14 offset:4608
s_waitcnt lgkmcnt(6)
v_mfma_f32_16x16x32_bf16 v[116:119], v[28:31], v[36:39], v[116:119]
v_mfma_f32_16x16x32_bf16 v[120:123], v[28:31], v[40:43], v[120:123]
v_mfma_f32_16x16x32_bf16 v[124:127], v[28:31], v[44:47], v[124:127]
v_mfma_f32_16x16x32_bf16 v[128:131], v[28:31], v[48:51], v[128:131]
v_mfma_f32_16x16x32_bf16 v[132:135], v[28:31], v[52:55], v[132:135]
v_xor_b32 v15, 96, v12
ds_read_b64_tr_b16 v[24:25], v15 offset:4096
ds_read_b64_tr_b16 v[26:27], v15 offset:4608
s_waitcnt lgkmcnt(6)
v_mfma_f32_16x16x32_bf16 v[136:139], v[32:35], v[36:39], v[136:139]
v_mfma_f32_16x16x32_bf16 v[140:143], v[32:35], v[40:43], v[140:143]
v_mfma_f32_16x16x32_bf16 v[144:147], v[32:35], v[44:47], v[144:147]
v_mfma_f32_16x16x32_bf16 v[148:151], v[32:35], v[48:51], v[148:151]
v_mfma_f32_16x16x32_bf16 v[152:155], v[32:35], v[52:55], v[152:155]
s_waitcnt vmcnt(0)
ds_read_b64_tr_b16 v[28:29], v13 offset:0
ds_read_b64_tr_b16 v[30:31], v13 offset:256
s_waitcnt lgkmcnt(6)
v_mfma_f32_16x16x32_bf16 v[156:159], v[16:19], v[36:39], v[156:159]
v_mfma_f32_16x16x32_bf16 v[160:163], v[16:19], v[40:43], v[160:163]
v_mfma_f32_16x16x32_bf16 v[164:167], v[16:19], v[44:47], v[164:167]
v_mfma_f32_16x16x32_bf16 v[168:171], v[16:19], v[48:51], v[168:171]
v_mfma_f32_16x16x32_bf16 v[172:175], v[16:19], v[52:55], v[172:175]
v_xor_b32 v15, 32, v13
ds_read_b64_tr_b16 v[32:33], v15 offset:0
ds_read_b64_tr_b16 v[34:35], v15 offset:256
s_waitcnt lgkmcnt(6)
v_mfma_f32_16x16x32_bf16 v[176:179], v[20:23], v[36:39], v[176:179]
v_mfma_f32_16x16x32_bf16 v[180:183], v[20:23], v[40:43], v[180:183]
v_mfma_f32_16x16x32_bf16 v[184:187], v[20:23], v[44:47], v[184:187]
v_mfma_f32_16x16x32_bf16 v[188:191], v[20:23], v[48:51], v[188:191]
v_mfma_f32_16x16x32_bf16 v[192:195], v[20:23], v[52:55], v[192:195]
s_waitcnt lgkmcnt(4)
v_mfma_f32_16x16x32_bf16 v[196:199], v[24:27], v[36:39], v[196:199]
v_mfma_f32_16x16x32_bf16 v[200:203], v[24:27], v[40:43], v[200:203]
v_mfma_f32_16x16x32_bf16 v[204:207], v[24:27], v[44:47], v[204:207]
v_mfma_f32_16x16x32_bf16 v[208:211], v[24:27], v[48:51], v[208:211]
v_mfma_f32_16x16x32_bf16 v[212:215], v[24:27], v[52:55], v[212:215]
s_waitcnt lgkmcnt(2)
v_mfma_f32_16x16x32_bf16 v[216:219], v[28:31], v[36:39], v[216:219]
v_mfma_f32_16x16x32_bf16 v[220:223], v[28:31], v[40:43], v[220:223]
v_mfma_f32_16x16x32_bf16 v[224:227], v[28:31], v[44:47], v[224:227]
v_mfma_f32_16x16x32_bf16 v[228:231], v[28:31], v[48:51], v[228:231]
v_mfma_f32_16x16x32_bf16 v[232:235], v[28:31], v[52:55], v[232:235]
s_waitcnt lgkmcnt(0)
v_mfma_f32_16x16x32_bf16 v[236:239], v[32:35], v[36:39], v[236:239]
s_add_u32 m0, s39, 0
s_add_u32 s60, s36, 163840
s_add_u32 s62, s60, 18432
buffer_load_dwordx4 v9, s[24:27], s60 offen offset:0  lds
v_mfma_f32_16x16x32_bf16 v[240:243], v[32:35], v[40:43], v[240:243]
buffer_load_dwordx4 v10, s[24:27], s60 offen offset:1024  lds
v_mfma_f32_16x16x32_bf16 v[244:247], v[32:35], v[44:47], v[244:247]
buffer_load_dwordx4 v9, s[24:27], s62 offen offset:2048  lds
v_mfma_f32_16x16x32_bf16 v[248:251], v[32:35], v[48:51], v[248:251]
buffer_load_dwordx4 v10, s[24:27], s62 offen offset:3072  lds
v_mfma_f32_16x16x32_bf16 v[252:255], v[32:35], v[52:55], v[252:255]
s_add_u32 m0, s39, 4096
s_add_u32 s60, s36, 163968
s_add_u32 s62, s60, 18432
buffer_load_dwordx4 v9, s[24:27], s60 offen offset:0  lds
buffer_load_dwordx4 v10, s[24:27], s60 offen offset:1024  lds
buffer_load_dwordx4 v9, s[24:27], s62 offen offset:2048  lds
buffer_load_dwordx4 v10, s[24:27], s62 offen offset:3072  lds
s_add_u32 m0, s39, 8192
s_add_u32 s60, s37, 163840
s_add_u32 s62, s60, 19456
buffer_load_dwordx4 v11, s[24:27], s60 offen offset:0  lds
buffer_load_dwordx4 v11, s[24:27], s62 offen offset:1024  lds
ds_read_b128 v[36:39], v4 offset:51200
ds_read_b128 v[40:43], v4 offset:52224
ds_read_b128 v[44:47], v4 offset:53248
ds_read_b128 v[48:51], v4 offset:54272
ds_read_b128 v[52:55], v4 offset:55296
s_waitcnt vmcnt(6)
ds_read_b64_tr_b16 v[16:17], v12 offset:0
ds_read_b64_tr_b16 v[18:19], v12 offset:512
v_xor_b32 v15, 32, v12
ds_read_b64_tr_b16 v[20:21], v15 offset:0
ds_read_b64_tr_b16 v[22:23], v15 offset:512
v_xor_b32 v14, 64, v12
ds_read_b64_tr_b16 v[24:25], v14 offset:0
ds_read_b64_tr_b16 v[26:27], v14 offset:512
v_xor_b32 v15, 96, v12
ds_read_b64_tr_b16 v[28:29], v15 offset:0
ds_read_b64_tr_b16 v[30:31], v15 offset:512
s_waitcnt lgkmcnt(6)
v_mfma_f32_16x16x32_bf16 v[56:59], v[16:19], v[36:39], v[56:59]
v_mfma_f32_16x16x32_bf16 v[60:63], v[16:19], v[40:43], v[60:63]
v_mfma_f32_16x16x32_bf16 v[64:67], v[16:19], v[44:47], v[64:67]
v_mfma_f32_16x16x32_bf16 v[68:71], v[16:19], v[48:51], v[68:71]
v_mfma_f32_16x16x32_bf16 v[72:75], v[16:19], v[52:55], v[72:75]
s_waitcnt vmcnt(2)
ds_read_b64_tr_b16 v[32:33], v12 offset:4096
ds_read_b64_tr_b16 v[34:35], v12 offset:4608
s_waitcnt lgkmcnt(6)
v_mfma_f32_16x16x32_bf16 v[76:79], v[20:23], v[36:39], v[76:79]
v_mfma_f32_16x16x32_bf16 v[80:83], v[20:23], v[40:43], v[80:83]
v_mfma_f32_16x16x32_bf16 v[84:87], v[20:23], v[44:47], v[84:87]
v_mfma_f32_16x16x32_bf16 v[88:91], v[20:23], v[48:51], v[88:91]
v_mfma_f32_16x16x32_bf16 v[92:95], v[20:23], v[52:55], v[92:95]
v_xor_b32 v15, 32, v12
ds_read_b64_tr_b16 v[16:17], v15 offset:4096
ds_read_b64_tr_b16 v[18:19], v15 offset:4608
s_waitcnt lgkmcnt(6)
v_mfma_f32_16x16x32_bf16 v[96:99], v[24:27], v[36:39], v[96:99]
v_mfma_f32_16x16x32_bf16 v[100:103], v[24:27], v[40:43], v[100:103]
v_mfma_f32_16x16x32_bf16 v[104:107], v[24:27], v[44:47], v[104:107]
v_mfma_f32_16x16x32_bf16 v[108:111], v[24:27], v[48:51], v[108:111]
v_mfma_f32_16x16x32_bf16 v[112:115], v[24:27], v[52:55], v[112:115]
v_xor_b32 v14, 64, v12
ds_read_b64_tr_b16 v[20:21], v14 offset:4096
ds_read_b64_tr_b16 v[22:23], v14 offset:4608
s_waitcnt lgkmcnt(6)
v_mfma_f32_16x16x32_bf16 v[116:119], v[28:31], v[36:39], v[116:119]
s_add_u32 m0, s39, 0
s_add_u32 s60, s36, 204800
s_add_u32 s62, s60, 18432
buffer_load_dwordx4 v9, s[24:27], s60 offen offset:0  lds
v_mfma_f32_16x16x32_bf16 v[120:123], v[28:31], v[40:43], v[120:123]
buffer_load_dwordx4 v10, s[24:27], s60 offen offset:1024  lds
v_mfma_f32_16x16x32_bf16 v[124:127], v[28:31], v[44:47], v[124:127]
buffer_load_dwordx4 v9, s[24:27], s62 offen offset:2048  lds
v_mfma_f32_16x16x32_bf16 v[128:131], v[28:31], v[48:51], v[128:131]
buffer_load_dwordx4 v10, s[24:27], s62 offen offset:3072  lds
v_mfma_f32_16x16x32_bf16 v[132:135], v[28:31], v[52:55], v[132:135]
v_xor_b32 v15, 96, v12
ds_read_b64_tr_b16 v[24:25], v15 offset:4096
ds_read_b64_tr_b16 v[26:27], v15 offset:4608
s_waitcnt lgkmcnt(6)
v_mfma_f32_16x16x32_bf16 v[136:139], v[32:35], v[36:39], v[136:139]
v_mfma_f32_16x16x32_bf16 v[140:143], v[32:35], v[40:43], v[140:143]
v_mfma_f32_16x16x32_bf16 v[144:147], v[32:35], v[44:47], v[144:147]
v_mfma_f32_16x16x32_bf16 v[148:151], v[32:35], v[48:51], v[148:151]
v_mfma_f32_16x16x32_bf16 v[152:155], v[32:35], v[52:55], v[152:155]
s_waitcnt vmcnt(4)
ds_read_b64_tr_b16 v[28:29], v13 offset:0
ds_read_b64_tr_b16 v[30:31], v13 offset:256
s_waitcnt lgkmcnt(6)
v_mfma_f32_16x16x32_bf16 v[156:159], v[16:19], v[36:39], v[156:159]
v_mfma_f32_16x16x32_bf16 v[160:163], v[16:19], v[40:43], v[160:163]
v_mfma_f32_16x16x32_bf16 v[164:167], v[16:19], v[44:47], v[164:167]
v_mfma_f32_16x16x32_bf16 v[168:171], v[16:19], v[48:51], v[168:171]
v_mfma_f32_16x16x32_bf16 v[172:175], v[16:19], v[52:55], v[172:175]
v_xor_b32 v15, 32, v13
ds_read_b64_tr_b16 v[32:33], v15 offset:0
ds_read_b64_tr_b16 v[34:35], v15 offset:256
s_waitcnt lgkmcnt(6)
v_mfma_f32_16x16x32_bf16 v[176:179], v[20:23], v[36:39], v[176:179]
v_mfma_f32_16x16x32_bf16 v[180:183], v[20:23], v[40:43], v[180:183]
v_mfma_f32_16x16x32_bf16 v[184:187], v[20:23], v[44:47], v[184:187]
v_mfma_f32_16x16x32_bf16 v[188:191], v[20:23], v[48:51], v[188:191]
v_mfma_f32_16x16x32_bf16 v[192:195], v[20:23], v[52:55], v[192:195]
s_waitcnt lgkmcnt(4)
v_mfma_f32_16x16x32_bf16 v[196:199], v[24:27], v[36:39], v[196:199]
s_add_u32 m0, s39, 4096
s_add_u32 s60, s36, 204928
s_add_u32 s62, s60, 18432
buffer_load_dwordx4 v9, s[24:27], s60 offen offset:0  lds
v_mfma_f32_16x16x32_bf16 v[200:203], v[24:27], v[40:43], v[200:203]
buffer_load_dwordx4 v10, s[24:27], s60 offen offset:1024  lds
v_mfma_f32_16x16x32_bf16 v[204:207], v[24:27], v[44:47], v[204:207]
buffer_load_dwordx4 v9, s[24:27], s62 offen offset:2048  lds
v_mfma_f32_16x16x32_bf16 v[208:211], v[24:27], v[48:51], v[208:211]
buffer_load_dwordx4 v10, s[24:27], s62 offen offset:3072  lds
v_mfma_f32_16x16x32_bf16 v[212:215], v[24:27], v[52:55], v[212:215]
s_waitcnt lgkmcnt(2)
v_mfma_f32_16x16x32_bf16 v[216:219], v[28:31], v[36:39], v[216:219]
v_mfma_f32_16x16x32_bf16 v[220:223], v[28:31], v[40:43], v[220:223]
v_mfma_f32_16x16x32_bf16 v[224:227], v[28:31], v[44:47], v[224:227]
v_mfma_f32_16x16x32_bf16 v[228:231], v[28:31], v[48:51], v[228:231]
v_mfma_f32_16x16x32_bf16 v[232:235], v[28:31], v[52:55], v[232:235]
s_waitcnt lgkmcnt(0)
v_mfma_f32_16x16x32_bf16 v[236:239], v[32:35], v[36:39], v[236:239]
s_add_u32 m0, s39, 8192
s_add_u32 s60, s37, 204800
s_add_u32 s62, s60, 19456
buffer_load_dwordx4 v11, s[24:27], s60 offen offset:0  lds
v_mfma_f32_16x16x32_bf16 v[240:243], v[32:35], v[40:43], v[240:243]
buffer_load_dwordx4 v11, s[24:27], s62 offen offset:1024  lds
v_mfma_f32_16x16x32_bf16 v[244:247], v[32:35], v[44:47], v[244:247]
v_mfma_f32_16x16x32_bf16 v[248:251], v[32:35], v[48:51], v[248:251]
v_mfma_f32_16x16x32_bf16 v[252:255], v[32:35], v[52:55], v[252:255]
ds_read_b128 v[36:39], v4 offset:56320
ds_read_b128 v[40:43], v4 offset:57344
ds_read_b128 v[44:47], v4 offset:58368
ds_read_b128 v[48:51], v4 offset:59392
ds_read_b128 v[52:55], v4 offset:60416
s_waitcnt vmcnt(6)
ds_read_b64_tr_b16 v[16:17], v12 offset:0
ds_read_b64_tr_b16 v[18:19], v12 offset:512
v_xor_b32 v15, 32, v12
ds_read_b64_tr_b16 v[20:21], v15 offset:0
ds_read_b64_tr_b16 v[22:23], v15 offset:512
v_xor_b32 v14, 64, v12
ds_read_b64_tr_b16 v[24:25], v14 offset:0
ds_read_b64_tr_b16 v[26:27], v14 offset:512
v_xor_b32 v15, 96, v12
ds_read_b64_tr_b16 v[28:29], v15 offset:0
ds_read_b64_tr_b16 v[30:31], v15 offset:512
s_waitcnt lgkmcnt(6)
v_mfma_f32_16x16x32_bf16 v[56:59], v[16:19], v[36:39], v[56:59]
v_mfma_f32_16x16x32_bf16 v[60:63], v[16:19], v[40:43], v[60:63]
v_mfma_f32_16x16x32_bf16 v[64:67], v[16:19], v[44:47], v[64:67]
v_mfma_f32_16x16x32_bf16 v[68:71], v[16:19], v[48:51], v[68:71]
v_mfma_f32_16x16x32_bf16 v[72:75], v[16:19], v[52:55], v[72:75]
s_waitcnt vmcnt(2)
ds_read_b64_tr_b16 v[32:33], v12 offset:4096
ds_read_b64_tr_b16 v[34:35], v12 offset:4608
s_waitcnt lgkmcnt(6)
v_mfma_f32_16x16x32_bf16 v[76:79], v[20:23], v[36:39], v[76:79]
v_mfma_f32_16x16x32_bf16 v[80:83], v[20:23], v[40:43], v[80:83]
v_mfma_f32_16x16x32_bf16 v[84:87], v[20:23], v[44:47], v[84:87]
v_mfma_f32_16x16x32_bf16 v[88:91], v[20:23], v[48:51], v[88:91]
v_mfma_f32_16x16x32_bf16 v[92:95], v[20:23], v[52:55], v[92:95]
v_xor_b32 v15, 32, v12
ds_read_b64_tr_b16 v[16:17], v15 offset:4096
ds_read_b64_tr_b16 v[18:19], v15 offset:4608
s_waitcnt lgkmcnt(6)
v_mfma_f32_16x16x32_bf16 v[96:99], v[24:27], v[36:39], v[96:99]
v_mfma_f32_16x16x32_bf16 v[100:103], v[24:27], v[40:43], v[100:103]
v_mfma_f32_16x16x32_bf16 v[104:107], v[24:27], v[44:47], v[104:107]
v_mfma_f32_16x16x32_bf16 v[108:111], v[24:27], v[48:51], v[108:111]
v_mfma_f32_16x16x32_bf16 v[112:115], v[24:27], v[52:55], v[112:115]
v_xor_b32 v14, 64, v12
ds_read_b64_tr_b16 v[20:21], v14 offset:4096
ds_read_b64_tr_b16 v[22:23], v14 offset:4608
s_waitcnt lgkmcnt(6)
v_mfma_f32_16x16x32_bf16 v[116:119], v[28:31], v[36:39], v[116:119]
v_mfma_f32_16x16x32_bf16 v[120:123], v[28:31], v[40:43], v[120:123]
v_mfma_f32_16x16x32_bf16 v[124:127], v[28:31], v[44:47], v[124:127]
v_mfma_f32_16x16x32_bf16 v[128:131], v[28:31], v[48:51], v[128:131]
v_mfma_f32_16x16x32_bf16 v[132:135], v[28:31], v[52:55], v[132:135]
v_xor_b32 v15, 96, v12
ds_read_b64_tr_b16 v[24:25], v15 offset:4096
ds_read_b64_tr_b16 v[26:27], v15 offset:4608
s_waitcnt lgkmcnt(6)
v_mfma_f32_16x16x32_bf16 v[136:139], v[32:35], v[36:39], v[136:139]
v_mfma_f32_16x16x32_bf16 v[140:143], v[32:35], v[40:43], v[140:143]
v_mfma_f32_16x16x32_bf16 v[144:147], v[32:35], v[44:47], v[144:147]
v_mfma_f32_16x16x32_bf16 v[148:151], v[32:35], v[48:51], v[148:151]
v_mfma_f32_16x16x32_bf16 v[152:155], v[32:35], v[52:55], v[152:155]
s_waitcnt vmcnt(0)
ds_read_b64_tr_b16 v[28:29], v13 offset:0
ds_read_b64_tr_b16 v[30:31], v13 offset:256
s_waitcnt lgkmcnt(6)
v_mfma_f32_16x16x32_bf16 v[156:159], v[16:19], v[36:39], v[156:159]
v_mfma_f32_16x16x32_bf16 v[160:163], v[16:19], v[40:43], v[160:163]
v_mfma_f32_16x16x32_bf16 v[164:167], v[16:19], v[44:47], v[164:167]
v_mfma_f32_16x16x32_bf16 v[168:171], v[16:19], v[48:51], v[168:171]
v_mfma_f32_16x16x32_bf16 v[172:175], v[16:19], v[52:55], v[172:175]
v_xor_b32 v15, 32, v13
ds_read_b64_tr_b16 v[32:33], v15 offset:0
ds_read_b64_tr_b16 v[34:35], v15 offset:256
s_waitcnt lgkmcnt(6)
v_mfma_f32_16x16x32_bf16 v[176:179], v[20:23], v[36:39], v[176:179]
v_mfma_f32_16x16x32_bf16 v[180:183], v[20:23], v[40:43], v[180:183]
v_mfma_f32_16x16x32_bf16 v[184:187], v[20:23], v[44:47], v[184:187]
v_mfma_f32_16x16x32_bf16 v[188:191], v[20:23], v[48:51], v[188:191]
v_mfma_f32_16x16x32_bf16 v[192:195], v[20:23], v[52:55], v[192:195]
s_waitcnt lgkmcnt(4)
v_mfma_f32_16x16x32_bf16 v[196:199], v[24:27], v[36:39], v[196:199]
v_mfma_f32_16x16x32_bf16 v[200:203], v[24:27], v[40:43], v[200:203]
v_mfma_f32_16x16x32_bf16 v[204:207], v[24:27], v[44:47], v[204:207]
v_mfma_f32_16x16x32_bf16 v[208:211], v[24:27], v[48:51], v[208:211]
v_mfma_f32_16x16x32_bf16 v[212:215], v[24:27], v[52:55], v[212:215]
s_waitcnt lgkmcnt(2)
v_mfma_f32_16x16x32_bf16 v[216:219], v[28:31], v[36:39], v[216:219]
v_mfma_f32_16x16x32_bf16 v[220:223], v[28:31], v[40:43], v[220:223]
v_mfma_f32_16x16x32_bf16 v[224:227], v[28:31], v[44:47], v[224:227]
v_mfma_f32_16x16x32_bf16 v[228:231], v[28:31], v[48:51], v[228:231]
v_mfma_f32_16x16x32_bf16 v[232:235], v[28:31], v[52:55], v[232:235]
s_waitcnt lgkmcnt(0)
v_mfma_f32_16x16x32_bf16 v[236:239], v[32:35], v[36:39], v[236:239]
v_mfma_f32_16x16x32_bf16 v[240:243], v[32:35], v[40:43], v[240:243]
v_mfma_f32_16x16x32_bf16 v[244:247], v[32:35], v[44:47], v[244:247]
v_mfma_f32_16x16x32_bf16 v[248:251], v[32:35], v[48:51], v[248:251]
v_mfma_f32_16x16x32_bf16 v[252:255], v[32:35], v[52:55], v[252:255]
.LP_noop:
s_add_u32 s3, s38, 0
s_and_b32 s3, s3, 3
s_xor_b32 s3, s3, s67
s_add_u32 s4, s38, 1
s_and_b32 s4, s4, 3
s_xor_b32 s4, s4, s67
s_mul_i32 s34, s3, 196608
s_add_u32 s34, s34, s33
s_mul_i32 s44, s4, 196608
s_add_u32 s44, s44, s33
s_mul_i32 s35, s4, 384
s_mul_i32 s3, s3, 245760
s_add_u32 s36, s45, s3
s_add_u32 s37, s46, s3
s_cmp_eq_u32 s38, 3
s_cbranch_scc1 .LP_last
s_barrier
s_add_u32 m0, s40, 139264
s_add_u32 s62, s41, 0
buffer_load_dwordx4 v8, s[20:23], s62 offen offset:0  lds
s_add_u32 s62, s41, 9216
buffer_load_dwordx4 v8, s[20:23], s62 offen offset:1024  lds
s_mov_b32 exec_hi, 0
s_add_u32 s62, s41, 18432
buffer_load_dwordx4 v8, s[20:23], s62 offen offset:2048  lds
s_mov_b32 exec_hi, -1
s_add_u32 m0, s33, 90112
s_add_u32 s60, s35, 0
buffer_load_dwordx4 v5, s[16:19], s60 offen offset:0  lds
buffer_load_dwordx4 v6, s[16:19], s60 offen offset:1024  lds
buffer_load_dwordx4 v7, s[16:19], s60 offen offset:2048  lds
s_add_u32 m0, s33, 102400
s_add_u32 s60, s35, 393216
buffer_load_dwordx4 v5, s[16:19], s60 offen offset:0  lds
buffer_load_dwordx4 v6, s[16:19], s60 offen offset:1024  lds
buffer_load_dwordx4 v7, s[16:19], s60 offen offset:2048  lds
s_add_u32 m0, s40, 149504
s_add_u32 s62, s41, 128
buffer_load_dwordx4 v8, s[20:23], s62 offen offset:0  lds
s_add_u32 s62, s41, 9344
buffer_load_dwordx4 v8, s[20:23], s62 offen offset:1024  lds
s_mov_b32 exec_hi, 0
s_add_u32 s62, s41, 18560
buffer_load_dwordx4 v8, s[20:23], s62 offen offset:2048  lds
s_mov_b32 exec_hi, -1
s_add_u32 m0, s33, 114688
s_add_u32 s60, s35, 786432
buffer_load_dwordx4 v5, s[16:19], s60 offen offset:0  lds
buffer_load_dwordx4 v6, s[16:19], s60 offen offset:1024  lds
buffer_load_dwordx4 v7, s[16:19], s60 offen offset:2048  lds
s_add_u32 m0, s33, 126976
s_add_u32 s60, s35, 1179648
buffer_load_dwordx4 v5, s[16:19], s60 offen offset:0  lds
buffer_load_dwordx4 v6, s[16:19], s60 offen offset:1024  lds
buffer_load_dwordx4 v7, s[16:19], s60 offen offset:2048  lds
s_barrier
s_add_u32 m0, s33, 0
s_add_u32 s61, s34, 49152
buffer_load_dwordx4 v1, s[12:15], s61 offen offset:0 nt lds
buffer_load_dwordx4 v2, s[12:15], s61 offen offset:1024 nt lds
buffer_load_dwordx4 v3, s[12:15], s61 offen offset:2048 nt lds
s_waitcnt vmcnt(15)
s_barrier
s_add_u32 m0, s33, 12288
s_add_u32 s61, s34, 61440
buffer_load_dwordx4 v1, s[12:15], s61 offen offset:0 nt lds
buffer_load_dwordx4 v2, s[12:15], s61 offen offset:1024 nt lds
buffer_load_dwordx4 v3, s[12:15], s61 offen offset:2048 nt lds
s_waitcnt vmcnt(15)
s_barrier
s_add_u32 m0, s33, 90112
s_add_u32 s60, s35, 1572864
buffer_load_dwordx4 v5, s[16:19], s60 offen offset:0  lds
buffer_load_dwordx4 v6, s[16:19], s60 offen offset:1024  lds
buffer_load_dwordx4 v7, s[16:19], s60 offen offset:2048  lds
s_waitcnt vmcnt(12)
s_barrier
s_add_u32 m0, s40, 139264
s_add_u32 s62, s41, 256
buffer_load_dwordx4 v8, s[20:23], s62 offen offset:0  lds
s_add_u32 s62, s41, 9472
buffer_load_dwordx4 v8, s[20:23], s62 offen offset:1024  lds
s_mov_b32 exec_hi, 0
s_add_u32 s62, s41, 18688
buffer_load_dwordx4 v8, s[20:23], s62 offen offset:2048  lds
s_mov_b32 exec_hi, -1
s_add_u32 m0, s33, 102400
s_add_u32 s60, s35, 1966080
buffer_load_dwordx4 v5, s[16:19], s60 offen offset:0  lds
buffer_load_dwordx4 v6, s[16:19], s60 offen offset:1024  lds
buffer_load_dwordx4 v7, s[16:19], s60 offen offset:2048  lds
s_barrier
s_add_u32 m0, s33, 114688
s_add_u32 s60, s35, 2359296
buffer_load_dwordx4 v5, s[16:19], s60 offen offset:0  lds
buffer_load_dwordx4 v6, s[16:19], s60 offen offset:1024  lds
buffer_load_dwordx4 v7, s[16:19], s60 offen offset:2048  lds
s_barrier
s_add_u32 m0, s33, 24576
s_add_u32 s61, s34, 73728
buffer_load_dwordx4 v1, s[12:15], s61 offen offset:0 nt lds
buffer_load_dwordx4 v2, s[12:15], s61 offen offset:1024 nt lds
buffer_load_dwordx4 v3, s[12:15], s61 offen offset:2048 nt lds
s_waitcnt vmcnt(21)
s_barrier
s_add_u32 m0, s33, 36864
s_add_u32 s61, s34, 86016
buffer_load_dwordx4 v1, s[12:15], s61 offen offset:0 nt lds
buffer_load_dwordx4 v2, s[12:15], s61 offen offset:1024 nt lds
buffer_load_dwordx4 v3, s[12:15], s61 offen offset:2048 nt lds
s_waitcnt vmcnt(12)
s_barrier
s_add_u32 m0, s40, 149504
s_add_u32 s62, s41, 384
buffer_load_dwordx4 v8, s[20:23], s62 offen offset:0  lds
s_add_u32 s62, s41, 9600
buffer_load_dwordx4 v8, s[20:23], s62 offen offset:1024  lds
s_mov_b32 exec_hi, 0
s_add_u32 s62, s41, 18816
buffer_load_dwordx4 v8, s[20:23], s62 offen offset:2048  lds
s_mov_b32 exec_hi, -1
s_add_u32 m0, s33, 126976
s_add_u32 s60, s35, 2752512
buffer_load_dwordx4 v5, s[16:19], s60 offen offset:0  lds
buffer_load_dwordx4 v6, s[16:19], s60 offen offset:1024  lds
buffer_load_dwordx4 v7, s[16:19], s60 offen offset:2048  lds
s_waitcnt vmcnt(15)
s_barrier
s_add_u32 m0, s33, 90112
s_add_u32 s60, s35, 3145728
buffer_load_dwordx4 v5, s[16:19], s60 offen offset:0  lds
buffer_load_dwordx4 v6, s[16:19], s60 offen offset:1024  lds
buffer_load_dwordx4 v7, s[16:19], s60 offen offset:2048  lds
s_waitcnt vmcnt(30)
s_barrier
s_add_u32 m0, s40, 139264
s_add_u32 s62, s41, 512
buffer_load_dwordx4 v8, s[20:23], s62 offen offset:0  lds
s_add_u32 s62, s41, 9728
buffer_load_dwordx4 v8, s[20:23], s62 offen offset:1024  lds
s_mov_b32 exec_hi, 0
s_add_u32 s62, s41, 18944
buffer_load_dwordx4 v8, s[20:23], s62 offen offset:2048  lds
s_mov_b32 exec_hi, -1
s_add_u32 m0, s33, 102400
s_add_u32 s60, s35, 3538944
buffer_load_dwordx4 v5, s[16:19], s60 offen offset:0  lds
buffer_load_dwordx4 v6, s[16:19], s60 offen offset:1024  lds
buffer_load_dwordx4 v7, s[16:19], s60 offen offset:2048  lds
s_waitcnt vmcnt(33)
s_barrier
s_add_u32 m0, s33, 0
s_add_u32 s61, s34, 98304
buffer_load_dwordx4 v1, s[12:15], s61 offen offset:0 nt lds
buffer_load_dwordx4 v2, s[12:15], s61 offen offset:1024 nt lds
buffer_load_dwordx4 v3, s[12:15], s61 offen offset:2048 nt lds
s_waitcnt vmcnt(15)
s_barrier
s_add_u32 m0, s33, 12288
s_add_u32 s61, s34, 110592
buffer_load_dwordx4 v1, s[12:15], s61 offen offset:0 nt lds
buffer_load_dwordx4 v2, s[12:15], s61 offen offset:1024 nt lds
buffer_load_dwordx4 v3, s[12:15], s61 offen offset:2048 nt lds
s_waitcnt vmcnt(15)
s_barrier
s_add_u32 m0, s33, 114688
s_add_u32 s60, s35, 3932160
buffer_load_dwordx4 v5, s[16:19], s60 offen offset:0  lds
buffer_load_dwordx4 v6, s[16:19], s60 offen offset:1024  lds
buffer_load_dwordx4 v7, s[16:19], s60 offen offset:2048  lds
s_waitcnt vmcnt(12)
s_barrier
s_add_u32 m0, s40, 149504
s_add_u32 s62, s41, 640
buffer_load_dwordx4 v8, s[20:23], s62 offen offset:0  lds
s_add_u32 s62, s41, 9856
buffer_load_dwordx4 v8, s[20:23], s62 offen offset:1024  lds
s_mov_b32 exec_hi, 0
s_add_u32 s62, s41, 19072
buffer_load_dwordx4 v8, s[20:23], s62 offen offset:2048  lds
s_mov_b32 exec_hi, -1
s_add_u32 m0, s33, 126976
s_add_u32 s60, s35, 4325376
buffer_load_dwordx4 v5, s[16:19], s60 offen offset:0  lds
buffer_load_dwordx4 v6, s[16:19], s60 offen offset:1024  lds
buffer_load_dwordx4 v7, s[16:19], s60 offen offset:2048  lds
s_waitcnt vmcnt(33)
s_barrier
s_add_u32 m0, s33, 90112
s_add_u32 s60, s35, 4718592
buffer_load_dwordx4 v5, s[16:19], s60 offen offset:0  lds
buffer_load_dwordx4 v6, s[16:19], s60 offen offset:1024  lds
buffer_load_dwordx4 v7, s[16:19], s60 offen offset:2048  lds
s_waitcnt vmcnt(33)
s_barrier
s_add_u32 m0, s33, 24576
s_add_u32 s61, s34, 122880
buffer_load_dwordx4 v1, s[12:15], s61 offen offset:0 nt lds
buffer_load_dwordx4 v2, s[12:15], s61 offen offset:1024 nt lds
buffer_load_dwordx4 v3, s[12:15], s61 offen offset:2048 nt lds
s_waitcnt vmcnt(21)
s_barrier
s_add_u32 m0, s33, 36864
s_add_u32 s61, s34, 135168
buffer_load_dwordx4 v1, s[12:15], s61 offen offset:0 nt lds
buffer_load_dwordx4 v2, s[12:15], s61 offen offset:1024 nt lds
buffer_load_dwordx4 v3, s[12:15], s61 offen offset:2048 nt lds
s_waitcnt vmcnt(12)
s_barrier
s_add_u32 m0, s40, 139264
s_add_u32 s62, s41, 768
buffer_load_dwordx4 v8, s[20:23], s62 offen offset:0  lds
s_add_u32 s62, s41, 9984
buffer_load_dwordx4 v8, s[20:23], s62 offen offset:1024  lds
s_mov_b32 exec_hi, 0
s_add_u32 s62, s41, 19200
buffer_load_dwordx4 v8, s[20:23], s62 offen offset:2048  lds
s_mov_b32 exec_hi, -1
s_add_u32 m0, s33, 102400
s_add_u32 s60, s35, 5111808
buffer_load_dwordx4 v5, s[16:19], s60 offen offset:0  lds
buffer_load_dwordx4 v6, s[16:19], s60 offen offset:1024  lds
buffer_load_dwordx4 v7, s[16:19], s60 offen offset:2048  lds
s_waitcnt vmcnt(15)
s_barrier
s_add_u32 m0, s33, 114688
s_add_u32 s60, s35, 5505024
buffer_load_dwordx4 v5, s[16:19], s60 offen offset:0  lds
buffer_load_dwordx4 v6, s[16:19], s60 offen offset:1024  lds
buffer_load_dwordx4 v7, s[16:19], s60 offen offset:2048  lds
s_waitcnt vmcnt(30)
s_barrier
s_add_u32 m0, s40, 149504
s_add_u32 s62, s41, 896
buffer_load_dwordx4 v8, s[20:23], s62 offen offset:0  lds
s_add_u32 s62, s41, 10112
buffer_load_dwordx4 v8, s[20:23], s62 offen offset:1024  lds
s_mov_b32 exec_hi, 0
s_add_u32 s62, s41, 19328
buffer_load_dwordx4 v8, s[20:23], s62 offen offset:2048  lds
s_mov_b32 exec_hi, -1
s_add_u32 m0, s33, 126976
s_add_u32 s60, s35, 5898240
buffer_load_dwordx4 v5, s[16:19], s60 offen offset:0  lds
buffer_load_dwordx4 v6, s[16:19], s60 offen offset:1024  lds
buffer_load_dwordx4 v7, s[16:19], s60 offen offset:2048  lds
s_waitcnt vmcnt(33)
s_barrier
s_add_u32 m0, s33, 0
s_add_u32 s61, s34, 147456
buffer_load_dwordx4 v1, s[12:15], s61 offen offset:0 nt lds
buffer_load_dwordx4 v2, s[12:15], s61 offen offset:1024 nt lds
buffer_load_dwordx4 v3, s[12:15], s61 offen offset:2048 nt lds
s_waitcnt vmcnt(15)
s_barrier
s_add_u32 m0, s33, 12288
s_add_u32 s61, s34, 159744
buffer_load_dwordx4 v1, s[12:15], s61 offen offset:0 nt lds
buffer_load_dwordx4 v2, s[12:15], s61 offen offset:1024 nt lds
buffer_load_dwordx4 v3, s[12:15], s61 offen offset:2048 nt lds
s_waitcnt vmcnt(15)
s_barrier
s_add_u32 m0, s33, 90112
s_add_u32 s60, s35, 6291456
buffer_load_dwordx4 v5, s[16:19], s60 offen offset:0  lds
buffer_load_dwordx4 v6, s[16:19], s60 offen offset:1024  lds
buffer_load_dwordx4 v7, s[16:19], s60 offen offset:2048  lds
s_waitcnt vmcnt(12)
s_barrier
s_add_u32 m0, s40, 139264
s_add_u32 s62, s41, 1024
buffer_load_dwordx4 v8, s[20:23], s62 offen offset:0  lds
s_add_u32 s62, s41, 10240
buffer_load_dwordx4 v8, s[20:23], s62 offen offset:1024  lds
s_mov_b32 exec_hi, 0
s_add_u32 s62, s41, 19456
buffer_load_dwordx4 v8, s[20:23], s62 offen offset:2048  lds
s_mov_b32 exec_hi, -1
s_add_u32 m0, s33, 102400
s_add_u32 s60, s35, 6684672
buffer_load_dwordx4 v5, s[16:19], s60 offen offset:0  lds
buffer_load_dwordx4 v6, s[16:19], s60 offen offset:1024  lds
buffer_load_dwordx4 v7, s[16:19], s60 offen offset:2048  lds
s_waitcnt vmcnt(33)
s_barrier
s_add_u32 m0, s33, 114688
s_add_u32 s60, s35, 7077888
buffer_load_dwordx4 v5, s[16:19], s60 offen offset:0  lds
buffer_load_dwordx4 v6, s[16:19], s60 offen offset:1024  lds
buffer_load_dwordx4 v7, s[16:19], s60 offen offset:2048  lds
s_waitcnt vmcnt(33)
s_barrier
s_add_u32 m0, s33, 24576
s_add_u32 s61, s34, 172032
buffer_load_dwordx4 v1, s[12:15], s61 offen offset:0 nt lds
buffer_load_dwordx4 v2, s[12:15], s61 offen offset:1024 nt lds
buffer_load_dwordx4 v3, s[12:15], s61 offen offset:2048 nt lds
s_waitcnt vmcnt(21)
s_barrier
s_add_u32 m0, s33, 36864
s_add_u32 s61, s34, 184320
buffer_load_dwordx4 v1, s[12:15], s61 offen offset:0 nt lds
buffer_load_dwordx4 v2, s[12:15], s61 offen offset:1024 nt lds
buffer_load_dwordx4 v3, s[12:15], s61 offen offset:2048 nt lds
s_waitcnt vmcnt(12)
s_barrier
s_add_u32 m0, s40, 149504
s_add_u32 s62, s41, 1152
buffer_load_dwordx4 v8, s[20:23], s62 offen offset:0  lds
s_add_u32 s62, s41, 10368
buffer_load_dwordx4 v8, s[20:23], s62 offen offset:1024  lds
s_mov_b32 exec_hi, 0
s_add_u32 s62, s41, 19584
buffer_load_dwordx4 v8, s[20:23], s62 offen offset:2048  lds
s_mov_b32 exec_hi, -1
s_add_u32 m0, s33, 126976
s_add_u32 s60, s35, 7471104
buffer_load_dwordx4 v5, s[16:19], s60 offen offset:0  lds
buffer_load_dwordx4 v6, s[16:19], s60 offen offset:1024  lds
buffer_load_dwordx4 v7, s[16:19], s60 offen offset:2048  lds
s_waitcnt vmcnt(15)
s_barrier
s_waitcnt vmcnt(27)
s_barrier
s_waitcnt vmcnt(24)
s_barrier
s_add_u32 m0, s33, 0
s_add_u32 s61, s44, 0
buffer_load_dwordx4 v1, s[8:11], s61 offen offset:0 nt lds
buffer_load_dwordx4 v2, s[8:11], s61 offen offset:1024 nt lds
buffer_load_dwordx4 v3, s[8:11], s61 offen offset:2048 nt lds
s_waitcnt vmcnt(6)
s_barrier
s_add_u32 m0, s33, 12288
s_add_u32 s61, s44, 12288
buffer_load_dwordx4 v1, s[8:11], s61 offen offset:0 nt lds
buffer_load_dwordx4 v2, s[8:11], s61 offen offset:1024 nt lds
buffer_load_dwordx4 v3, s[8:11], s61 offen offset:2048 nt lds
s_waitcnt vmcnt(6)
s_barrier
s_waitcnt vmcnt(15)
s_barrier
s_waitcnt vmcnt(12)
s_barrier
s_add_u32 m0, s33, 24576
s_add_u32 s61, s44, 24576
buffer_load_dwordx4 v1, s[8:11], s61 offen offset:0 nt lds
buffer_load_dwordx4 v2, s[8:11], s61 offen offset:1024 nt lds
buffer_load_dwordx4 v3, s[8:11], s61 offen offset:2048 nt lds
s_barrier
s_add_u32 m0, s33, 36864
s_add_u32 s61, s44, 36864
buffer_load_dwordx4 v1, s[8:11], s61 offen offset:0 nt lds
buffer_load_dwordx4 v2, s[8:11], s61 offen offset:1024 nt lds
buffer_load_dwordx4 v3, s[8:11], s61 offen offset:2048 nt lds
s_add_u32 m0, s39, 0
s_add_u32 s60, s36, 0
s_add_u32 s62, s60, 18432
buffer_load_dwordx4 v9, s[24:27], s60 offen offset:0  lds
buffer_load_dwordx4 v10, s[24:27], s60 offen offset:1024  lds
buffer_load_dwordx4 v9, s[24:27], s62 offen offset:2048  lds
buffer_load_dwordx4 v10, s[24:27], s62 offen offset:3072  lds
s_add_u32 m0, s39, 4096
s_add_u32 s60, s36, 128
s_add_u32 s62, s60, 18432
buffer_load_dwordx4 v9, s[24:27], s60 offen offset:0  lds
buffer_load_dwordx4 v10, s[24:27], s60 offen offset:1024  lds
buffer_load_dwordx4 v9, s[24:27], s62 offen offset:2048  lds
buffer_load_dwordx4 v10, s[24:27], s62 offen offset:3072  lds
s_add_u32 m0, s39, 8192
s_add_u32 s60, s37, 0
s_add_u32 s62, s60, 19456
buffer_load_dwordx4 v11, s[24:27], s60 offen offset:0  lds
buffer_load_dwordx4 v11, s[24:27], s62 offen offset:1024  lds
s_waitcnt vmcnt(10)
s_waitcnt lgkmcnt(0)
s_barrier
s_add_u32 s38, s38, 1
s_branch .LP_loop
.LP_last:
s_barrier
s_barrier
s_add_u32 m0, s33, 0
s_add_u32 s61, s34, 49152
buffer_load_dwordx4 v1, s[12:15], s61 offen offset:0 nt lds
buffer_load_dwordx4 v2, s[12:15], s61 offen offset:1024 nt lds
buffer_load_dwordx4 v3, s[12:15], s61 offen offset:2048 nt lds
s_barrier
s_add_u32 m0, s33, 12288
s_add_u32 s61, s34, 61440
buffer_load_dwordx4 v1, s[12:15], s61 offen offset:0 nt lds
buffer_load_dwordx4 v2, s[12:15], s61 offen offset:1024 nt lds
buffer_load_dwordx4 v3, s[12:15], s61 offen offset:2048 nt lds
s_barrier
s_add_u32 m0, s33, 24576
s_add_u32 s61, s34, 73728
buffer_load_dwordx4 v1, s[12:15], s61 offen offset:0 nt lds
buffer_load_dwordx4 v2, s[12:15], s61 offen offset:1024 nt lds
buffer_load_dwordx4 v3, s[12:15], s61 offen offset:2048 nt lds
s_waitcnt vmcnt(6)
s_barrier
s_add_u32 m0, s33, 36864
s_add_u32 s61, s34, 86016
buffer_load_dwordx4 v1, s[12:15], s61 offen offset:0 nt lds
buffer_load_dwordx4 v2, s[12:15], s61 offen offset:1024 nt lds
buffer_load_dwordx4 v3, s[12:15], s61 offen offset:2048 nt lds
s_waitcnt vmcnt(6)
s_barrier
s_add_u32 m0, s33, 0
s_add_u32 s61, s34, 98304
buffer_load_dwordx4 v1, s[12:15], s61 offen offset:0 nt lds
buffer_load_dwordx4 v2, s[12:15], s61 offen offset:1024 nt lds
buffer_load_dwordx4 v3, s[12:15], s61 offen offset:2048 nt lds
s_waitcnt vmcnt(6)
s_barrier
s_add_u32 m0, s33, 12288
s_add_u32 s61, s34, 110592
buffer_load_dwordx4 v1, s[12:15], s61 offen offset:0 nt lds
buffer_load_dwordx4 v2, s[12:15], s61 offen offset:1024 nt lds
buffer_load_dwordx4 v3, s[12:15], s61 offen offset:2048 nt lds
s_waitcnt vmcnt(6)
s_barrier
s_add_u32 m0, s33, 24576
s_add_u32 s61, s34, 122880
buffer_load_dwordx4 v1, s[12:15], s61 offen offset:0 nt lds
buffer_load_dwordx4 v2, s[12:15], s61 offen offset:1024 nt lds
buffer_load_dwordx4 v3, s[12:15], s61 offen offset:2048 nt lds
s_waitcnt vmcnt(6)
s_barrier
s_add_u32 m0, s33, 36864
s_add_u32 s61, s34, 135168
buffer_load_dwordx4 v1, s[12:15], s61 offen offset:0 nt lds
buffer_load_dwordx4 v2, s[12:15], s61 offen offset:1024 nt lds
buffer_load_dwordx4 v3, s[12:15], s61 offen offset:2048 nt lds
s_waitcnt vmcnt(6)
s_barrier
s_add_u32 m0, s33, 0
s_add_u32 s61, s34, 147456
buffer_load_dwordx4 v1, s[12:15], s61 offen offset:0 nt lds
buffer_load_dwordx4 v2, s[12:15], s61 offen offset:1024 nt lds
buffer_load_dwordx4 v3, s[12:15], s61 offen offset:2048 nt lds
s_waitcnt vmcnt(6)
s_barrier
s_add_u32 m0, s33, 12288
s_add_u32 s61, s34, 159744
buffer_load_dwordx4 v1, s[12:15], s61 offen offset:0 nt lds
buffer_load_dwordx4 v2, s[12:15], s61 offen offset:1024 nt lds
buffer_load_dwordx4 v3, s[12:15], s61 offen offset:2048 nt lds
s_waitcnt vmcnt(6)
s_barrier
s_add_u32 m0, s33, 24576
s_add_u32 s61, s34, 172032
buffer_load_dwordx4 v1, s[12:15], s61 offen offset:0 nt lds
buffer_load_dwordx4 v2, s[12:15], s61 offen offset:1024 nt lds
buffer_load_dwordx4 v3, s[12:15], s61 offen offset:2048 nt lds
s_waitcnt vmcnt(6)
s_barrier
s_add_u32 m0, s33, 36864
s_add_u32 s61, s34, 184320
buffer_load_dwordx4 v1, s[12:15], s61 offen offset:0 nt lds
buffer_load_dwordx4 v2, s[12:15], s61 offen offset:1024 nt lds
buffer_load_dwordx4 v3, s[12:15], s61 offen offset:2048 nt lds
s_waitcnt vmcnt(6)
s_barrier
s_waitcnt vmcnt(3)
s_barrier
s_waitcnt vmcnt(0)
s_barrier
s_barrier
s_add_u32 m0, s39, 0
s_add_u32 s60, s36, 0
s_add_u32 s62, s60, 18432
buffer_load_dwordx4 v9, s[24:27], s60 offen offset:0  lds
buffer_load_dwordx4 v10, s[24:27], s60 offen offset:1024  lds
buffer_load_dwordx4 v9, s[24:27], s62 offen offset:2048  lds
buffer_load_dwordx4 v10, s[24:27], s62 offen offset:3072  lds
s_add_u32 m0, s39, 4096
s_add_u32 s60, s36, 128
s_add_u32 s62, s60, 18432
buffer_load_dwordx4 v9, s[24:27], s60 offen offset:0  lds
buffer_load_dwordx4 v10, s[24:27], s60 offen offset:1024  lds
buffer_load_dwordx4 v9, s[24:27], s62 offen offset:2048  lds
buffer_load_dwordx4 v10, s[24:27], s62 offen offset:3072  lds
s_add_u32 m0, s39, 8192
s_add_u32 s60, s37, 0
s_add_u32 s62, s60, 19456
buffer_load_dwordx4 v11, s[24:27], s60 offen offset:0  lds
buffer_load_dwordx4 v11, s[24:27], s62 offen offset:1024  lds
s_waitcnt lgkmcnt(0)
s_barrier
v_lshlrev_b32 v1, 4, v0
ds_read_b128 v[36:39], v4 offset:30720
ds_read_b128 v[40:43], v4 offset:31744
ds_read_b128 v[44:47], v4 offset:32768
ds_read_b128 v[48:51], v4 offset:33792
ds_read_b128 v[52:55], v4 offset:34816
s_waitcnt vmcnt(6)
ds_read_b64_tr_b16 v[16:17], v12 offset:0
ds_read_b64_tr_b16 v[18:19], v12 offset:512
v_xor_b32 v15, 32, v12
ds_read_b64_tr_b16 v[20:21], v15 offset:0
ds_read_b64_tr_b16 v[22:23], v15 offset:512
v_xor_b32 v14, 64, v12
ds_read_b64_tr_b16 v[24:25], v14 offset:0
ds_read_b64_tr_b16 v[26:27], v14 offset:512
v_xor_b32 v15, 96, v12
ds_read_b64_tr_b16 v[28:29], v15 offset:0
ds_read_b64_tr_b16 v[30:31], v15 offset:512
s_waitcnt lgkmcnt(6)
v_mfma_f32_16x16x32_bf16 v[56:59], v[16:19], v[36:39], v[56:59]
v_mfma_f32_16x16x32_bf16 v[60:63], v[16:19], v[40:43], v[60:63]
v_mfma_f32_16x16x32_bf16 v[64:67], v[16:19], v[44:47], v[64:67]
v_mfma_f32_16x16x32_bf16 v[68:71], v[16:19], v[48:51], v[68:71]
v_mfma_f32_16x16x32_bf16 v[72:75], v[16:19], v[52:55], v[72:75]
s_waitcnt vmcnt(2)
ds_read_b64_tr_b16 v[32:33], v12 offset:4096
ds_read_b64_tr_b16 v[34:35], v12 offset:4608
s_waitcnt lgkmcnt(6)
v_mfma_f32_16x16x32_bf16 v[76:79], v[20:23], v[36:39], v[76:79]
v_mfma_f32_16x16x32_bf16 v[80:83], v[20:23], v[40:43], v[80:83]
v_mfma_f32_16x16x32_bf16 v[84:87], v[20:23], v[44:47], v[84:87]
v_mfma_f32_16x16x32_bf16 v[88:91], v[20:23], v[48:51], v[88:91]
v_mfma_f32_16x16x32_bf16 v[92:95], v[20:23], v[52:55], v[92:95]
v_xor_b32 v15, 32, v12
ds_read_b64_tr_b16 v[16:17], v15 offset:4096
ds_read_b64_tr_b16 v[18:19], v15 offset:4608
s_waitcnt lgkmcnt(6)
v_mfma_f32_16x16x32_bf16 v[96:99], v[24:27], v[36:39], v[96:99]
v_mfma_f32_16x16x32_bf16 v[100:103], v[24:27], v[40:43], v[100:103]
v_mfma_f32_16x16x32_bf16 v[104:107], v[24:27], v[44:47], v[104:107]
v_mfma_f32_16x16x32_bf16 v[108:111], v[24:27], v[48:51], v[108:111]
v_mfma_f32_16x16x32_bf16 v[112:115], v[24:27], v[52:55], v[112:115]
v_xor_b32 v14, 64, v12
ds_read_b64_tr_b16 v[20:21], v14 offset:4096
ds_read_b64_tr_b16 v[22:23], v14 offset:4608
s_waitcnt lgkmcnt(6)
v_mfma_f32_16x16x32_bf16 v[116:119], v[28:31], v[36:39], v[116:119]
s_add_u32 m0, s39, 0
s_add_u32 s60, s36, 40960
s_add_u32 s62, s60, 18432
buffer_load_dwordx4 v9, s[24:27], s60 offen offset:0  lds
v_mfma_f32_16x16x32_bf16 v[120:123], v[28:31], v[40:43], v[120:123]
buffer_load_dwordx4 v10, s[24:27], s60 offen offset:1024  lds
v_mfma_f32_16x16x32_bf16 v[124:127], v[28:31], v[44:47], v[124:127]
buffer_load_dwordx4 v9, s[24:27], s62 offen offset:2048  lds
v_mfma_f32_16x16x32_bf16 v[128:131], v[28:31], v[48:51], v[128:131]
buffer_load_dwordx4 v10, s[24:27], s62 offen offset:3072  lds
v_mfma_f32_16x16x32_bf16 v[132:135], v[28:31], v[52:55], v[132:135]
v_xor_b32 v15, 96, v12
ds_read_b64_tr_b16 v[24:25], v15 offset:4096
ds_read_b64_tr_b16 v[26:27], v15 offset:4608
s_waitcnt lgkmcnt(6)
v_mfma_f32_16x16x32_bf16 v[136:139], v[32:35], v[36:39], v[136:139]
v_mfma_f32_16x16x32_bf16 v[140:143], v[32:35], v[40:43], v[140:143]
v_mfma_f32_16x16x32_bf16 v[144:147], v[32:35], v[44:47], v[144:147]
v_mfma_f32_16x16x32_bf16 v[148:151], v[32:35], v[48:51], v[148:151]
v_mfma_f32_16x16x32_bf16 v[152:155], v[32:35], v[52:55], v[152:155]
s_waitcnt vmcnt(4)
ds_read_b64_tr_b16 v[28:29], v13 offset:0
ds_read_b64_tr_b16 v[30:31], v13 offset:256
s_waitcnt lgkmcnt(6)
v_mfma_f32_16x16x32_bf16 v[156:159], v[16:19], v[36:39], v[156:159]
v_mfma_f32_16x16x32_bf16 v[160:163], v[16:19], v[40:43], v[160:163]
v_mfma_f32_16x16x32_bf16 v[164:167], v[16:19], v[44:47], v[164:167]
v_mfma_f32_16x16x32_bf16 v[168:171], v[16:19], v[48:51], v[168:171]
v_mfma_f32_16x16x32_bf16 v[172:175], v[16:19], v[52:55], v[172:175]
v_xor_b32 v15, 32, v13
ds_read_b64_tr_b16 v[32:33], v15 offset:0
ds_read_b64_tr_b16 v[34:35], v15 offset:256
s_waitcnt lgkmcnt(6)
v_mfma_f32_16x16x32_bf16 v[176:179], v[20:23], v[36:39], v[176:179]
v_mfma_f32_16x16x32_bf16 v[180:183], v[20:23], v[40:43], v[180:183]
v_mfma_f32_16x16x32_bf16 v[184:187], v[20:23], v[44:47], v[184:187]
v_mfma_f32_16x16x32_bf16 v[188:191], v[20:23], v[48:51], v[188:191]
v_mfma_f32_16x16x32_bf16 v[192:195], v[20:23], v[52:55], v[192:195]
s_waitcnt lgkmcnt(4)
v_mfma_f32_16x16x32_bf16 v[196:199], v[24:27], v[36:39], v[196:199]
s_add_u32 m0, s39, 4096
s_add_u32 s60, s36, 41088
s_add_u32 s62, s60, 18432
buffer_load_dwordx4 v9, s[24:27], s60 offen offset:0  lds
v_mfma_f32_16x16x32_bf16 v[200:203], v[24:27], v[40:43], v[200:203]
buffer_load_dwordx4 v10, s[24:27], s60 offen offset:1024  lds
v_mfma_f32_16x16x32_bf16 v[204:207], v[24:27], v[44:47], v[204:207]
buffer_load_dwordx4 v9, s[24:27], s62 offen offset:2048  lds
v_mfma_f32_16x16x32_bf16 v[208:211], v[24:27], v[48:51], v[208:211]
buffer_load_dwordx4 v10, s[24:27], s62 offen offset:3072  lds
v_mfma_f32_16x16x32_bf16 v[212:215], v[24:27], v[52:55], v[212:215]
s_waitcnt lgkmcnt(2)
v_mfma_f32_16x16x32_bf16 v[216:219], v[28:31], v[36:39], v[216:219]
v_mfma_f32_16x16x32_bf16 v[220:223], v[28:31], v[40:43], v[220:223]
v_mfma_f32_16x16x32_bf16 v[224:227], v[28:31], v[44:47], v[224:227]
v_mfma_f32_16x16x32_bf16 v[228:231], v[28:31], v[48:51], v[228:231]
v_mfma_f32_16x16x32_bf16 v[232:235], v[28:31], v[52:55], v[232:235]
s_waitcnt lgkmcnt(0)
v_mfma_f32_16x16x32_bf16 v[236:239], v[32:35], v[36:39], v[236:239]
s_add_u32 m0, s39, 8192
s_add_u32 s60, s37, 40960
s_add_u32 s62, s60, 19456
buffer_load_dwordx4 v11, s[24:27], s60 offen offset:0  lds
v_mfma_f32_16x16x32_bf16 v[240:243], v[32:35], v[40:43], v[240:243]
buffer_load_dwordx4 v11, s[24:27], s62 offen offset:1024  lds
v_mfma_f32_16x16x32_bf16 v[244:247], v[32:35], v[44:47], v[244:247]
v_mfma_f32_16x16x32_bf16 v[248:251], v[32:35], v[48:51], v[248:251]
v_mfma_f32_16x16x32_bf16 v[252:255], v[32:35], v[52:55], v[252:255]
ds_read_b128 v[36:39], v4 offset:35840
ds_read_b128 v[40:43], v4 offset:36864
ds_read_b128 v[44:47], v4 offset:37888
ds_read_b128 v[48:51], v4 offset:38912
ds_read_b128 v[52:55], v4 offset:39936
s_waitcnt vmcnt(6)
ds_read_b64_tr_b16 v[16:17], v12 offset:0
ds_read_b64_tr_b16 v[18:19], v12 offset:512
v_xor_b32 v15, 32, v12
ds_read_b64_tr_b16 v[20:21], v15 offset:0
ds_read_b64_tr_b16 v[22:23], v15 offset:512
v_xor_b32 v14, 64, v12
ds_read_b64_tr_b16 v[24:25], v14 offset:0
ds_read_b64_tr_b16 v[26:27], v14 offset:512
v_xor_b32 v15, 96, v12
ds_read_b64_tr_b16 v[28:29], v15 offset:0
ds_read_b64_tr_b16 v[30:31], v15 offset:512
s_waitcnt lgkmcnt(6)
v_mfma_f32_16x16x32_bf16 v[56:59], v[16:19], v[36:39], v[56:59]
v_mfma_f32_16x16x32_bf16 v[60:63], v[16:19], v[40:43], v[60:63]
v_mfma_f32_16x16x32_bf16 v[64:67], v[16:19], v[44:47], v[64:67]
v_mfma_f32_16x16x32_bf16 v[68:71], v[16:19], v[48:51], v[68:71]
v_mfma_f32_16x16x32_bf16 v[72:75], v[16:19], v[52:55], v[72:75]
s_waitcnt vmcnt(2)
ds_read_b64_tr_b16 v[32:33], v12 offset:4096
ds_read_b64_tr_b16 v[34:35], v12 offset:4608
s_waitcnt lgkmcnt(6)
v_mfma_f32_16x16x32_bf16 v[76:79], v[20:23], v[36:39], v[76:79]
v_mfma_f32_16x16x32_bf16 v[80:83], v[20:23], v[40:43], v[80:83]
v_mfma_f32_16x16x32_bf16 v[84:87], v[20:23], v[44:47], v[84:87]
v_mfma_f32_16x16x32_bf16 v[88:91], v[20:23], v[48:51], v[88:91]
v_mfma_f32_16x16x32_bf16 v[92:95], v[20:23], v[52:55], v[92:95]
v_xor_b32 v15, 32, v12
ds_read_b64_tr_b16 v[16:17], v15 offset:4096
ds_read_b64_tr_b16 v[18:19], v15 offset:4608
s_waitcnt lgkmcnt(6)
v_mfma_f32_16x16x32_bf16 v[96:99], v[24:27], v[36:39], v[96:99]
v_mfma_f32_16x16x32_bf16 v[100:103], v[24:27], v[40:43], v[100:103]
v_mfma_f32_16x16x32_bf16 v[104:107], v[24:27], v[44:47], v[104:107]
v_mfma_f32_16x16x32_bf16 v[108:111], v[24:27], v[48:51], v[108:111]
v_mfma_f32_16x16x32_bf16 v[112:115], v[24:27], v[52:55], v[112:115]
v_xor_b32 v14, 64, v12
ds_read_b64_tr_b16 v[20:21], v14 offset:4096
ds_read_b64_tr_b16 v[22:23], v14 offset:4608
s_waitcnt lgkmcnt(6)
v_mfma_f32_16x16x32_bf16 v[116:119], v[28:31], v[36:39], v[116:119]
s_add_u32 m0, s39, 0
s_add_u32 s60, s36, 81920
s_add_u32 s62, s60, 18432
buffer_load_dwordx4 v9, s[24:27], s60 offen offset:0  lds
v_mfma_f32_16x16x32_bf16 v[120:123], v[28:31], v[40:43], v[120:123]
buffer_load_dwordx4 v10, s[24:27], s60 offen offset:1024  lds
v_mfma_f32_16x16x32_bf16 v[124:127], v[28:31], v[44:47], v[124:127]
buffer_load_dwordx4 v9, s[24:27], s62 offen offset:2048  lds
v_mfma_f32_16x16x32_bf16 v[128:131], v[28:31], v[48:51], v[128:131]
buffer_load_dwordx4 v10, s[24:27], s62 offen offset:3072  lds
v_mfma_f32_16x16x32_bf16 v[132:135], v[28:31], v[52:55], v[132:135]
v_xor_b32 v15, 96, v12
ds_read_b64_tr_b16 v[24:25], v15 offset:4096
ds_read_b64_tr_b16 v[26:27], v15 offset:4608
s_waitcnt lgkmcnt(6)
v_mfma_f32_16x16x32_bf16 v[136:139], v[32:35], v[36:39], v[136:139]
v_mfma_f32_16x16x32_bf16 v[140:143], v[32:35], v[40:43], v[140:143]
v_mfma_f32_16x16x32_bf16 v[144:147], v[32:35], v[44:47], v[144:147]
v_mfma_f32_16x16x32_bf16 v[148:151], v[32:35], v[48:51], v[148:151]
v_mfma_f32_16x16x32_bf16 v[152:155], v[32:35], v[52:55], v[152:155]
s_waitcnt vmcnt(4)
ds_read_b64_tr_b16 v[28:29], v13 offset:0
ds_read_b64_tr_b16 v[30:31], v13 offset:256
s_waitcnt lgkmcnt(6)
v_mfma_f32_16x16x32_bf16 v[156:159], v[16:19], v[36:39], v[156:159]
v_mfma_f32_16x16x32_bf16 v[160:163], v[16:19], v[40:43], v[160:163]
v_mfma_f32_16x16x32_bf16 v[164:167], v[16:19], v[44:47], v[164:167]
v_mfma_f32_16x16x32_bf16 v[168:171], v[16:19], v[48:51], v[168:171]
v_mfma_f32_16x16x32_bf16 v[172:175], v[16:19], v[52:55], v[172:175]
v_xor_b32 v15, 32, v13
ds_read_b64_tr_b16 v[32:33], v15 offset:0
ds_read_b64_tr_b16 v[34:35], v15 offset:256
s_waitcnt lgkmcnt(6)
v_mfma_f32_16x16x32_bf16 v[176:179], v[20:23], v[36:39], v[176:179]
v_mfma_f32_16x16x32_bf16 v[180:183], v[20:23], v[40:43], v[180:183]
v_mfma_f32_16x16x32_bf16 v[184:187], v[20:23], v[44:47], v[184:187]
v_mfma_f32_16x16x32_bf16 v[188:191], v[20:23], v[48:51], v[188:191]
v_mfma_f32_16x16x32_bf16 v[192:195], v[20:23], v[52:55], v[192:195]
s_waitcnt lgkmcnt(4)
v_mfma_f32_16x16x32_bf16 v[196:199], v[24:27], v[36:39], v[196:199]
s_add_u32 m0, s39, 4096
s_add_u32 s60, s36, 82048
s_add_u32 s62, s60, 18432
buffer_load_dwordx4 v9, s[24:27], s60 offen offset:0  lds
v_mfma_f32_16x16x32_bf16 v[200:203], v[24:27], v[40:43], v[200:203]
buffer_load_dwordx4 v10, s[24:27], s60 offen offset:1024  lds
v_mfma_f32_16x16x32_bf16 v[204:207], v[24:27], v[44:47], v[204:207]
buffer_load_dwordx4 v9, s[24:27], s62 offen offset:2048  lds
v_mfma_f32_16x16x32_bf16 v[208:211], v[24:27], v[48:51], v[208:211]
buffer_load_dwordx4 v10, s[24:27], s62 offen offset:3072  lds
v_mfma_f32_16x16x32_bf16 v[212:215], v[24:27], v[52:55], v[212:215]
s_waitcnt lgkmcnt(2)
v_mfma_f32_16x16x32_bf16 v[216:219], v[28:31], v[36:39], v[216:219]
v_mfma_f32_16x16x32_bf16 v[220:223], v[28:31], v[40:43], v[220:223]
v_mfma_f32_16x16x32_bf16 v[224:227], v[28:31], v[44:47], v[224:227]
v_mfma_f32_16x16x32_bf16 v[228:231], v[28:31], v[48:51], v[228:231]
v_mfma_f32_16x16x32_bf16 v[232:235], v[28:31], v[52:55], v[232:235]
s_waitcnt lgkmcnt(0)
v_mfma_f32_16x16x32_bf16 v[236:239], v[32:35], v[36:39], v[236:239]
s_add_u32 m0, s39, 8192
s_add_u32 s60, s37, 81920
s_add_u32 s62, s60, 19456
buffer_load_dwordx4 v11, s[24:27], s60 offen offset:0  lds
v_mfma_f32_16x16x32_bf16 v[240:243], v[32:35], v[40:43], v[240:243]
buffer_load_dwordx4 v11, s[24:27], s62 offen offset:1024  lds
v_mfma_f32_16x16x32_bf16 v[244:247], v[32:35], v[44:47], v[244:247]
v_mfma_f32_16x16x32_bf16 v[248:251], v[32:35], v[48:51], v[248:251]
v_mfma_f32_16x16x32_bf16 v[252:255], v[32:35], v[52:55], v[252:255]
ds_read_b128 v[36:39], v4 offset:40960
ds_read_b128 v[40:43], v4 offset:41984
ds_read_b128 v[44:47], v4 offset:43008
ds_read_b128 v[48:51], v4 offset:44032
ds_read_b128 v[52:55], v4 offset:45056
s_waitcnt vmcnt(6)
ds_read_b64_tr_b16 v[16:17], v12 offset:0
ds_read_b64_tr_b16 v[18:19], v12 offset:512
v_xor_b32 v15, 32, v12
ds_read_b64_tr_b16 v[20:21], v15 offset:0
ds_read_b64_tr_b16 v[22:23], v15 offset:512
v_xor_b32 v14, 64, v12
ds_read_b64_tr_b16 v[24:25], v14 offset:0
ds_read_b64_tr_b16 v[26:27], v14 offset:512
v_xor_b32 v15, 96, v12
ds_read_b64_tr_b16 v[28:29], v15 offset:0
ds_read_b64_tr_b16 v[30:31], v15 offset:512
s_waitcnt lgkmcnt(6)
v_mfma_f32_16x16x32_bf16 v[56:59], v[16:19], v[36:39], v[56:59]
v_mfma_f32_16x16x32_bf16 v[60:63], v[16:19], v[40:43], v[60:63]
v_mfma_f32_16x16x32_bf16 v[64:67], v[16:19], v[44:47], v[64:67]
v_mfma_f32_16x16x32_bf16 v[68:71], v[16:19], v[48:51], v[68:71]
v_mfma_f32_16x16x32_bf16 v[72:75], v[16:19], v[52:55], v[72:75]
s_waitcnt vmcnt(2)
ds_read_b64_tr_b16 v[32:33], v12 offset:4096
ds_read_b64_tr_b16 v[34:35], v12 offset:4608
s_waitcnt lgkmcnt(6)
v_mfma_f32_16x16x32_bf16 v[76:79], v[20:23], v[36:39], v[76:79]
v_mfma_f32_16x16x32_bf16 v[80:83], v[20:23], v[40:43], v[80:83]
v_mfma_f32_16x16x32_bf16 v[84:87], v[20:23], v[44:47], v[84:87]
v_mfma_f32_16x16x32_bf16 v[88:91], v[20:23], v[48:51], v[88:91]
v_mfma_f32_16x16x32_bf16 v[92:95], v[20:23], v[52:55], v[92:95]
v_xor_b32 v15, 32, v12
ds_read_b64_tr_b16 v[16:17], v15 offset:4096
ds_read_b64_tr_b16 v[18:19], v15 offset:4608
s_waitcnt lgkmcnt(6)
v_mfma_f32_16x16x32_bf16 v[96:99], v[24:27], v[36:39], v[96:99]
v_mfma_f32_16x16x32_bf16 v[100:103], v[24:27], v[40:43], v[100:103]
v_mfma_f32_16x16x32_bf16 v[104:107], v[24:27], v[44:47], v[104:107]
v_mfma_f32_16x16x32_bf16 v[108:111], v[24:27], v[48:51], v[108:111]
v_mfma_f32_16x16x32_bf16 v[112:115], v[24:27], v[52:55], v[112:115]
v_xor_b32 v14, 64, v12
ds_read_b64_tr_b16 v[20:21], v14 offset:4096
ds_read_b64_tr_b16 v[22:23], v14 offset:4608
s_waitcnt lgkmcnt(6)
v_mfma_f32_16x16x32_bf16 v[116:119], v[28:31], v[36:39], v[116:119]
s_add_u32 m0, s39, 0
s_add_u32 s60, s36, 122880
s_add_u32 s62, s60, 18432
buffer_load_dwordx4 v9, s[24:27], s60 offen offset:0  lds
v_mfma_f32_16x16x32_bf16 v[120:123], v[28:31], v[40:43], v[120:123]
buffer_load_dwordx4 v10, s[24:27], s60 offen offset:1024  lds
v_mfma_f32_16x16x32_bf16 v[124:127], v[28:31], v[44:47], v[124:127]
buffer_load_dwordx4 v9, s[24:27], s62 offen offset:2048  lds
v_mfma_f32_16x16x32_bf16 v[128:131], v[28:31], v[48:51], v[128:131]
buffer_load_dwordx4 v10, s[24:27], s62 offen offset:3072  lds
v_mfma_f32_16x16x32_bf16 v[132:135], v[28:31], v[52:55], v[132:135]
v_xor_b32 v15, 96, v12
ds_read_b64_tr_b16 v[24:25], v15 offset:4096
ds_read_b64_tr_b16 v[26:27], v15 offset:4608
s_waitcnt lgkmcnt(6)
v_mfma_f32_16x16x32_bf16 v[136:139], v[32:35], v[36:39], v[136:139]
v_mfma_f32_16x16x32_bf16 v[140:143], v[32:35], v[40:43], v[140:143]
v_mfma_f32_16x16x32_bf16 v[144:147], v[32:35], v[44:47], v[144:147]
v_mfma_f32_16x16x32_bf16 v[148:151], v[32:35], v[48:51], v[148:151]
v_mfma_f32_16x16x32_bf16 v[152:155], v[32:35], v[52:55], v[152:155]
s_waitcnt vmcnt(4)
ds_read_b64_tr_b16 v[28:29], v13 offset:0
ds_read_b64_tr_b16 v[30:31], v13 offset:256
s_waitcnt lgkmcnt(6)
v_mfma_f32_16x16x32_bf16 v[156:159], v[16:19], v[36:39], v[156:159]
v_mfma_f32_16x16x32_bf16 v[160:163], v[16:19], v[40:43], v[160:163]
v_mfma_f32_16x16x32_bf16 v[164:167], v[16:19], v[44:47], v[164:167]
v_mfma_f32_16x16x32_bf16 v[168:171], v[16:19], v[48:51], v[168:171]
v_mfma_f32_16x16x32_bf16 v[172:175], v[16:19], v[52:55], v[172:175]
v_xor_b32 v15, 32, v13
ds_read_b64_tr_b16 v[32:33], v15 offset:0
ds_read_b64_tr_b16 v[34:35], v15 offset:256
s_waitcnt lgkmcnt(6)
v_mfma_f32_16x16x32_bf16 v[176:179], v[20:23], v[36:39], v[176:179]
v_mfma_f32_16x16x32_bf16 v[180:183], v[20:23], v[40:43], v[180:183]
v_mfma_f32_16x16x32_bf16 v[184:187], v[20:23], v[44:47], v[184:187]
v_mfma_f32_16x16x32_bf16 v[188:191], v[20:23], v[48:51], v[188:191]
v_mfma_f32_16x16x32_bf16 v[192:195], v[20:23], v[52:55], v[192:195]
s_waitcnt lgkmcnt(4)
v_mfma_f32_16x16x32_bf16 v[196:199], v[24:27], v[36:39], v[196:199]
s_add_u32 m0, s39, 4096
s_add_u32 s60, s36, 123008
s_add_u32 s62, s60, 18432
buffer_load_dwordx4 v9, s[24:27], s60 offen offset:0  lds
v_mfma_f32_16x16x32_bf16 v[200:203], v[24:27], v[40:43], v[200:203]
buffer_load_dwordx4 v10, s[24:27], s60 offen offset:1024  lds
v_mfma_f32_16x16x32_bf16 v[204:207], v[24:27], v[44:47], v[204:207]
buffer_load_dwordx4 v9, s[24:27], s62 offen offset:2048  lds
v_mfma_f32_16x16x32_bf16 v[208:211], v[24:27], v[48:51], v[208:211]
buffer_load_dwordx4 v10, s[24:27], s62 offen offset:3072  lds
v_mfma_f32_16x16x32_bf16 v[212:215], v[24:27], v[52:55], v[212:215]
s_waitcnt lgkmcnt(2)
v_mfma_f32_16x16x32_bf16 v[216:219], v[28:31], v[36:39], v[216:219]
v_mfma_f32_16x16x32_bf16 v[220:223], v[28:31], v[40:43], v[220:223]
v_mfma_f32_16x16x32_bf16 v[224:227], v[28:31], v[44:47], v[224:227]
v_mfma_f32_16x16x32_bf16 v[228:231], v[28:31], v[48:51], v[228:231]
v_mfma_f32_16x16x32_bf16 v[232:235], v[28:31], v[52:55], v[232:235]
s_waitcnt lgkmcnt(0)
v_mfma_f32_16x16x32_bf16 v[236:239], v[32:35], v[36:39], v[236:239]
s_add_u32 m0, s39, 8192
s_add_u32 s60, s37, 122880
s_add_u32 s62, s60, 19456
buffer_load_dwordx4 v11, s[24:27], s60 offen offset:0  lds
v_mfma_f32_16x16x32_bf16 v[240:243], v[32:35], v[40:43], v[240:243]
buffer_load_dwordx4 v11, s[24:27], s62 offen offset:1024  lds
v_mfma_f32_16x16x32_bf16 v[244:247], v[32:35], v[44:47], v[244:247]
v_mfma_f32_16x16x32_bf16 v[248:251], v[32:35], v[48:51], v[248:251]
v_mfma_f32_16x16x32_bf16 v[252:255], v[32:35], v[52:55], v[252:255]
ds_read_b128 v[36:39], v4 offset:46080
ds_read_b128 v[40:43], v4 offset:47104
ds_read_b128 v[44:47], v4 offset:48128
ds_read_b128 v[48:51], v4 offset:49152
ds_read_b128 v[52:55], v4 offset:50176
s_waitcnt vmcnt(6)
ds_read_b64_tr_b16 v[16:17], v12 offset:0
ds_read_b64_tr_b16 v[18:19], v12 offset:512
v_xor_b32 v15, 32, v12
ds_read_b64_tr_b16 v[20:21], v15 offset:0
ds_read_b64_tr_b16 v[22:23], v15 offset:512
v_xor_b32 v14, 64, v12
ds_read_b64_tr_b16 v[24:25], v14 offset:0
ds_read_b64_tr_b16 v[26:27], v14 offset:512
v_xor_b32 v15, 96, v12
ds_read_b64_tr_b16 v[28:29], v15 offset:0
ds_read_b64_tr_b16 v[30:31], v15 offset:512
s_waitcnt lgkmcnt(6)
v_mfma_f32_16x16x32_bf16 v[56:59], v[16:19], v[36:39], v[56:59]
v_mfma_f32_16x16x32_bf16 v[60:63], v[16:19], v[40:43], v[60:63]
v_mfma_f32_16x16x32_bf16 v[64:67], v[16:19], v[44:47], v[64:67]
v_mfma_f32_16x16x32_bf16 v[68:71], v[16:19], v[48:51], v[68:71]
v_mfma_f32_16x16x32_bf16 v[72:75], v[16:19], v[52:55], v[72:75]
s_waitcnt vmcnt(2)
ds_read_b64_tr_b16 v[32:33], v12 offset:4096
ds_read_b64_tr_b16 v[34:35], v12 offset:4608
s_waitcnt lgkmcnt(6)
v_mfma_f32_16x16x32_bf16 v[76:79], v[20:23], v[36:39], v[76:79]
v_mfma_f32_16x16x32_bf16 v[80:83], v[20:23], v[40:43], v[80:83]
v_mfma_f32_16x16x32_bf16 v[84:87], v[20:23], v[44:47], v[84:87]
v_mfma_f32_16x16x32_bf16 v[88:91], v[20:23], v[48:51], v[88:91]
v_mfma_f32_16x16x32_bf16 v[92:95], v[20:23], v[52:55], v[92:95]
v_xor_b32 v15, 32, v12
ds_read_b64_tr_b16 v[16:17], v15 offset:4096
ds_read_b64_tr_b16 v[18:19], v15 offset:4608
s_waitcnt lgkmcnt(6)
v_mfma_f32_16x16x32_bf16 v[96:99], v[24:27], v[36:39], v[96:99]
v_mfma_f32_16x16x32_bf16 v[100:103], v[24:27], v[40:43], v[100:103]
v_mfma_f32_16x16x32_bf16 v[104:107], v[24:27], v[44:47], v[104:107]
v_mfma_f32_16x16x32_bf16 v[108:111], v[24:27], v[48:51], v[108:111]
v_mfma_f32_16x16x32_bf16 v[112:115], v[24:27], v[52:55], v[112:115]
v_xor_b32 v14, 64, v12
ds_read_b64_tr_b16 v[20:21], v14 offset:4096
ds_read_b64_tr_b16 v[22:23], v14 offset:4608
s_waitcnt lgkmcnt(6)
v_mfma_f32_16x16x32_bf16 v[116:119], v[28:31], v[36:39], v[116:119]
s_add_u32 m0, s39, 0
s_add_u32 s60, s36, 163840
s_add_u32 s62, s60, 18432
buffer_load_dwordx4 v9, s[24:27], s60 offen offset:0  lds
v_mfma_f32_16x16x32_bf16 v[120:123], v[28:31], v[40:43], v[120:123]
buffer_load_dwordx4 v10, s[24:27], s60 offen offset:1024  lds
v_mfma_f32_16x16x32_bf16 v[124:127], v[28:31], v[44:47], v[124:127]
buffer_load_dwordx4 v9, s[24:27], s62 offen offset:2048  lds
v_mfma_f32_16x16x32_bf16 v[128:131], v[28:31], v[48:51], v[128:131]
buffer_load_dwordx4 v10, s[24:27], s62 offen offset:3072  lds
v_mfma_f32_16x16x32_bf16 v[132:135], v[28:31], v[52:55], v[132:135]
v_xor_b32 v15, 96, v12
ds_read_b64_tr_b16 v[24:25], v15 offset:4096
ds_read_b64_tr_b16 v[26:27], v15 offset:4608
s_waitcnt lgkmcnt(6)
v_mfma_f32_16x16x32_bf16 v[136:139], v[32:35], v[36:39], v[136:139]
v_mfma_f32_16x16x32_bf16 v[140:143], v[32:35], v[40:43], v[140:143]
v_mfma_f32_16x16x32_bf16 v[144:147], v[32:35], v[44:47], v[144:147]
v_mfma_f32_16x16x32_bf16 v[148:151], v[32:35], v[48:51], v[148:151]
v_mfma_f32_16x16x32_bf16 v[152:155], v[32:35], v[52:55], v[152:155]
s_waitcnt vmcnt(4)
ds_read_b64_tr_b16 v[28:29], v13 offset:0
ds_read_b64_tr_b16 v[30:31], v13 offset:256
s_waitcnt lgkmcnt(6)
v_mfma_f32_16x16x32_bf16 v[156:159], v[16:19], v[36:39], v[156:159]
v_mfma_f32_16x16x32_bf16 v[160:163], v[16:19], v[40:43], v[160:163]
v_mfma_f32_16x16x32_bf16 v[164:167], v[16:19], v[44:47], v[164:167]
v_mfma_f32_16x16x32_bf16 v[168:171], v[16:19], v[48:51], v[168:171]
v_mfma_f32_16x16x32_bf16 v[172:175], v[16:19], v[52:55], v[172:175]
v_xor_b32 v15, 32, v13
ds_read_b64_tr_b16 v[32:33], v15 offset:0
ds_read_b64_tr_b16 v[34:35], v15 offset:256
s_waitcnt lgkmcnt(6)
v_mfma_f32_16x16x32_bf16 v[176:179], v[20:23], v[36:39], v[176:179]
v_mfma_f32_16x16x32_bf16 v[180:183], v[20:23], v[40:43], v[180:183]
v_mfma_f32_16x16x32_bf16 v[184:187], v[20:23], v[44:47], v[184:187]
v_mfma_f32_16x16x32_bf16 v[188:191], v[20:23], v[48:51], v[188:191]
v_mfma_f32_16x16x32_bf16 v[192:195], v[20:23], v[52:55], v[192:195]
s_waitcnt lgkmcnt(4)
v_mfma_f32_16x16x32_bf16 v[196:199], v[24:27], v[36:39], v[196:199]
s_add_u32 m0, s39, 4096
s_add_u32 s60, s36, 163968
s_add_u32 s62, s60, 18432
buffer_load_dwordx4 v9, s[24:27], s60 offen offset:0  lds
v_mfma_f32_16x16x32_bf16 v[200:203], v[24:27], v[40:43], v[200:203]
buffer_load_dwordx4 v10, s[24:27], s60 offen offset:1024  lds
v_mfma_f32_16x16x32_bf16 v[204:207], v[24:27], v[44:47], v[204:207]
buffer_load_dwordx4 v9, s[24:27], s62 offen offset:2048  lds
v_mfma_f32_16x16x32_bf16 v[208:211], v[24:27], v[48:51], v[208:211]
buffer_load_dwordx4 v10, s[24:27], s62 offen offset:3072  lds
v_mfma_f32_16x16x32_bf16 v[212:215], v[24:27], v[52:55], v[212:215]
s_waitcnt lgkmcnt(2)
v_mfma_f32_16x16x32_bf16 v[216:219], v[28:31], v[36:39], v[216:219]
v_mfma_f32_16x16x32_bf16 v[220:223], v[28:31], v[40:43], v[220:223]
v_mfma_f32_16x16x32_bf16 v[224:227], v[28:31], v[44:47], v[224:227]
v_mfma_f32_16x16x32_bf16 v[228:231], v[28:31], v[48:51], v[228:231]
v_mfma_f32_16x16x32_bf16 v[232:235], v[28:31], v[52:55], v[232:235]
s_waitcnt lgkmcnt(0)
v_mfma_f32_16x16x32_bf16 v[236:239], v[32:35], v[36:39], v[236:239]
s_add_u32 m0, s39, 8192
s_add_u32 s60, s37, 163840
s_add_u32 s62, s60, 19456
buffer_load_dwordx4 v11, s[24:27], s60 offen offset:0  lds
v_mfma_f32_16x16x32_bf16 v[240:243], v[32:35], v[40:43], v[240:243]
buffer_load_dwordx4 v11, s[24:27], s62 offen offset:1024  lds
v_mfma_f32_16x16x32_bf16 v[244:247], v[32:35], v[44:47], v[244:247]
v_mfma_f32_16x16x32_bf16 v[248:251], v[32:35], v[48:51], v[248:251]
v_mfma_f32_16x16x32_bf16 v[252:255], v[32:35], v[52:55], v[252:255]
ds_read_b128 v[36:39], v4 offset:51200
ds_read_b128 v[40:43], v4 offset:52224
ds_read_b128 v[44:47], v4 offset:53248
ds_read_b128 v[48:51], v4 offset:54272
ds_read_b128 v[52:55], v4 offset:55296
s_waitcnt vmcnt(6)
ds_read_b64_tr_b16 v[16:17], v12 offset:0
ds_read_b64_tr_b16 v[18:19], v12 offset:512
v_xor_b32 v15, 32, v12
ds_read_b64_tr_b16 v[20:21], v15 offset:0
ds_read_b64_tr_b16 v[22:23], v15 offset:512
v_xor_b32 v14, 64, v12
ds_read_b64_tr_b16 v[24:25], v14 offset:0
ds_read_b64_tr_b16 v[26:27], v14 offset:512
v_xor_b32 v15, 96, v12
ds_read_b64_tr_b16 v[28:29], v15 offset:0
ds_read_b64_tr_b16 v[30:31], v15 offset:512
s_waitcnt lgkmcnt(6)
v_mfma_f32_16x16x32_bf16 v[56:59], v[16:19], v[36:39], v[56:59]
v_mfma_f32_16x16x32_bf16 v[60:63], v[16:19], v[40:43], v[60:63]
v_mfma_f32_16x16x32_bf16 v[64:67], v[16:19], v[44:47], v[64:67]
v_mfma_f32_16x16x32_bf16 v[68:71], v[16:19], v[48:51], v[68:71]
v_mfma_f32_16x16x32_bf16 v[72:75], v[16:19], v[52:55], v[72:75]
s_waitcnt vmcnt(2)
ds_read_b64_tr_b16 v[32:33], v12 offset:4096
ds_read_b64_tr_b16 v[34:35], v12 offset:4608
s_waitcnt lgkmcnt(6)
v_mfma_f32_16x16x32_bf16 v[76:79], v[20:23], v[36:39], v[76:79]
v_mfma_f32_16x16x32_bf16 v[80:83], v[20:23], v[40:43], v[80:83]
v_mfma_f32_16x16x32_bf16 v[84:87], v[20:23], v[44:47], v[84:87]
v_mfma_f32_16x16x32_bf16 v[88:91], v[20:23], v[48:51], v[88:91]
v_mfma_f32_16x16x32_bf16 v[92:95], v[20:23], v[52:55], v[92:95]
v_xor_b32 v15, 32, v12
ds_read_b64_tr_b16 v[16:17], v15 offset:4096
ds_read_b64_tr_b16 v[18:19], v15 offset:4608
s_waitcnt lgkmcnt(6)
v_mfma_f32_16x16x32_bf16 v[96:99], v[24:27], v[36:39], v[96:99]
v_mfma_f32_16x16x32_bf16 v[100:103], v[24:27], v[40:43], v[100:103]
v_mfma_f32_16x16x32_bf16 v[104:107], v[24:27], v[44:47], v[104:107]
v_mfma_f32_16x16x32_bf16 v[108:111], v[24:27], v[48:51], v[108:111]
v_mfma_f32_16x16x32_bf16 v[112:115], v[24:27], v[52:55], v[112:115]
v_xor_b32 v14, 64, v12
ds_read_b64_tr_b16 v[20:21], v14 offset:4096
ds_read_b64_tr_b16 v[22:23], v14 offset:4608
s_waitcnt lgkmcnt(6)
v_mfma_f32_16x16x32_bf16 v[116:119], v[28:31], v[36:39], v[116:119]
s_add_u32 m0, s39, 0
s_add_u32 s60, s36, 204800
s_add_u32 s62, s60, 18432
buffer_load_dwordx4 v9, s[24:27], s60 offen offset:0  lds
v_mfma_f32_16x16x32_bf16 v[120:123], v[28:31], v[40:43], v[120:123]
buffer_load_dwordx4 v10, s[24:27], s60 offen offset:1024  lds
v_mfma_f32_16x16x32_bf16 v[124:127], v[28:31], v[44:47], v[124:127]
buffer_load_dwordx4 v9, s[24:27], s62 offen offset:2048  lds
v_mfma_f32_16x16x32_bf16 v[128:131], v[28:31], v[48:51], v[128:131]
buffer_load_dwordx4 v10, s[24:27], s62 offen offset:3072  lds
v_mfma_f32_16x16x32_bf16 v[132:135], v[28:31], v[52:55], v[132:135]
v_xor_b32 v15, 96, v12
ds_read_b64_tr_b16 v[24:25], v15 offset:4096
ds_read_b64_tr_b16 v[26:27], v15 offset:4608
s_waitcnt lgkmcnt(6)
v_mfma_f32_16x16x32_bf16 v[136:139], v[32:35], v[36:39], v[136:139]
v_mfma_f32_16x16x32_bf16 v[140:143], v[32:35], v[40:43], v[140:143]
v_mfma_f32_16x16x32_bf16 v[144:147], v[32:35], v[44:47], v[144:147]
v_mfma_f32_16x16x32_bf16 v[148:151], v[32:35], v[48:51], v[148:151]
v_mfma_f32_16x16x32_bf16 v[152:155], v[32:35], v[52:55], v[152:155]
s_waitcnt vmcnt(4)
ds_read_b64_tr_b16 v[28:29], v13 offset:0
ds_read_b64_tr_b16 v[30:31], v13 offset:256
s_waitcnt lgkmcnt(6)
v_mfma_f32_16x16x32_bf16 v[156:159], v[16:19], v[36:39], v[156:159]
v_mfma_f32_16x16x32_bf16 v[160:163], v[16:19], v[40:43], v[160:163]
v_mfma_f32_16x16x32_bf16 v[164:167], v[16:19], v[44:47], v[164:167]
v_mfma_f32_16x16x32_bf16 v[168:171], v[16:19], v[48:51], v[168:171]
v_mfma_f32_16x16x32_bf16 v[172:175], v[16:19], v[52:55], v[172:175]
v_xor_b32 v15, 32, v13
ds_read_b64_tr_b16 v[32:33], v15 offset:0
ds_read_b64_tr_b16 v[34:35], v15 offset:256
s_waitcnt lgkmcnt(6)
v_mfma_f32_16x16x32_bf16 v[176:179], v[20:23], v[36:39], v[176:179]
v_mfma_f32_16x16x32_bf16 v[180:183], v[20:23], v[40:43], v[180:183]
v_mfma_f32_16x16x32_bf16 v[184:187], v[20:23], v[44:47], v[184:187]
v_mfma_f32_16x16x32_bf16 v[188:191], v[20:23], v[48:51], v[188:191]
v_mfma_f32_16x16x32_bf16 v[192:195], v[20:23], v[52:55], v[192:195]
s_waitcnt lgkmcnt(4)
v_mfma_f32_16x16x32_bf16 v[196:199], v[24:27], v[36:39], v[196:199]
s_add_u32 m0, s39, 4096
s_add_u32 s60, s36, 204928
s_add_u32 s62, s60, 18432
buffer_load_dwordx4 v9, s[24:27], s60 offen offset:0  lds
v_mfma_f32_16x16x32_bf16 v[200:203], v[24:27], v[40:43], v[200:203]
buffer_load_dwordx4 v10, s[24:27], s60 offen offset:1024  lds
v_mfma_f32_16x16x32_bf16 v[204:207], v[24:27], v[44:47], v[204:207]
buffer_load_dwordx4 v9, s[24:27], s62 offen offset:2048  lds
v_mfma_f32_16x16x32_bf16 v[208:211], v[24:27], v[48:51], v[208:211]
buffer_load_dwordx4 v10, s[24:27], s62 offen offset:3072  lds
v_mfma_f32_16x16x32_bf16 v[212:215], v[24:27], v[52:55], v[212:215]
s_waitcnt lgkmcnt(2)
v_mfma_f32_16x16x32_bf16 v[216:219], v[28:31], v[36:39], v[216:219]
v_mfma_f32_16x16x32_bf16 v[220:223], v[28:31], v[40:43], v[220:223]
v_mfma_f32_16x16x32_bf16 v[224:227], v[28:31], v[44:47], v[224:227]
v_mfma_f32_16x16x32_bf16 v[228:231], v[28:31], v[48:51], v[228:231]
v_mfma_f32_16x16x32_bf16 v[232:235], v[28:31], v[52:55], v[232:235]
s_waitcnt lgkmcnt(0)
v_mfma_f32_16x16x32_bf16 v[236:239], v[32:35], v[36:39], v[236:239]
s_add_u32 m0, s39, 8192
s_add_u32 s60, s37, 204800
s_add_u32 s62, s60, 19456
buffer_load_dwordx4 v11, s[24:27], s60 offen offset:0  lds
v_mfma_f32_16x16x32_bf16 v[240:243], v[32:35], v[40:43], v[240:243]
buffer_load_dwordx4 v11, s[24:27], s62 offen offset:1024  lds
v_mfma_f32_16x16x32_bf16 v[244:247], v[32:35], v[44:47], v[244:247]
v_mfma_f32_16x16x32_bf16 v[248:251], v[32:35], v[48:51], v[248:251]
v_mfma_f32_16x16x32_bf16 v[252:255], v[32:35], v[52:55], v[252:255]
ds_read_b128 v[36:39], v4 offset:56320
ds_read_b128 v[40:43], v4 offset:57344
ds_read_b128 v[44:47], v4 offset:58368
ds_read_b128 v[48:51], v4 offset:59392
ds_read_b128 v[52:55], v4 offset:60416
s_waitcnt vmcnt(6)
ds_read_b64_tr_b16 v[16:17], v12 offset:0
ds_read_b64_tr_b16 v[18:19], v12 offset:512
v_xor_b32 v15, 32, v12
ds_read_b64_tr_b16 v[20:21], v15 offset:0
ds_read_b64_tr_b16 v[22:23], v15 offset:512
v_xor_b32 v14, 64, v12
ds_read_b64_tr_b16 v[24:25], v14 offset:0
ds_read_b64_tr_b16 v[26:27], v14 offset:512
v_xor_b32 v15, 96, v12
ds_read_b64_tr_b16 v[28:29], v15 offset:0
ds_read_b64_tr_b16 v[30:31], v15 offset:512
s_waitcnt lgkmcnt(6)
v_mfma_f32_16x16x32_bf16 v[56:59], v[16:19], v[36:39], v[56:59]
v_mfma_f32_16x16x32_bf16 v[60:63], v[16:19], v[40:43], v[60:63]
v_mfma_f32_16x16x32_bf16 v[64:67], v[16:19], v[44:47], v[64:67]
v_mfma_f32_16x16x32_bf16 v[68:71], v[16:19], v[48:51], v[68:71]
v_mfma_f32_16x16x32_bf16 v[72:75], v[16:19], v[52:55], v[72:75]
s_waitcnt vmcnt(2)
ds_read_b64_tr_b16 v[32:33], v12 offset:4096
ds_read_b64_tr_b16 v[34:35], v12 offset:4608
s_waitcnt lgkmcnt(6)
v_mfma_f32_16x16x32_bf16 v[76:79], v[20:23], v[36:39], v[76:79]
v_mfma_f32_16x16x32_bf16 v[80:83], v[20:23], v[40:43], v[80:83]
v_mfma_f32_16x16x32_bf16 v[84:87], v[20:23], v[44:47], v[84:87]
v_mfma_f32_16x16x32_bf16 v[88:91], v[20:23], v[48:51], v[88:91]
v_mfma_f32_16x16x32_bf16 v[92:95], v[20:23], v[52:55], v[92:95]
v_xor_b32 v15, 32, v12
ds_read_b64_tr_b16 v[16:17], v15 offset:4096
ds_read_b64_tr_b16 v[18:19], v15 offset:4608
s_waitcnt lgkmcnt(6)
v_mfma_f32_16x16x32_bf16 v[96:99], v[24:27], v[36:39], v[96:99]
v_mfma_f32_16x16x32_bf16 v[100:103], v[24:27], v[40:43], v[100:103]
v_mfma_f32_16x16x32_bf16 v[104:107], v[24:27], v[44:47], v[104:107]
v_mfma_f32_16x16x32_bf16 v[108:111], v[24:27], v[48:51], v[108:111]
v_mfma_f32_16x16x32_bf16 v[112:115], v[24:27], v[52:55], v[112:115]
v_xor_b32 v14, 64, v12
ds_read_b64_tr_b16 v[20:21], v14 offset:4096
ds_read_b64_tr_b16 v[22:23], v14 offset:4608
s_waitcnt lgkmcnt(6)
v_mfma_f32_16x16x32_bf16 v[116:119], v[28:31], v[36:39], v[116:119]
v_mfma_f32_16x16x32_bf16 v[120:123], v[28:31], v[40:43], v[120:123]
v_mfma_f32_16x16x32_bf16 v[124:127], v[28:31], v[44:47], v[124:127]
v_mfma_f32_16x16x32_bf16 v[128:131], v[28:31], v[48:51], v[128:131]
v_mfma_f32_16x16x32_bf16 v[132:135], v[28:31], v[52:55], v[132:135]
v_xor_b32 v15, 96, v12
ds_read_b64_tr_b16 v[24:25], v15 offset:4096
ds_read_b64_tr_b16 v[26:27], v15 offset:4608
s_waitcnt lgkmcnt(6)
v_mfma_f32_16x16x32_bf16 v[136:139], v[32:35], v[36:39], v[136:139]
v_cvt_pk_bf16_f32 v56, v56, v57
v_cvt_pk_bf16_f32 v57, v58, v59
v_cvt_pk_bf16_f32 v58, v76, v77
v_cvt_pk_bf16_f32 v59, v78, v79
s_mov_b32 s3, 0
buffer_store_dwordx4 v[56:59], v1, s[28:31], s3 offen sc1
v_mfma_f32_16x16x32_bf16 v[140:143], v[32:35], v[40:43], v[140:143]
v_cvt_pk_bf16_f32 v60, v60, v61
v_cvt_pk_bf16_f32 v61, v62, v63
v_cvt_pk_bf16_f32 v62, v80, v81
v_cvt_pk_bf16_f32 v63, v82, v83
s_mov_b32 s3, 1024
buffer_store_dwordx4 v[60:63], v1, s[28:31], s3 offen sc1
v_mfma_f32_16x16x32_bf16 v[144:147], v[32:35], v[44:47], v[144:147]
v_cvt_pk_bf16_f32 v64, v64, v65
v_cvt_pk_bf16_f32 v65, v66, v67
v_cvt_pk_bf16_f32 v66, v84, v85
v_cvt_pk_bf16_f32 v67, v86, v87
s_mov_b32 s3, 2048
buffer_store_dwordx4 v[64:67], v1, s[28:31], s3 offen sc1
v_mfma_f32_16x16x32_bf16 v[148:151], v[32:35], v[48:51], v[148:151]
v_cvt_pk_bf16_f32 v68, v68, v69
v_cvt_pk_bf16_f32 v69, v70, v71
v_cvt_pk_bf16_f32 v70, v88, v89
v_cvt_pk_bf16_f32 v71, v90, v91
s_mov_b32 s3, 3072
buffer_store_dwordx4 v[68:71], v1, s[28:31], s3 offen sc1
v_mfma_f32_16x16x32_bf16 v[152:155], v[32:35], v[52:55], v[152:155]
v_cvt_pk_bf16_f32 v72, v72, v73
v_cvt_pk_bf16_f32 v73, v74, v75
v_cvt_pk_bf16_f32 v74, v92, v93
v_cvt_pk_bf16_f32 v75, v94, v95
s_mov_b32 s3, 4096
buffer_store_dwordx4 v[72:75], v1, s[28:31], s3 offen sc1
s_waitcnt vmcnt(5)
ds_read_b64_tr_b16 v[28:29], v13 offset:0
ds_read_b64_tr_b16 v[30:31], v13 offset:256
s_waitcnt lgkmcnt(6)
v_mfma_f32_16x16x32_bf16 v[156:159], v[16:19], v[36:39], v[156:159]
v_mfma_f32_16x16x32_bf16 v[160:163], v[16:19], v[40:43], v[160:163]
v_mfma_f32_16x16x32_bf16 v[164:167], v[16:19], v[44:47], v[164:167]
v_mfma_f32_16x16x32_bf16 v[168:171], v[16:19], v[48:51], v[168:171]
v_mfma_f32_16x16x32_bf16 v[172:175], v[16:19], v[52:55], v[172:175]
v_xor_b32 v15, 32, v13
ds_read_b64_tr_b16 v[32:33], v15 offset:0
ds_read_b64_tr_b16 v[34:35], v15 offset:256
s_waitcnt lgkmcnt(6)
v_mfma_f32_16x16x32_bf16 v[176:179], v[20:23], v[36:39], v[176:179]
v_cvt_pk_bf16_f32 v96, v96, v97
v_cvt_pk_bf16_f32 v97, v98, v99
v_cvt_pk_bf16_f32 v98, v116, v117
v_cvt_pk_bf16_f32 v99, v118, v119
s_mov_b32 s3, 5120
buffer_store_dwordx4 v[96:99], v1, s[28:31], s3 offen sc1
v_mfma_f32_16x16x32_bf16 v[180:183], v[20:23], v[40:43], v[180:183]
v_cvt_pk_bf16_f32 v100, v100, v101
v_cvt_pk_bf16_f32 v101, v102, v103
v_cvt_pk_bf16_f32 v102, v120, v121
v_cvt_pk_bf16_f32 v103, v122, v123
s_mov_b32 s3, 6144
buffer_store_dwordx4 v[100:103], v1, s[28:31], s3 offen sc1
v_mfma_f32_16x16x32_bf16 v[184:187], v[20:23], v[44:47], v[184:187]
v_cvt_pk_bf16_f32 v104, v104, v105
v_cvt_pk_bf16_f32 v105, v106, v107
v_cvt_pk_bf16_f32 v106, v124, v125
v_cvt_pk_bf16_f32 v107, v126, v127
s_mov_b32 s3, 7168
buffer_store_dwordx4 v[104:107], v1, s[28:31], s3 offen sc1
v_mfma_f32_16x16x32_bf16 v[188:191], v[20:23], v[48:51], v[188:191]
v_cvt_pk_bf16_f32 v108, v108, v109
v_cvt_pk_bf16_f32 v109, v110, v111
v_cvt_pk_bf16_f32 v110, v128, v129
v_cvt_pk_bf16_f32 v111, v130, v131
s_mov_b32 s3, 8192
buffer_store_dwordx4 v[108:111], v1, s[28:31], s3 offen sc1
v_mfma_f32_16x16x32_bf16 v[192:195], v[20:23], v[52:55], v[192:195]
v_cvt_pk_bf16_f32 v112, v112, v113
v_cvt_pk_bf16_f32 v113, v114, v115
v_cvt_pk_bf16_f32 v114, v132, v133
v_cvt_pk_bf16_f32 v115, v134, v135
s_mov_b32 s3, 9216
buffer_store_dwordx4 v[112:115], v1, s[28:31], s3 offen sc1
s_waitcnt lgkmcnt(4)
v_mfma_f32_16x16x32_bf16 v[196:199], v[24:27], v[36:39], v[196:199]
v_mfma_f32_16x16x32_bf16 v[200:203], v[24:27], v[40:43], v[200:203]
v_mfma_f32_16x16x32_bf16 v[204:207], v[24:27], v[44:47], v[204:207]
v_mfma_f32_16x16x32_bf16 v[208:211], v[24:27], v[48:51], v[208:211]
v_mfma_f32_16x16x32_bf16 v[212:215], v[24:27], v[52:55], v[212:215]
s_waitcnt lgkmcnt(2)
v_mfma_f32_16x16x32_bf16 v[216:219], v[28:31], v[36:39], v[216:219]
v_cvt_pk_bf16_f32 v136, v136, v137
v_cvt_pk_bf16_f32 v137, v138, v139
v_cvt_pk_bf16_f32 v138, v156, v157
v_cvt_pk_bf16_f32 v139, v158, v159
s_mov_b32 s3, 10240
buffer_store_dwordx4 v[136:139], v1, s[28:31], s3 offen sc1
v_mfma_f32_16x16x32_bf16 v[220:223], v[28:31], v[40:43], v[220:223]
v_cvt_pk_bf16_f32 v140, v140, v141
v_cvt_pk_bf16_f32 v141, v142, v143
v_cvt_pk_bf16_f32 v142, v160, v161
v_cvt_pk_bf16_f32 v143, v162, v163
s_mov_b32 s3, 11264
buffer_store_dwordx4 v[140:143], v1, s[28:31], s3 offen sc1
v_mfma_f32_16x16x32_bf16 v[224:227], v[28:31], v[44:47], v[224:227]
v_cvt_pk_bf16_f32 v144, v144, v145
v_cvt_pk_bf16_f32 v145, v146, v147
v_cvt_pk_bf16_f32 v146, v164, v165
v_cvt_pk_bf16_f32 v147, v166, v167
s_mov_b32 s3, 12288
buffer_store_dwordx4 v[144:147], v1, s[28:31], s3 offen sc1
v_mfma_f32_16x16x32_bf16 v[228:231], v[28:31], v[48:51], v[228:231]
v_cvt_pk_bf16_f32 v148, v148, v149
v_cvt_pk_bf16_f32 v149, v150, v151
v_cvt_pk_bf16_f32 v150, v168, v169
v_cvt_pk_bf16_f32 v151, v170, v171
s_mov_b32 s3, 13312
buffer_store_dwordx4 v[148:151], v1, s[28:31], s3 offen sc1
v_mfma_f32_16x16x32_bf16 v[232:235], v[28:31], v[52:55], v[232:235]
v_cvt_pk_bf16_f32 v152, v152, v153
v_cvt_pk_bf16_f32 v153, v154, v155
v_cvt_pk_bf16_f32 v154, v172, v173
v_cvt_pk_bf16_f32 v155, v174, v175
s_mov_b32 s3, 14336
buffer_store_dwordx4 v[152:155], v1, s[28:31], s3 offen sc1
s_waitcnt lgkmcnt(0)
v_mfma_f32_16x16x32_bf16 v[236:239], v[32:35], v[36:39], v[236:239]
v_mfma_f32_16x16x32_bf16 v[240:243], v[32:35], v[40:43], v[240:243]
v_mfma_f32_16x16x32_bf16 v[244:247], v[32:35], v[44:47], v[244:247]
v_mfma_f32_16x16x32_bf16 v[248:251], v[32:35], v[48:51], v[248:251]
v_mfma_f32_16x16x32_bf16 v[252:255], v[32:35], v[52:55], v[252:255]
v_cvt_pk_bf16_f32 v176, v176, v177
v_cvt_pk_bf16_f32 v177, v178, v179
v_cvt_pk_bf16_f32 v178, v196, v197
v_cvt_pk_bf16_f32 v179, v198, v199
s_mov_b32 s3, 15360
buffer_store_dwordx4 v[176:179], v1, s[28:31], s3 offen sc1
v_cvt_pk_bf16_f32 v180, v180, v181
v_cvt_pk_bf16_f32 v181, v182, v183
v_cvt_pk_bf16_f32 v182, v200, v201
v_cvt_pk_bf16_f32 v183, v202, v203
s_mov_b32 s3, 16384
buffer_store_dwordx4 v[180:183], v1, s[28:31], s3 offen sc1
v_cvt_pk_bf16_f32 v184, v184, v185
v_cvt_pk_bf16_f32 v185, v186, v187
v_cvt_pk_bf16_f32 v186, v204, v205
v_cvt_pk_bf16_f32 v187, v206, v207
s_mov_b32 s3, 17408
buffer_store_dwordx4 v[184:187], v1, s[28:31], s3 offen sc1
v_cvt_pk_bf16_f32 v188, v188, v189
v_cvt_pk_bf16_f32 v189, v190, v191
v_cvt_pk_bf16_f32 v190, v208, v209
v_cvt_pk_bf16_f32 v191, v210, v211
s_mov_b32 s3, 18432
buffer_store_dwordx4 v[188:191], v1, s[28:31], s3 offen sc1
v_cvt_pk_bf16_f32 v192, v192, v193
v_cvt_pk_bf16_f32 v193, v194, v195
v_cvt_pk_bf16_f32 v194, v212, v213
v_cvt_pk_bf16_f32 v195, v214, v215
s_mov_b32 s3, 19456
buffer_store_dwordx4 v[192:195], v1, s[28:31], s3 offen sc1
v_cvt_pk_bf16_f32 v216, v216, v217
v_cvt_pk_bf16_f32 v217, v218, v219
v_cvt_pk_bf16_f32 v218, v236, v237
v_cvt_pk_bf16_f32 v219, v238, v239
s_mov_b32 s3, 20480
buffer_store_dwordx4 v[216:219], v1, s[28:31], s3 offen sc1
v_cvt_pk_bf16_f32 v220, v220, v221
v_cvt_pk_bf16_f32 v221, v222, v223
v_cvt_pk_bf16_f32 v222, v240, v241
v_cvt_pk_bf16_f32 v223, v242, v243
s_mov_b32 s3, 21504
buffer_store_dwordx4 v[220:223], v1, s[28:31], s3 offen sc1
v_cvt_pk_bf16_f32 v224, v224, v225
v_cvt_pk_bf16_f32 v225, v226, v227
v_cvt_pk_bf16_f32 v226, v244, v245
v_cvt_pk_bf16_f32 v227, v246, v247
s_mov_b32 s3, 22528
buffer_store_dwordx4 v[224:227], v1, s[28:31], s3 offen sc1
v_cvt_pk_bf16_f32 v228, v228, v229
v_cvt_pk_bf16_f32 v229, v230, v231
v_cvt_pk_bf16_f32 v230, v248, v249
v_cvt_pk_bf16_f32 v231, v250, v251
s_mov_b32 s3, 23552
buffer_store_dwordx4 v[228:231], v1, s[28:31], s3 offen sc1
v_cvt_pk_bf16_f32 v232, v232, v233
v_cvt_pk_bf16_f32 v233, v234, v235
v_cvt_pk_bf16_f32 v234, v252, v253
v_cvt_pk_bf16_f32 v235, v254, v255
s_mov_b32 s3, 24576
buffer_store_dwordx4 v[232:235], v1, s[28:31], s3 offen sc1
s_waitcnt vmcnt(0)
.Lfin:
s_load_dwordx4 s[40:43], s[0:1], 80
s_bfe_u32 s3, s2, 0x10002
s_bfe_u32 s4, s2, 0x40003
s_lshl_b32 s16, s3, 4
s_add_u32 s16, s16, s4
s_and_b32 s5, s2, 3
s_lshl_b32 s5, s5, 1
s_lshr_b32 s6, s2, 7
s_add_u32 s5, s5, s6
s_lshl_b32 s5, s5, 3
s_add_u32 s17, s5, s50
s_mul_i32 s18, s16, 819200
s_mul_i32 s19, s4, 204800
s_mul_i32 s3, s3, 1280
s_add_u32 s19, s19, s3
v_mbcnt_lo_u32_b32 v0, -1, 0
v_mbcnt_hi_u32_b32 v0, -1, v0
v_lshlrev_b32 v1, 4, v0
v_and_b32 v2, 15, v0
v_mul_u32_u24 v2, 2560, v2
v_lshrrev_b32 v3, 4, v0
v_lshl_add_u32 v2, v3, 3, v2
s_waitcnt lgkmcnt(0)
s_add_u32 s8, s64, s18
s_addc_u32 s9, s65, 0
s_mov_b32 s10, 819200
s_mov_b32 s11, 0x00020000
s_mov_b32 s12, s40
s_mov_b32 s13, s41
s_mov_b32 s14, 3276800
s_mov_b32 s15, 0x00020000
s_cmp_lg_u32 s50, 0
s_cbranch_scc1 .Lfin_z1
s_lshl_b32 s3, s16, 3
v_mov_b32 v4, s3
s_mov_b32 s4, 0
s_mov_b64 exec, 1
.Lfin_chk:
global_load_dword v6, v4, s[42:43] sc1
s_add_u32 s4, s4, 1
s_waitcnt vmcnt(0)
v_readfirstlane_b32 s5, v6
s_cmp_gt_u32 s4, 400000
s_cbranch_scc1 .Lfin_chkd
s_and_b32 s5, s5, 7
s_cbranch_scc1 .Lfin_chk
.Lfin_chkd:
s_mov_b64 exec, -1
s_lshl_b32 s3, s16, 10
s_lshr_b32 s5, s17, 1
s_add_u32 s3, s3, s5
s_add_u32 s3, s3, 26214400
v_lshlrev_b32 v4, 7, v0
v_add_u32 v4, s3, v4
v_lshlrev_b32 v7, 2, v0
v_add_u32 v7, s69, v7
v_mov_b32 v5, 8
.Lfin_z1:
s_barrier
s_cmp_lg_u32 s50, 0
s_cbranch_scc1 .Lfin_go
s_mov_b32 s4, 0
s_mov_b64 exec, 0xff
global_store_dword v4, v5, s[64:65] sc1
.Lfin_poll:
global_load_dword v6, v7, s[64:65] sc1
s_add_u32 s4, s4, 1
s_waitcnt vmcnt(0)
v_cmp_ne_u32 vcc, 8, v6
s_cmp_gt_u32 s4, 400000
s_cbranch_scc1 .Lfin_met
s_nop 3
s_cbranch_vccnz .Lfin_poll
.Lfin_met:
s_mov_b64 exec, -1
.Lfin_go:
s_barrier
s_add_u32 s3, s17, 0
s_lshl_b32 s20, s3, 10
s_mul_i32 s4, s3, 41
s_lshr_b32 s4, s4, 10
s_mul_i32 s5, s4, 25
s_sub_u32 s5, s3, s5
s_mul_i32 s6, s5, 52
s_lshr_b32 s6, s6, 8
s_mul_i32 s7, s6, 5
s_sub_u32 s7, s5, s7
s_mul_i32 s7, s7, 40960
s_mul_i32 s5, s4, 320
s_add_u32 s7, s7, s5
s_and_b32 s4, s4, 1
s_add_u32 s4, s4, s6
s_cmp_eq_u32 s4, 5
s_cselect_b32 s4, 0, s4
s_lshl_b32 s4, s4, 6
s_add_u32 s7, s7, s4
s_add_u32 s22, s7, s19
buffer_load_dwordx4 v[16:19], v1, s[8:11], s20 offen sc1
s_add_u32 s20, s20, 102400
buffer_load_dwordx4 v[20:23], v1, s[8:11], s20 offen sc1
s_add_u32 s20, s20, 102400
buffer_load_dwordx4 v[24:27], v1, s[8:11], s20 offen sc1
s_add_u32 s20, s20, 102400
buffer_load_dwordx4 v[28:31], v1, s[8:11], s20 offen sc1
s_add_u32 s20, s20, 102400
buffer_load_dwordx4 v[32:35], v1, s[8:11], s20 offen sc1
s_add_u32 s20, s20, 102400
buffer_load_dwordx4 v[36:39], v1, s[8:11], s20 offen sc1
s_add_u32 s20, s20, 102400
buffer_load_dwordx4 v[40:43], v1, s[8:11], s20 offen sc1
s_add_u32 s20, s20, 102400
buffer_load_dwordx4 v[44:47], v1, s[8:11], s20 offen sc1
s_add_u32 s20, s20, 102400
s_cmp_ge_u32 s17, 36
s_cbranch_scc1 .Lfin_one
s_add_u32 s3, s17, 64
s_lshl_b32 s20, s3, 10
s_mul_i32 s4, s3, 41
s_lshr_b32 s4, s4, 10
s_mul_i32 s5, s4, 25
s_sub_u32 s5, s3, s5
s_mul_i32 s6, s5, 52
s_lshr_b32 s6, s6, 8
s_mul_i32 s7, s6, 5
s_sub_u32 s7, s5, s7
s_mul_i32 s7, s7, 40960
s_mul_i32 s5, s4, 320
s_add_u32 s7, s7, s5
s_and_b32 s4, s4, 1
s_add_u32 s4, s4, s6
s_cmp_eq_u32 s4, 5
s_cselect_b32 s4, 0, s4
s_lshl_b32 s4, s4, 6
s_add_u32 s7, s7, s4
s_add_u32 s23, s7, s19
buffer_load_dwordx4 v[48:51], v1, s[8:11], s20 offen sc1
s_add_u32 s20, s20, 102400
buffer_load_dwordx4 v[52:55], v1, s[8:11], s20 offen sc1
s_add_u32 s20, s20, 102400
buffer_load_dwordx4 v[56:59], v1, s[8:11], s20 offen sc1
s_add_u32 s20, s20, 102400
buffer_load_dwordx4 v[60:63], v1, s[8:11], s20 offen sc1
s_add_u32 s20, s20, 102400
buffer_load_dwordx4 v[64:67], v1, s[8:11], s20 offen sc1
s_add_u32 s20, s20, 102400
buffer_load_dwordx4 v[68:71], v1, s[8:11], s20 offen sc1
s_add_u32 s20, s20, 102400
buffer_load_dwordx4 v[72:75], v1, s[8:11], s20 offen sc1
s_add_u32 s20, s20, 102400
buffer_load_dwordx4 v[76:79], v1, s[8:11], s20 offen sc1
s_add_u32 s20, s20, 102400
s_waitcnt vmcnt(15)
v_lshlrev_b32 v80, 16, v16
v_and_b32 v81, 0xffff0000, v16
v_lshlrev_b32 v82, 16, v17
v_and_b32 v83, 0xffff0000, v17
v_lshlrev_b32 v84, 16, v18
v_and_b32 v85, 0xffff0000, v18
v_lshlrev_b32 v86, 16, v19
v_and_b32 v87, 0xffff0000, v19
s_waitcnt vmcnt(14)
v_lshlrev_b32 v12, 16, v20
v_and_b32 v13, 0xffff0000, v20
v_add_f32 v80, v80, v12
v_add_f32 v81, v81, v13
v_lshlrev_b32 v12, 16, v21
v_and_b32 v13, 0xffff0000, v21
v_add_f32 v82, v82, v12
v_add_f32 v83, v83, v13
v_lshlrev_b32 v12, 16, v22
v_and_b32 v13, 0xffff0000, v22
v_add_f32 v84, v84, v12
v_add_f32 v85, v85, v13
v_lshlrev_b32 v12, 16, v23
v_and_b32 v13, 0xffff0000, v23
v_add_f32 v86, v86, v12
v_add_f32 v87, v87, v13
s_waitcnt vmcnt(13)
v_lshlrev_b32 v12, 16, v24
v_and_b32 v13, 0xffff0000, v24
v_add_f32 v80, v80, v12
v_add_f32 v81, v81, v13
v_lshlrev_b32 v12, 16, v25
v_and_b32 v13, 0xffff0000, v25
v_add_f32 v82, v82, v12
v_add_f32 v83, v83, v13
v_lshlrev_b32 v12, 16, v26
v_and_b32 v13, 0xffff0000, v26
v_add_f32 v84, v84, v12
v_add_f32 v85, v85, v13
v_lshlrev_b32 v12, 16, v27
v_and_b32 v13, 0xffff0000, v27
v_add_f32 v86, v86, v12
v_add_f32 v87, v87, v13
s_waitcnt vmcnt(12)
v_lshlrev_b32 v12, 16, v28
v_and_b32 v13, 0xffff0000, v28
v_add_f32 v80, v80, v12
v_add_f32 v81, v81, v13
v_lshlrev_b32 v12, 16, v29
v_and_b32 v13, 0xffff0000, v29
v_add_f32 v82, v82, v12
v_add_f32 v83, v83, v13
v_lshlrev_b32 v12, 16, v30
v_and_b32 v13, 0xffff0000, v30
v_add_f32 v84, v84, v12
v_add_f32 v85, v85, v13
v_lshlrev_b32 v12, 16, v31
v_and_b32 v13, 0xffff0000, v31
v_add_f32 v86, v86, v12
v_add_f32 v87, v87, v13
s_waitcnt vmcnt(11)
v_lshlrev_b32 v12, 16, v32
v_and_b32 v13, 0xffff0000, v32
v_add_f32 v80, v80, v12
v_add_f32 v81, v81, v13
v_lshlrev_b32 v12, 16, v33
v_and_b32 v13, 0xffff0000, v33
v_add_f32 v82, v82, v12
v_add_f32 v83, v83, v13
v_lshlrev_b32 v12, 16, v34
v_and_b32 v13, 0xffff0000, v34
v_add_f32 v84, v84, v12
v_add_f32 v85, v85, v13
v_lshlrev_b32 v12, 16, v35
v_and_b32 v13, 0xffff0000, v35
v_add_f32 v86, v86, v12
v_add_f32 v87, v87, v13
s_waitcnt vmcnt(10)
v_lshlrev_b32 v12, 16, v36
v_and_b32 v13, 0xffff0000, v36
v_add_f32 v80, v80, v12
v_add_f32 v81, v81, v13
v_lshlrev_b32 v12, 16, v37
v_and_b32 v13, 0xffff0000, v37
v_add_f32 v82, v82, v12
v_add_f32 v83, v83, v13
v_lshlrev_b32 v12, 16, v38
v_and_b32 v13, 0xffff0000, v38
v_add_f32 v84, v84, v12
v_add_f32 v85, v85, v13
v_lshlrev_b32 v12, 16, v39
v_and_b32 v13, 0xffff0000, v39
v_add_f32 v86, v86, v12
v_add_f32 v87, v87, v13
s_waitcnt vmcnt(9)
v_lshlrev_b32 v12, 16, v40
v_and_b32 v13, 0xffff0000, v40
v_add_f32 v80, v80, v12
v_add_f32 v81, v81, v13
v_lshlrev_b32 v12, 16, v41
v_and_b32 v13, 0xffff0000, v41
v_add_f32 v82, v82, v12
v_add_f32 v83, v83, v13
v_lshlrev_b32 v12, 16, v42
v_and_b32 v13, 0xffff0000, v42
v_add_f32 v84, v84, v12
v_add_f32 v85, v85, v13
v_lshlrev_b32 v12, 16, v43
v_and_b32 v13, 0xffff0000, v43
v_add_f32 v86, v86, v12
v_add_f32 v87, v87, v13
s_waitcnt vmcnt(8)
v_lshlrev_b32 v12, 16, v44
v_and_b32 v13, 0xffff0000, v44
v_add_f32 v80, v80, v12
v_add_f32 v81, v81, v13
v_lshlrev_b32 v12, 16, v45
v_and_b32 v13, 0xffff0000, v45
v_add_f32 v82, v82, v12
v_add_f32 v83, v83, v13
v_lshlrev_b32 v12, 16, v46
v_and_b32 v13, 0xffff0000, v46
v_add_f32 v84, v84, v12
v_add_f32 v85, v85, v13
v_lshlrev_b32 v12, 16, v47
v_and_b32 v13, 0xffff0000, v47
v_add_f32 v86, v86, v12
v_add_f32 v87, v87, v13
v_cvt_pk_bf16_f32 v80, v80, v81
v_cvt_pk_bf16_f32 v81, v82, v83
v_cvt_pk_bf16_f32 v82, v84, v85
v_cvt_pk_bf16_f32 v83, v86, v87
buffer_store_dwordx2 v[80:81], v2, s[12:15], s22 offen
buffer_store_dwordx2 v[82:83], v2, s[12:15], s22 offen offset:32
s_waitcnt vmcnt(9)
v_lshlrev_b32 v88, 16, v48
v_and_b32 v89, 0xffff0000, v48
v_lshlrev_b32 v90, 16, v49
v_and_b32 v91, 0xffff0000, v49
v_lshlrev_b32 v92, 16, v50
v_and_b32 v93, 0xffff0000, v50
v_lshlrev_b32 v94, 16, v51
v_and_b32 v95, 0xffff0000, v51
s_waitcnt vmcnt(8)
v_lshlrev_b32 v12, 16, v52
v_and_b32 v13, 0xffff0000, v52
v_add_f32 v88, v88, v12
v_add_f32 v89, v89, v13
v_lshlrev_b32 v12, 16, v53
v_and_b32 v13, 0xffff0000, v53
v_add_f32 v90, v90, v12
v_add_f32 v91, v91, v13
v_lshlrev_b32 v12, 16, v54
v_and_b32 v13, 0xffff0000, v54
v_add_f32 v92, v92, v12
v_add_f32 v93, v93, v13
v_lshlrev_b32 v12, 16, v55
v_and_b32 v13, 0xffff0000, v55
v_add_f32 v94, v94, v12
v_add_f32 v95, v95, v13
s_waitcnt vmcnt(7)
v_lshlrev_b32 v12, 16, v56
v_and_b32 v13, 0xffff0000, v56
v_add_f32 v88, v88, v12
v_add_f32 v89, v89, v13
v_lshlrev_b32 v12, 16, v57
v_and_b32 v13, 0xffff0000, v57
v_add_f32 v90, v90, v12
v_add_f32 v91, v91, v13
v_lshlrev_b32 v12, 16, v58
v_and_b32 v13, 0xffff0000, v58
v_add_f32 v92, v92, v12
v_add_f32 v93, v93, v13
v_lshlrev_b32 v12, 16, v59
v_and_b32 v13, 0xffff0000, v59
v_add_f32 v94, v94, v12
v_add_f32 v95, v95, v13
s_waitcnt vmcnt(6)
v_lshlrev_b32 v12, 16, v60
v_and_b32 v13, 0xffff0000, v60
v_add_f32 v88, v88, v12
v_add_f32 v89, v89, v13
v_lshlrev_b32 v12, 16, v61
v_and_b32 v13, 0xffff0000, v61
v_add_f32 v90, v90, v12
v_add_f32 v91, v91, v13
v_lshlrev_b32 v12, 16, v62
v_and_b32 v13, 0xffff0000, v62
v_add_f32 v92, v92, v12
v_add_f32 v93, v93, v13
v_lshlrev_b32 v12, 16, v63
v_and_b32 v13, 0xffff0000, v63
v_add_f32 v94, v94, v12
v_add_f32 v95, v95, v13
s_waitcnt vmcnt(5)
v_lshlrev_b32 v12, 16, v64
v_and_b32 v13, 0xffff0000, v64
v_add_f32 v88, v88, v12
v_add_f32 v89, v89, v13
v_lshlrev_b32 v12, 16, v65
v_and_b32 v13, 0xffff0000, v65
v_add_f32 v90, v90, v12
v_add_f32 v91, v91, v13
v_lshlrev_b32 v12, 16, v66
v_and_b32 v13, 0xffff0000, v66
v_add_f32 v92, v92, v12
v_add_f32 v93, v93, v13
v_lshlrev_b32 v12, 16, v67
v_and_b32 v13, 0xffff0000, v67
v_add_f32 v94, v94, v12
v_add_f32 v95, v95, v13
s_waitcnt vmcnt(4)
v_lshlrev_b32 v12, 16, v68
v_and_b32 v13, 0xffff0000, v68
v_add_f32 v88, v88, v12
v_add_f32 v89, v89, v13
v_lshlrev_b32 v12, 16, v69
v_and_b32 v13, 0xffff0000, v69
v_add_f32 v90, v90, v12
v_add_f32 v91, v91, v13
v_lshlrev_b32 v12, 16, v70
v_and_b32 v13, 0xffff0000, v70
v_add_f32 v92, v92, v12
v_add_f32 v93, v93, v13
v_lshlrev_b32 v12, 16, v71
v_and_b32 v13, 0xffff0000, v71
v_add_f32 v94, v94, v12
v_add_f32 v95, v95, v13
s_waitcnt vmcnt(3)
v_lshlrev_b32 v12, 16, v72
v_and_b32 v13, 0xffff0000, v72
v_add_f32 v88, v88, v12
v_add_f32 v89, v89, v13
v_lshlrev_b32 v12, 16, v73
v_and_b32 v13, 0xffff0000, v73
v_add_f32 v90, v90, v12
v_add_f32 v91, v91, v13
v_lshlrev_b32 v12, 16, v74
v_and_b32 v13, 0xffff0000, v74
v_add_f32 v92, v92, v12
v_add_f32 v93, v93, v13
v_lshlrev_b32 v12, 16, v75
v_and_b32 v13, 0xffff0000, v75
v_add_f32 v94, v94, v12
v_add_f32 v95, v95, v13
s_waitcnt vmcnt(2)
v_lshlrev_b32 v12, 16, v76
v_and_b32 v13, 0xffff0000, v76
v_add_f32 v88, v88, v12
v_add_f32 v89, v89, v13
v_lshlrev_b32 v12, 16, v77
v_and_b32 v13, 0xffff0000, v77
v_add_f32 v90, v90, v12
v_add_f32 v91, v91, v13
v_lshlrev_b32 v12, 16, v78
v_and_b32 v13, 0xffff0000, v78
v_add_f32 v92, v92, v12
v_add_f32 v93, v93, v13
v_lshlrev_b32 v12, 16, v79
v_and_b32 v13, 0xffff0000, v79
v_add_f32 v94, v94, v12
v_add_f32 v95, v95, v13
v_cvt_pk_bf16_f32 v88, v88, v89
v_cvt_pk_bf16_f32 v89, v90, v91
v_cvt_pk_bf16_f32 v90, v92, v93
v_cvt_pk_bf16_f32 v91, v94, v95
buffer_store_dwordx2 v[88:89], v2, s[12:15], s23 offen
buffer_store_dwordx2 v[90:91], v2, s[12:15], s23 offen offset:32
s_branch .Lfin_done
.Lfin_one:
s_waitcnt vmcnt(7)
v_lshlrev_b32 v80, 16, v16
v_and_b32 v81, 0xffff0000, v16
v_lshlrev_b32 v82, 16, v17
v_and_b32 v83, 0xffff0000, v17
v_lshlrev_b32 v84, 16, v18
v_and_b32 v85, 0xffff0000, v18
v_lshlrev_b32 v86, 16, v19
v_and_b32 v87, 0xffff0000, v19
s_waitcnt vmcnt(6)
v_lshlrev_b32 v12, 16, v20
v_and_b32 v13, 0xffff0000, v20
v_add_f32 v80, v80, v12
v_add_f32 v81, v81, v13
v_lshlrev_b32 v12, 16, v21
v_and_b32 v13, 0xffff0000, v21
v_add_f32 v82, v82, v12
v_add_f32 v83, v83, v13
v_lshlrev_b32 v12, 16, v22
v_and_b32 v13, 0xffff0000, v22
v_add_f32 v84, v84, v12
v_add_f32 v85, v85, v13
v_lshlrev_b32 v12, 16, v23
v_and_b32 v13, 0xffff0000, v23
v_add_f32 v86, v86, v12
v_add_f32 v87, v87, v13
s_waitcnt vmcnt(5)
v_lshlrev_b32 v12, 16, v24
v_and_b32 v13, 0xffff0000, v24
v_add_f32 v80, v80, v12
v_add_f32 v81, v81, v13
v_lshlrev_b32 v12, 16, v25
v_and_b32 v13, 0xffff0000, v25
v_add_f32 v82, v82, v12
v_add_f32 v83, v83, v13
v_lshlrev_b32 v12, 16, v26
v_and_b32 v13, 0xffff0000, v26
v_add_f32 v84, v84, v12
v_add_f32 v85, v85, v13
v_lshlrev_b32 v12, 16, v27
v_and_b32 v13, 0xffff0000, v27
v_add_f32 v86, v86, v12
v_add_f32 v87, v87, v13
s_waitcnt vmcnt(4)
v_lshlrev_b32 v12, 16, v28
v_and_b32 v13, 0xffff0000, v28
v_add_f32 v80, v80, v12
v_add_f32 v81, v81, v13
v_lshlrev_b32 v12, 16, v29
v_and_b32 v13, 0xffff0000, v29
v_add_f32 v82, v82, v12
v_add_f32 v83, v83, v13
v_lshlrev_b32 v12, 16, v30
v_and_b32 v13, 0xffff0000, v30
v_add_f32 v84, v84, v12
v_add_f32 v85, v85, v13
v_lshlrev_b32 v12, 16, v31
v_and_b32 v13, 0xffff0000, v31
v_add_f32 v86, v86, v12
v_add_f32 v87, v87, v13
s_waitcnt vmcnt(3)
v_lshlrev_b32 v12, 16, v32
v_and_b32 v13, 0xffff0000, v32
v_add_f32 v80, v80, v12
v_add_f32 v81, v81, v13
v_lshlrev_b32 v12, 16, v33
v_and_b32 v13, 0xffff0000, v33
v_add_f32 v82, v82, v12
v_add_f32 v83, v83, v13
v_lshlrev_b32 v12, 16, v34
v_and_b32 v13, 0xffff0000, v34
v_add_f32 v84, v84, v12
v_add_f32 v85, v85, v13
v_lshlrev_b32 v12, 16, v35
v_and_b32 v13, 0xffff0000, v35
v_add_f32 v86, v86, v12
v_add_f32 v87, v87, v13
s_waitcnt vmcnt(2)
v_lshlrev_b32 v12, 16, v36
v_and_b32 v13, 0xffff0000, v36
v_add_f32 v80, v80, v12
v_add_f32 v81, v81, v13
v_lshlrev_b32 v12, 16, v37
v_and_b32 v13, 0xffff0000, v37
v_add_f32 v82, v82, v12
v_add_f32 v83, v83, v13
v_lshlrev_b32 v12, 16, v38
v_and_b32 v13, 0xffff0000, v38
v_add_f32 v84, v84, v12
v_add_f32 v85, v85, v13
v_lshlrev_b32 v12, 16, v39
v_and_b32 v13, 0xffff0000, v39
v_add_f32 v86, v86, v12
v_add_f32 v87, v87, v13
s_waitcnt vmcnt(1)
v_lshlrev_b32 v12, 16, v40
v_and_b32 v13, 0xffff0000, v40
v_add_f32 v80, v80, v12
v_add_f32 v81, v81, v13
v_lshlrev_b32 v12, 16, v41
v_and_b32 v13, 0xffff0000, v41
v_add_f32 v82, v82, v12
v_add_f32 v83, v83, v13
v_lshlrev_b32 v12, 16, v42
v_and_b32 v13, 0xffff0000, v42
v_add_f32 v84, v84, v12
v_add_f32 v85, v85, v13
v_lshlrev_b32 v12, 16, v43
v_and_b32 v13, 0xffff0000, v43
v_add_f32 v86, v86, v12
v_add_f32 v87, v87, v13
s_waitcnt vmcnt(0)
v_lshlrev_b32 v12, 16, v44
v_and_b32 v13, 0xffff0000, v44
v_add_f32 v80, v80, v12
v_add_f32 v81, v81, v13
v_lshlrev_b32 v12, 16, v45
v_and_b32 v13, 0xffff0000, v45
v_add_f32 v82, v82, v12
v_add_f32 v83, v83, v13
v_lshlrev_b32 v12, 16, v46
v_and_b32 v13, 0xffff0000, v46
v_add_f32 v84, v84, v12
v_add_f32 v85, v85, v13
v_lshlrev_b32 v12, 16, v47
v_and_b32 v13, 0xffff0000, v47
v_add_f32 v86, v86, v12
v_add_f32 v87, v87, v13
v_cvt_pk_bf16_f32 v80, v80, v81
v_cvt_pk_bf16_f32 v81, v82, v83
v_cvt_pk_bf16_f32 v82, v84, v85
v_cvt_pk_bf16_f32 v83, v86, v87
buffer_store_dwordx2 v[80:81], v2, s[12:15], s22 offen
buffer_store_dwordx2 v[82:83], v2, s[12:15], s22 offen offset:32
.Lfin_done:
s_waitcnt vmcnt(0)
.Lf_end2:
s_endpgm
.section .rodata,"a"
.p2align 6
.amdhsa_kernel concat_heads__mha_block_cached__mha_block_cached__near_ridge_kernel
  .amdhsa_next_free_vgpr 256
  .amdhsa_next_free_sgpr 96
  .amdhsa_accum_offset 256
  .amdhsa_group_segment_fixed_size 0
  .amdhsa_kernarg_size 104
  .amdhsa_user_sgpr_count 2
  .amdhsa_user_sgpr_kernarg_segment_ptr 1
  .amdhsa_system_sgpr_workgroup_id_x 1
.end_amdhsa_kernel
```
